```python
import torch

def _softmax(x, axis=-1):
    return torch.softmax(x, dim=axis)
def _gelu(x):
    return torch.nn.functional.gelu(x, approximate="tanh")
def _silu(x):
    return torch.nn.functional.silu(x)
def _sigmoid(x):
    return torch.sigmoid(x)
def _layernorm(x, axis=-1, eps=1e-5):
    m = x.mean(dim=axis, keepdim=True)
    v = x.var(dim=axis, keepdim=True, unbiased=False)
    return (x - m) / torch.sqrt(v + eps)
def _scatter_add(tgt, idx, src, axis=0):
    return tgt.clone().index_add_(axis, idx, src)
def _segment_sum(src, seg, n):
    out = torch.zeros((n,) + src.shape[1:], dtype=src.dtype)
    return out.index_add_(0, seg, src)
def _pad(x, pw):
    flat = tuple(v for pair in reversed(pw) for v in pair)
    return torch.nn.functional.pad(x, flat)

kernel_name = 'interleave_layers__linear_kernel_hedgehog__mha_block__prompt'

def setup_inputs():

    _w = (lambda a: (lambda t: t.to(torch.bfloat16) if t.is_floating_point() else t)(torch.as_tensor(a)))
    def _A_setup():
        B, S, D, H = 1, 2048, 448, 16
        Dh = D // H
        return {
            "x": _w((lambda *s: torch.randn(*s, dtype=torch.bfloat16) * 0.05)(B, S, D)),
            "wqkv": _w((lambda *s: torch.randn(*s, dtype=torch.bfloat16) * 0.4)(D, 3 * D)),
            "w_phi": _w((lambda *s: torch.randn(*s, dtype=torch.bfloat16) * 0.4)(H, Dh, Dh) * (Dh ** -0.5)),
            "wo": _w((lambda *s: torch.randn(*s, dtype=torch.bfloat16) * 0.05)(D, D)),
        }
    _A_in = _A_setup()

    def _B_setup():
        B, S, D, H = 1, 2048, 448, 16
        return {
            "x": _w((lambda *s: torch.randn(*s, dtype=torch.bfloat16) * 0.05)(B, S, D)),
            "wqkv": _w((lambda *s: torch.randn(*s, dtype=torch.bfloat16) * 0.1)(D, 3 * D)),
            "wo": _w((lambda *s: torch.randn(*s, dtype=torch.bfloat16) * 0.05)(D, D)),
        }
    _B_in = _B_setup()

    return {
        "A_x": _A_in["x"],
        "A_wqkv": _A_in["wqkv"],
        "A_w_phi": _A_in["w_phi"],
        "A_wo": _A_in["wo"],
        "B_x": _B_in["x"],
        "B_wqkv": _B_in["wqkv"],
        "B_wo": _B_in["wo"],
    }

def reference(A_x, A_wqkv, A_w_phi, A_wo, B_x, B_wqkv, B_wo):
    def _A_ref(x, wqkv, w_phi, wo):
        B, S, D = x.shape
        H = 16; Dh = D // H
        qkv = (lambda x, *d: x.permute(*d))((x @ wqkv).reshape(B, S, 3, H, Dh), 2, 0, 3, 1, 4)
        q, k, v = qkv[0], qkv[1], qkv[2]
        pq = torch.einsum("bhsd,hdf->bhsf", q, w_phi)
        pk = torch.einsum("bhsd,hdf->bhsf", k, w_phi)
        phi_q = torch.concatenate([_softmax(pq, axis=-1), _softmax(-pq, axis=-1)], axis=-1)
        phi_k = torch.concatenate([_softmax(pk, axis=-1), _softmax(-pk, axis=-1)], axis=-1)
        kv = torch.einsum("bhsf,bhsd->bhfd", phi_k, v)
        z  = torch.einsum("bhsf->bhf", phi_k)
        num = torch.einsum("bhqf,bhfd->bhqd", phi_q, kv)
        den = torch.einsum("bhqf,bhf->bhq", phi_q, z)[..., None] + 1e-6
        o = num / den
        return (lambda x, *d: x.permute(*d))(o, 0, 2, 1, 3).reshape(B, S, D) @ wo

    def _B_ref(x, wqkv, wo):
        B, S, D = x.shape
        H = 16
        Dh = D // H
        qkv = (lambda x, *d: x.permute(*d))((x @ wqkv).reshape(B, S, 3, H, Dh), 2, 0, 3, 1, 4)
        q, k, v = qkv[0], qkv[1], qkv[2]
        scores = torch.einsum("bhqd,bhkd->bhqk", q, k) * (Dh ** -0.5)
        p = _softmax(scores, axis=-1)
        o = torch.einsum("bhqk,bhkd->bhqd", p, v)
        return (lambda x, *d: x.permute(*d))(o, 0, 2, 1, 3).reshape(B, S, D) @ wo

    x = A_x
    x = x + _A_ref(_layernorm(x, axis=-1), A_wqkv, A_w_phi, A_wo)
    x = x + _B_ref(_layernorm(x, axis=-1), B_wqkv, B_wo)
    x = x + _A_ref(_layernorm(x, axis=-1), A_wqkv, A_w_phi, A_wo)
    x = x + _B_ref(_layernorm(x, axis=-1), B_wqkv, B_wo)
    return x
```

```asm
; @launch grid=(256,1,1) block=(256,1,1) lds=163840
.amdgcn_target "amdgcn-amd-amdhsa--gfx950"
.text
.globl interleave_layers__linear_kernel_hedgehog__mha_block__prompt_kernel
.p2align 8
.type interleave_layers__linear_kernel_hedgehog__mha_block__prompt_kernel,@function
interleave_layers__linear_kernel_hedgehog__mha_block__prompt_kernel:
    s_cmp_ge_u32 s2, 256
    s_cbranch_scc1 L_end
    s_load_dwordx16 s[4:19], s[0:1], 0
    s_load_dwordx4 s[20:23], s[0:1], 64
    v_lshrrev_b32 v1, 6, v0
    s_nop 0
    v_readfirstlane_b32 s62, v1
    v_and_b32 v0, 63, v0
    s_getpc_b64 s[56:57]
    s_and_b32 s56, s56, 0xffffff00
    s_lshr_b32 s89, s2, 3
    s_lshl_b32 s89, s89, 2
    s_add_u32 s89, s89, s62
    s_mul_i32 s89, s89, 640
    v_lshl_add_u32 v2, v0, 7, s89
    s_mov_b32 s89, L_code_end-interleave_layers__linear_kernel_hedgehog__mha_block__prompt_kernel-4
    v_min_u32 v2, s89, v2
    v_mov_b32 v3, 0
    v_lshl_add_u64 v[2:3], v[2:3], 0, s[56:57]
    s_mov_b64 exec, 31
    global_load_dword v250, v[2:3], off
    s_mov_b64 exec, -1
    s_bfe_u32 s89, s2, 0x20001
    s_lshl_b32 s89, s89, 2
    s_bfe_u32 s90, s2, 0x20003
    s_add_u32 s60, s89, s90
    s_and_b32 s89, s2, 1
    s_lshl_b32 s89, s89, 3
    s_lshr_b32 s90, s2, 5
    s_add_u32 s61, s89, s90
    s_mov_b32 s63, 0x40000
    s_mov_b32 s88, 1
    s_mov_b32 s93, 0x00003f80
    s_mov_b32 s94, 0x3f800000
    s_mov_b32 s80, 0
    s_mov_b32 s81, -1
    s_mov_b32 s82, -1
    s_mov_b32 s83, 0
    s_mov_b32 s84, 0xf0000000
    s_mov_b32 s85, 0xf0000000
    s_bitcmp1_b32 s61, 0
    s_cselect_b64 s[86:87], 0, s[80:81]
    s_lshl_b32 s89, s60, 2
    s_add_u32 s89, s89, s62
    s_lshl_b32 s90, s61, 2
    s_add_u32 s90, s90, s62
    s_lshl_b32 s68, s89, 15
    s_lshl_b32 s91, s61, 11
    s_add_u32 s69, s68, s91
    s_lshr_b32 s91, s61, 2
    s_lshl_b32 s92, s91, 13
    s_or_b32 s68, s68, s92
    s_xor_b32 s95, s62, s91
    s_lshl_b32 s70, s90, 16
    s_lshl_b32 s71, s90, 14
    s_mul_i32 s100, s62, 7168
    s_mul_i32 s3, s61, 114688
    s_mul_i32 s92, s95, 7168
    s_add_u32 s3, s3, s92
    s_add_u32 s3, s3, 26214400
    v_lshlrev_b32 v1, 4, v0
    v_lshrrev_b32 v83, 3, v0
    v_and_b32 v84, 7, v0
    v_lshrrev_b32 v85, 1, v83
    v_xor_b32 v84, v84, v85
    v_mul_u32_u24 v83, 896, v83
    v_lshl_add_u32 v88, v84, 4, v83
    v_xor_b32 v89, 64, v88
    s_mul_i32 s92, s61, 56
    v_lshrrev_b32 v83, 2, v0
    v_and_b32 v84, 3, v0
    v_lshl_add_u32 v84, v84, 4, s92
    v_mul_u32_u24 v12, 2688, v83
    v_add_u32 v12, v12, v84
    v_mul_u32_u24 v87, 896, v83
    v_add_u32 v87, v87, v84
    s_mul_i32 s72, s89, 28672
    s_mul_i32 s73, s62, 26624
    s_add_u32 s73, s73, 57344
    s_mul_i32 s74, s61, 6
    s_lshr_b32 s74, s74, 4
    s_waitcnt lgkmcnt(0)
    s_mov_b32 s24, s4
    s_and_b32 s25, s5, 0xffff
    s_mov_b32 s26, 1835008
    s_mov_b32 s27, 0x20000
    s_mov_b32 s52, s22
    s_and_b32 s53, s23, 0xffff
    s_mov_b32 s54, 31457280
    s_mov_b32 s55, 0x20000
    s_or_b32 s91, s2, s62
    s_cmp_lg_u32 s91, 0
    s_cbranch_scc1 L_noinit
    v_lshlrev_b32 v84, 7, v0
    v_mov_b32 v85, 0
    buffer_store_dword v85, v84, s[52:55], 0 offen sc1
    v_add_u32 v84, 8192, v84
    buffer_store_dword v85, v84, s[52:55], 0 offen sc1
    s_nop 1
L_noinit:
    s_mov_b32 s28, s6
    s_and_b32 s29, s7, 0xffff
    s_mov_b32 s30, 1204224
    s_mov_b32 s31, 0x20000
    s_lshl_b32 s75, s74, 7
    s_add_u32 s75, s75, s72
    s_lshl_b32 s76, s74, 12
    s_add_u32 s76, s76, s73
    s_add_u32 m0, s76, 0
    s_nop 0
    buffer_load_dwordx4 v88, s[24:27], s75 offen lds
    s_add_u32 m0, s76, 1024
    s_add_u32 s75, s75, 7168
    buffer_load_dwordx4 v88, s[24:27], s75 offen lds
    s_add_u32 m0, s76, 2048
    s_add_u32 s75, s75, 7168
    buffer_load_dwordx4 v89, s[24:27], s75 offen lds
    s_add_u32 m0, s76, 3072
    s_add_u32 s75, s75, 7168
    buffer_load_dwordx4 v89, s[24:27], s75 offen lds
    s_add_u32 s74, s74, 1
    s_cmp_eq_u32 s74, 6
    s_cselect_b32 s74, 0, s74
    s_lshl_b32 s75, s74, 7
    s_add_u32 s75, s75, s72
    s_lshl_b32 s76, s74, 12
    s_add_u32 s76, s76, s73
    s_add_u32 m0, s76, 0
    s_nop 0
    buffer_load_dwordx4 v88, s[24:27], s75 offen lds
    s_add_u32 m0, s76, 1024
    s_add_u32 s75, s75, 7168
    buffer_load_dwordx4 v88, s[24:27], s75 offen lds
    s_add_u32 m0, s76, 2048
    s_add_u32 s75, s75, 7168
    buffer_load_dwordx4 v89, s[24:27], s75 offen lds
    s_add_u32 m0, s76, 3072
    s_add_u32 s75, s75, 7168
    buffer_load_dwordx4 v89, s[24:27], s75 offen lds
    s_add_u32 s74, s74, 1
    s_cmp_eq_u32 s74, 6
    s_cselect_b32 s74, 0, s74
    s_lshl_b32 s75, s74, 7
    s_add_u32 s75, s75, s72
    s_lshl_b32 s76, s74, 12
    s_add_u32 s76, s76, s73
    s_add_u32 m0, s76, 0
    s_nop 0
    buffer_load_dwordx4 v88, s[24:27], s75 offen lds
    s_add_u32 m0, s76, 1024
    s_add_u32 s75, s75, 7168
    buffer_load_dwordx4 v88, s[24:27], s75 offen lds
    s_add_u32 m0, s76, 2048
    s_add_u32 s75, s75, 7168
    buffer_load_dwordx4 v89, s[24:27], s75 offen lds
    s_add_u32 m0, s76, 3072
    s_add_u32 s75, s75, 7168
    buffer_load_dwordx4 v89, s[24:27], s75 offen lds
    s_add_u32 s74, s74, 1
    s_cmp_eq_u32 s74, 6
    s_cselect_b32 s74, 0, s74
    s_lshl_b32 s75, s74, 7
    s_add_u32 s75, s75, s72
    s_lshl_b32 s76, s74, 12
    s_add_u32 s76, s76, s73
    s_add_u32 m0, s76, 0
    s_nop 0
    buffer_load_dwordx4 v88, s[24:27], s75 offen lds
    s_add_u32 m0, s76, 1024
    s_add_u32 s75, s75, 7168
    buffer_load_dwordx4 v88, s[24:27], s75 offen lds
    s_add_u32 m0, s76, 2048
    s_add_u32 s75, s75, 7168
    buffer_load_dwordx4 v89, s[24:27], s75 offen lds
    s_add_u32 m0, s76, 3072
    s_add_u32 s75, s75, 7168
    buffer_load_dwordx4 v89, s[24:27], s75 offen lds
    s_add_u32 s74, s74, 1
    s_cmp_eq_u32 s74, 6
    s_cselect_b32 s74, 0, s74
    s_lshl_b32 s75, s74, 7
    s_add_u32 s75, s75, s72
    s_lshl_b32 s76, s74, 12
    s_add_u32 s76, s76, s73
    s_add_u32 m0, s76, 0
    s_nop 0
    buffer_load_dwordx4 v88, s[24:27], s75 offen lds
    s_add_u32 m0, s76, 1024
    s_add_u32 s75, s75, 7168
    buffer_load_dwordx4 v88, s[24:27], s75 offen lds
    s_add_u32 m0, s76, 2048
    s_add_u32 s75, s75, 7168
    buffer_load_dwordx4 v89, s[24:27], s75 offen lds
    s_add_u32 m0, s76, 3072
    s_add_u32 s75, s75, 7168
    buffer_load_dwordx4 v89, s[24:27], s75 offen lds
    s_add_u32 s74, s74, 1
    s_cmp_eq_u32 s74, 6
    s_cselect_b32 s74, 0, s74
    s_lshl_b32 s75, s74, 7
    s_add_u32 s75, s75, s72
    s_lshl_b32 s76, s74, 12
    s_add_u32 s76, s76, s73
    s_add_u32 m0, s76, 0
    s_nop 0
    buffer_load_dwordx4 v88, s[24:27], s75 offen lds
    s_add_u32 m0, s76, 1024
    s_add_u32 s75, s75, 7168
    buffer_load_dwordx4 v88, s[24:27], s75 offen lds
    s_add_u32 m0, s76, 2048
    s_add_u32 s75, s75, 7168
    buffer_load_dwordx4 v89, s[24:27], s75 offen lds
    s_add_u32 m0, s76, 3072
    s_add_u32 s75, s75, 7168
    buffer_load_dwordx4 v89, s[24:27], s75 offen lds
    s_add_u32 s74, s74, 1
    s_cmp_eq_u32 s74, 6
    s_cselect_b32 s74, 0, s74
    s_add_u32 m0, s73, 24576
    s_add_u32 s75, s72, 768
    buffer_load_dwordx4 v88, s[24:27], s75 offen lds
    s_add_u32 m0, s73, 25600
    s_add_u32 s75, s72, 7936
    buffer_load_dwordx4 v88, s[24:27], s75 offen lds
    s_mul_i32 s74, s60, 7
    s_lshr_b32 s74, s74, 4
    s_and_b32 s77, s60, 1
    s_xor_b32 s78, s77, 0
    s_mul_i32 s76, s78, 28672
    s_add_u32 s76, s76, s100
    s_mul_i32 s78, s78, 896
    s_mul_i32 s79, s62, 301056
    s_add_u32 s78, s78, s79
    s_add_u32 s78, s78, 896
    s_lshl_b32 s75, s74, 10
    s_add_u32 m0, s75, s76
    s_mul_i32 s75, s74, 43008
    s_add_u32 s75, s75, s78
    buffer_load_dwordx4 v12, s[28:31], s75 offen lds
    s_add_u32 s74, s74, 1
    s_cmp_eq_u32 s74, 7
    s_cselect_b32 s74, 0, s74
    s_lshl_b32 s75, s74, 10
    s_add_u32 m0, s75, s76
    s_mul_i32 s75, s74, 43008
    s_add_u32 s75, s75, s78
    buffer_load_dwordx4 v12, s[28:31], s75 offen lds
    s_add_u32 s74, s74, 1
    s_cmp_eq_u32 s74, 7
    s_cselect_b32 s74, 0, s74
    s_lshl_b32 s75, s74, 10
    s_add_u32 m0, s75, s76
    s_mul_i32 s75, s74, 43008
    s_add_u32 s75, s75, s78
    buffer_load_dwordx4 v12, s[28:31], s75 offen lds
    s_add_u32 s74, s74, 1
    s_cmp_eq_u32 s74, 7
    s_cselect_b32 s74, 0, s74
    s_lshl_b32 s75, s74, 10
    s_add_u32 m0, s75, s76
    s_mul_i32 s75, s74, 43008
    s_add_u32 s75, s75, s78
    buffer_load_dwordx4 v12, s[28:31], s75 offen lds
    s_add_u32 s74, s74, 1
    s_cmp_eq_u32 s74, 7
    s_cselect_b32 s74, 0, s74
    s_lshl_b32 s75, s74, 10
    s_add_u32 m0, s75, s76
    s_mul_i32 s75, s74, 43008
    s_add_u32 s75, s75, s78
    buffer_load_dwordx4 v12, s[28:31], s75 offen lds
    s_add_u32 s74, s74, 1
    s_cmp_eq_u32 s74, 7
    s_cselect_b32 s74, 0, s74
    s_lshl_b32 s75, s74, 10
    s_add_u32 m0, s75, s76
    s_mul_i32 s75, s74, 43008
    s_add_u32 s75, s75, s78
    buffer_load_dwordx4 v12, s[28:31], s75 offen lds
    s_add_u32 s74, s74, 1
    s_cmp_eq_u32 s74, 7
    s_cselect_b32 s74, 0, s74
    s_lshr_b32 s91, s61, 2
    s_lshl_b32 s91, s91, 3
    s_lshl_b32 s56, 1, s91
    s_lshl_b32 s58, s56, 7
    s_lshr_b32 s91, s60, 2
    s_lshl_b32 s91, s91, 3
    s_lshl_b32 s57, 1, s91
    s_lshl_b32 s59, s57, 7
    s_mov_b32 s32, s8
    s_and_b32 s33, s9, 0xffff
    s_mov_b32 s34, 25088
    s_mov_b32 s35, 0x20000
    s_mov_b32 s36, s10
    s_and_b32 s37, s11, 0xffff
    s_mov_b32 s38, 401408
    s_mov_b32 s39, 0x20000
    s_mov_b32 s40, s14
    s_and_b32 s41, s15, 0xffff
    s_mov_b32 s42, 1204224
    s_mov_b32 s43, 0x20000
    s_mov_b32 s44, s16
    s_and_b32 s45, s17, 0xffff
    s_mov_b32 s46, 401408
    s_mov_b32 s47, 0x20000
    s_mov_b32 s48, s18
    s_and_b32 s49, s19, 0xffff
    s_mov_b32 s50, 1835008
    s_mov_b32 s51, 0x20000
    s_lshl_b32 s91, s89, 7
    s_add_u32 s64, s22, s91
    s_addc_u32 s65, s23, 0
    s_lshl_b32 s91, s90, 7
    s_add_u32 s91, s91, 8192
    s_add_u32 s66, s22, s91
    s_addc_u32 s67, s23, 0
    v_and_b32 v80, 31, v0
    v_lshrrev_b32 v81, 5, v0
    v_lshrrev_b32 v83, 3, v80
    v_and_b32 v84, 3, v80
    v_lshl_add_u32 v83, v83, 2, v84
    v_bfe_u32 v84, v80, 2, 1
    v_mad_u32_u24 v84, v84, 14, v83
    s_add_u32 s91, s73, 4096
    v_lshl_add_u32 v84, v84, 1, s91
    v_mul_u32_u24 v85, 224, v81
    v_add_u32 v100, v84, v85
    v_cmp_lt_u32 s[16:17], 13, v83
    s_lshl_b32 s91, s89, 5
    v_add_u32 v82, s91, v80
    v_mul_u32_u24 v82, 896, v82
    v_lshl_add_u32 v14, v81, 3, v82
    v_add_u32 v14, s92, v14
    v_and_b32 v83, 15, v0
    v_lshrrev_b32 v84, 2, v83
    v_lshlrev_b32 v84, 6, v84
    v_and_b32 v83, 3, v83
    v_lshl_add_u32 v84, v83, 3, v84
    v_bfe_u32 v83, v0, 4, 1
    v_lshl_add_u32 v84, v83, 5, v84
    v_lshl_add_u32 v3, v81, 9, v84
    v_add_u32 v4, 57344, v3
    v_add_u32 v2, 57344, v1
    v_lshlrev_b32 v83, 3, v80
    v_lshl_add_u32 v5, v81, 12, v83
    v_lshlrev_b32 v83, 4, v80
    v_lshl_add_u32 v10, v81, 11, v83
    v_lshl_add_u32 v11, v81, 12, v83
    v_add_u32 v102, 114688, v1
    s_lshl_b32 s91, s62, 13
    s_add_u32 s91, s91, 114688
    v_and_b32 v83, 7, v80
    v_bfe_u32 v84, v80, 2, 2
    v_lshl_add_u32 v83, v83, 2, v84
    v_xor_b32 v83, v83, v81
    v_lshlrev_b32 v83, 3, v83
    v_lshl_add_u32 v83, v80, 8, v83
    v_add_u32 v8, s91, v83
    v_and_b32 v82, 15, v0
    v_lshrrev_b32 v84, 4, v0
    v_lshrrev_b32 v83, 2, v82
    v_lshl_add_u32 v83, v84, 2, v83
    v_and_b32 v85, 7, v83
    v_lshl_add_u32 v85, v85, 2, v84
    v_and_b32 v98, 3, v82
    v_xor_b32 v85, v85, v98
    v_lshlrev_b32 v85, 3, v85
    v_lshl_add_u32 v83, v83, 8, v85
    v_add_u32 v83, 114688, v83
    s_lshl_b32 s91, s62, 5
    v_xor_b32 v9, s91, v83
    v_xor_b32 v13, 128, v83
    v_xor_b32 v7, 160, v83
    v_and_b32 v83, 1, v84
    v_lshlrev_b32 v83, 9, v83
    v_lshrrev_b32 v84, 1, v84
    v_lshl_add_u32 v83, v84, 3, v83
    v_lshl_add_u32 v83, v82, 4, v83
    s_lshl_b32 s91, s62, 10
    s_add_u32 s91, s91, 147456
    v_add_u32 v103, s91, v83
    v_bfe_u32 v82, v80, 1, 2
    v_lshrrev_b32 v83, 4, v80
    v_lshl_add_u32 v82, v83, 2, v82
    v_xor_b32 v82, v82, v81
    v_lshlrev_b32 v84, 7, v80
    v_add_u32 v84, s73, v84
    v_mul_u32_u24 v83, 26624, v83
    v_sub_u32 v83, 24576, v83
    v_xor_b32 v6, v82, v81
    v_lshl_add_u32 v85, v81, 3, s92
    v_add_u32 v85, 0, v85
    v_lshrrev_b32 v101, 7, v85
    v_bfe_u32 v98, v85, 4, 3
    v_xor_b32 v98, v98, v6
    v_lshl_add_u32 v98, v98, 4, v84
    v_and_b32 v85, 8, v85
    v_add_u32 v98, v98, v85
    v_lshl_add_u32 v104, v101, 12, v98
    v_add_u32 v98, v98, v83
    v_cmp_eq_u32 s[98:99], 6, v101
    s_nop 1
    v_cndmask_b32 v108, 0, v98, s[98:99]
    v_cmp_gt_u32 s[98:99], 6, v101
    s_nop 1
    v_cndmask_b32 v104, 0, v104, s[98:99]
    v_lshl_add_u32 v85, v81, 3, s92
    v_add_u32 v85, 16, v85
    v_lshrrev_b32 v101, 7, v85
    v_bfe_u32 v98, v85, 4, 3
    v_xor_b32 v98, v98, v6
    v_lshl_add_u32 v98, v98, 4, v84
    v_and_b32 v85, 8, v85
    v_add_u32 v98, v98, v85
    v_lshl_add_u32 v105, v101, 12, v98
    v_add_u32 v98, v98, v83
    v_cmp_eq_u32 s[98:99], 6, v101
    s_nop 1
    v_cndmask_b32 v109, 0, v98, s[98:99]
    v_cmp_gt_u32 s[98:99], 6, v101
    s_nop 1
    v_cndmask_b32 v105, 0, v105, s[98:99]
    v_lshl_add_u32 v85, v81, 3, s92
    v_add_u32 v85, 32, v85
    v_lshrrev_b32 v101, 7, v85
    v_bfe_u32 v98, v85, 4, 3
    v_xor_b32 v98, v98, v6
    v_lshl_add_u32 v98, v98, 4, v84
    v_and_b32 v85, 8, v85
    v_add_u32 v98, v98, v85
    v_lshl_add_u32 v106, v101, 12, v98
    v_add_u32 v98, v98, v83
    v_cmp_eq_u32 s[98:99], 6, v101
    s_nop 1
    v_cndmask_b32 v110, 0, v98, s[98:99]
    v_cmp_gt_u32 s[98:99], 6, v101
    s_nop 1
    v_cndmask_b32 v106, 0, v106, s[98:99]
    v_lshl_add_u32 v85, v81, 3, s92
    v_add_u32 v85, 48, v85
    v_lshrrev_b32 v101, 7, v85
    v_bfe_u32 v98, v85, 4, 3
    v_xor_b32 v98, v98, v6
    v_lshl_add_u32 v98, v98, 4, v84
    v_and_b32 v85, 8, v85
    v_add_u32 v98, v98, v85
    v_lshl_add_u32 v107, v101, 12, v98
    v_add_u32 v98, v98, v83
    v_cmp_eq_u32 s[98:99], 6, v101
    s_nop 1
    v_cndmask_b32 v111, 0, v98, s[98:99]
    v_cmp_gt_u32 s[98:99], 6, v101
    s_nop 1
    v_cndmask_b32 v107, 0, v107, s[98:99]
    v_xor_b32 v85, 0, v82
    v_lshl_add_u32 v90, v85, 4, v84
    v_add_u32 v94, v90, v83
    v_xor_b32 v85, 2, v82
    v_lshl_add_u32 v91, v85, 4, v84
    v_add_u32 v95, v91, v83
    v_xor_b32 v85, 4, v82
    v_lshl_add_u32 v92, v85, 4, v84
    v_add_u32 v96, v92, v83
    v_xor_b32 v85, 6, v82
    v_lshl_add_u32 v93, v85, 4, v84
    v_add_u32 v97, v93, v83
    s_add_u32 s10, s60, 16
    s_sub_u32 s11, s60, 5
    v_mov_b32 v99, 0x40000000
    v_lshrrev_b32 v6, 5, v0
    v_bfe_u32 v101, v0, 4, 1
    v_bfe_u32 v82, v0, 2, 2
    v_and_b32 v83, 3, v0
    s_mul_i32 s90, s61, 56
    v_lshl_add_u32 v83, v83, 4, s90
    s_mul_i32 s91, s60, 37
    s_lshr_b32 s91, s91, 8
    s_mul_i32 s90, s91, 7
    s_sub_u32 s15, s60, s90
    s_add_u32 s92, s91, 1
    s_cmp_eq_u32 s91, 2
    s_cselect_b32 s92, 0, s92
    s_mul_i32 s4, s92, 896
    s_mul_i32 s91, s91, 21504
    s_lshl_b32 s90, s60, 10
    s_add_u32 s90, s90, s91
    s_add_u32 s7, s90, s3
    s_mul_i32 s90, s15, 7
    s_mov_b32 s91, 1
    s_mov_b32 s92, 2
    s_mul_i32 s18, s15, 14
    s_sub_u32 s18, s18, 52
    s_cmp_ge_u32 s15, 4
    s_cselect_b32 s90, s18, s90
    s_cselect_b32 s91, 7, s91
    s_cmp_ge_u32 s15, 6
    s_cselect_b32 s90, 5, s90
    s_cselect_b32 s91, 14, s91
    s_cselect_b32 s92, 7, s92
    s_mul_i32 s18, s95, 28
    s_add_u32 s90, s90, s18
    v_mul_u32_u24 v84, s91, v6
    v_mad_u32_u24 v84, v101, s92, v84
    v_add_u32 v84, s90, v84
    v_lshl_add_u32 v84, v84, 2, v82
    v_mul_u32_u24 v84, 2688, v84
    v_add_u32 v248, v84, v83
    s_mul_i32 s91, s10, 37
    s_lshr_b32 s91, s91, 8
    s_mul_i32 s90, s91, 7
    s_sub_u32 s15, s10, s90
    s_add_u32 s92, s91, 1
    s_cmp_eq_u32 s91, 2
    s_cselect_b32 s92, 0, s92
    s_mul_i32 s5, s92, 896
    s_mul_i32 s91, s91, 21504
    s_lshl_b32 s90, s10, 10
    s_add_u32 s90, s90, s91
    s_add_u32 s8, s90, s3
    s_mul_i32 s90, s15, 7
    s_mov_b32 s91, 1
    s_mov_b32 s92, 2
    s_mul_i32 s18, s15, 14
    s_sub_u32 s18, s18, 52
    s_cmp_ge_u32 s15, 4
    s_cselect_b32 s90, s18, s90
    s_cselect_b32 s91, 7, s91
    s_cmp_ge_u32 s15, 6
    s_cselect_b32 s90, 5, s90
    s_cselect_b32 s91, 14, s91
    s_cselect_b32 s92, 7, s92
    s_mul_i32 s18, s95, 28
    s_add_u32 s90, s90, s18
    v_mul_u32_u24 v84, s91, v6
    v_mad_u32_u24 v84, v101, s92, v84
    v_add_u32 v84, s90, v84
    v_lshl_add_u32 v84, v84, 2, v82
    v_mul_u32_u24 v84, 2688, v84
    v_add_u32 v249, v84, v83
    s_cmp_lt_u32 s10, 21
    s_cselect_b64 s[98:99], -1, 0
    s_cselect_b32 s8, s8, 0
    s_cselect_b32 s5, s5, 0
    v_cndmask_b32 v249, v99, v249, s[98:99]
    v_cndmask_b32 v253, v99, v1, s[98:99]
    s_and_b32 s15, s11, 7
    s_lshl_b32 s90, s15, 10
    s_add_u32 s90, s90, 86016
    s_add_u32 s9, s90, s3
    s_mul_i32 s90, s15, 7
    s_mov_b32 s91, 1
    s_mov_b32 s92, 2
    s_mul_i32 s18, s15, 14
    s_sub_u32 s18, s18, 52
    s_cmp_ge_u32 s15, 4
    s_cselect_b32 s90, s18, s90
    s_cselect_b32 s91, 7, s91
    s_cmp_ge_u32 s15, 6
    s_cselect_b32 s90, 5, s90
    s_cselect_b32 s91, 14, s91
    s_cselect_b32 s92, 7, s92
    s_mul_i32 s18, s95, 28
    s_add_u32 s90, s90, s18
    v_mul_u32_u24 v84, s91, v6
    v_mad_u32_u24 v84, v101, s92, v84
    v_add_u32 v84, s90, v84
    v_lshl_add_u32 v84, v84, 2, v82
    v_mul_u32_u24 v84, 896, v84
    s_waitcnt vmcnt(32)
    v_add_u32 v250, v84, v83
    s_cmp_lt_u32 s11, 7
    s_cselect_b64 s[98:99], -1, 0
    s_cselect_b32 s9, s9, 0
    v_cndmask_b32 v250, v99, v250, s[98:99]
    v_cndmask_b32 v255, v99, v1, s[98:99]
    s_mov_b32 s6, 0
    s_add_u32 s12, s7, 1835008
    s_add_u32 s13, s8, 1835008
    s_add_u32 s14, s9, 1835008
    s_mul_i32 s15, s62, 6144
    s_add_u32 s15, s15, 86016
    v_add_u32 v252, s15, v3
    v_mov_b32 v123, 0
    v_mov_b32 v87, 0
    s_mov_b64 vcc, 0
    s_branch L_page_base
.p2align 12
L_page_base:
    s_waitcnt vmcnt(5)
    s_or_b32 s90, s2, s62
    s_cmp_lg_u32 s90, 0
    s_cbranch_scc1 L_noflag
    s_atomic_add s88, s[20:21], 0
L_noflag:
    s_mov_b32 s89, 0x3f803f80
    ds_read_b128 v[128:131], v90 offset:0
    ds_read_b128 v[132:135], v91 offset:0
    ds_read_b128 v[136:139], v92 offset:0
    ds_read_b128 v[140:143], v93 offset:0
    ds_read_b64 v[112:113], v104
    ds_read_b64 v[114:115], v105
    ds_read_b64 v[116:117], v106
    ds_read_b64 v[118:119], v107
    ds_read_b128 v[144:147], v90 offset:4096
    ds_read_b128 v[148:151], v91 offset:4096
    ds_read_b128 v[152:155], v92 offset:4096
    ds_read_b128 v[156:159], v93 offset:4096
    ds_read_b128 v[160:163], v90 offset:8192
    ds_read_b128 v[164:167], v91 offset:8192
    ds_read_b128 v[168:171], v92 offset:8192
    ds_read_b128 v[172:175], v93 offset:8192
    s_waitcnt lgkmcnt(4)
    s_add_u32 m0, s73, 0
    s_add_u32 s90, s72, 15104
    buffer_load_dwordx4 v89, s[24:27], s90 offen lds
    s_add_u32 m0, s73, 1024
    s_add_u32 s90, s72, 22272
    buffer_load_dwordx4 v89, s[24:27], s90 offen lds
    s_add_u32 m0, s73, 4096
    s_mul_i32 s90, s61, 1568
    buffer_load_dwordx4 v1, s[32:35], s90 offen lds
    buffer_load_dwordx4 v1, s[32:35], s90 offen offset:1024 lds
    v_dot2_f32_bf16 v32, v128, v128, 0
    v_dot2_f32_bf16 v34, v128, s89, 0
    v_dot2_f32_bf16 v33, v129, v129, 0
    v_dot2_f32_bf16 v35, v129, s89, 0
    v_dot2_f32_bf16 v32, v130, v130, v32
    v_dot2_f32_bf16 v34, v130, s89, v34
    v_dot2_f32_bf16 v33, v131, v131, v33
    v_dot2_f32_bf16 v35, v131, s89, v35
    v_dot2_f32_bf16 v32, v132, v132, v32
    v_dot2_f32_bf16 v34, v132, s89, v34
    v_dot2_f32_bf16 v33, v133, v133, v33
    v_dot2_f32_bf16 v35, v133, s89, v35
    v_dot2_f32_bf16 v32, v134, v134, v32
    v_dot2_f32_bf16 v34, v134, s89, v34
    v_dot2_f32_bf16 v33, v135, v135, v33
    v_dot2_f32_bf16 v35, v135, s89, v35
    s_lshl_b32 s75, s74, 10
    s_add_u32 m0, s75, s76
    s_mul_i32 s75, s74, 43008
    s_add_u32 s75, s75, s78
    buffer_load_dwordx4 v12, s[28:31], s75 offen lds
    s_add_u32 s74, s74, 1
    s_cmp_eq_u32 s74, 7
    s_cselect_b32 s74, 0, s74
    v_dot2_f32_bf16 v32, v136, v136, v32
    v_dot2_f32_bf16 v34, v136, s89, v34
    v_dot2_f32_bf16 v33, v137, v137, v33
    v_dot2_f32_bf16 v35, v137, s89, v35
    v_dot2_f32_bf16 v32, v138, v138, v32
    v_dot2_f32_bf16 v34, v138, s89, v34
    v_dot2_f32_bf16 v33, v139, v139, v33
    v_dot2_f32_bf16 v35, v139, s89, v35
    v_dot2_f32_bf16 v32, v140, v140, v32
    v_dot2_f32_bf16 v34, v140, s89, v34
    v_dot2_f32_bf16 v33, v141, v141, v33
    v_dot2_f32_bf16 v35, v141, s89, v35
    v_dot2_f32_bf16 v32, v142, v142, v32
    v_dot2_f32_bf16 v34, v142, s89, v34
    v_dot2_f32_bf16 v33, v143, v143, v33
    v_dot2_f32_bf16 v35, v143, s89, v35
    s_xor_b32 s78, s77, 1
    s_mul_i32 s76, s78, 28672
    s_add_u32 s76, s76, s100
    s_mul_i32 s78, s78, 896
    s_mul_i32 s79, s62, 301056
    s_add_u32 s78, s78, s79
    s_add_u32 s78, s78, 896
    s_lshl_b32 s75, s74, 10
    s_add_u32 m0, s75, s76
    s_mul_i32 s75, s74, 43008
    s_add_u32 s75, s75, s78
    buffer_load_dwordx4 v12, s[28:31], s75 offen lds
    s_add_u32 s74, s74, 1
    s_cmp_eq_u32 s74, 7
    s_cselect_b32 s74, 0, s74
    ds_read_b128 v[176:179], v90 offset:12288
    ds_read_b128 v[180:183], v91 offset:12288
    ds_read_b128 v[184:187], v92 offset:12288
    ds_read_b128 v[188:191], v93 offset:12288
    v_dot2_f32_bf16 v32, v144, v144, v32
    v_dot2_f32_bf16 v34, v144, s89, v34
    v_dot2_f32_bf16 v33, v145, v145, v33
    v_dot2_f32_bf16 v35, v145, s89, v35
    v_dot2_f32_bf16 v32, v146, v146, v32
    v_dot2_f32_bf16 v34, v146, s89, v34
    v_dot2_f32_bf16 v33, v147, v147, v33
    v_dot2_f32_bf16 v35, v147, s89, v35
    v_dot2_f32_bf16 v32, v148, v148, v32
    v_dot2_f32_bf16 v34, v148, s89, v34
    v_dot2_f32_bf16 v33, v149, v149, v33
    v_dot2_f32_bf16 v35, v149, s89, v35
    v_dot2_f32_bf16 v32, v150, v150, v32
    v_dot2_f32_bf16 v34, v150, s89, v34
    v_dot2_f32_bf16 v33, v151, v151, v33
    v_dot2_f32_bf16 v35, v151, s89, v35
    s_lshl_b32 s75, s74, 10
    s_add_u32 m0, s75, s76
    s_mul_i32 s75, s74, 43008
    s_add_u32 s75, s75, s78
    buffer_load_dwordx4 v12, s[28:31], s75 offen lds
    s_add_u32 s74, s74, 1
    s_cmp_eq_u32 s74, 7
    s_cselect_b32 s74, 0, s74
    v_dot2_f32_bf16 v32, v152, v152, v32
    v_dot2_f32_bf16 v34, v152, s89, v34
    v_dot2_f32_bf16 v33, v153, v153, v33
    v_dot2_f32_bf16 v35, v153, s89, v35
    v_dot2_f32_bf16 v32, v154, v154, v32
    v_dot2_f32_bf16 v34, v154, s89, v34
    v_dot2_f32_bf16 v33, v155, v155, v33
    v_dot2_f32_bf16 v35, v155, s89, v35
    v_dot2_f32_bf16 v32, v156, v156, v32
    v_dot2_f32_bf16 v34, v156, s89, v34
    v_dot2_f32_bf16 v33, v157, v157, v33
    v_dot2_f32_bf16 v35, v157, s89, v35
    v_dot2_f32_bf16 v32, v158, v158, v32
    v_dot2_f32_bf16 v34, v158, s89, v34
    v_dot2_f32_bf16 v33, v159, v159, v33
    v_dot2_f32_bf16 v35, v159, s89, v35
    s_lshl_b32 s75, s74, 10
    s_add_u32 m0, s75, s76
    s_mul_i32 s75, s74, 43008
    s_add_u32 s75, s75, s78
    buffer_load_dwordx4 v12, s[28:31], s75 offen lds
    s_add_u32 s74, s74, 1
    s_cmp_eq_u32 s74, 7
    s_cselect_b32 s74, 0, s74
    ds_read_b128 v[192:195], v90 offset:16384
    ds_read_b128 v[196:199], v91 offset:16384
    ds_read_b128 v[200:203], v92 offset:16384
    ds_read_b128 v[204:207], v93 offset:16384
    s_waitcnt lgkmcnt(11)
    v_dot2_f32_bf16 v32, v160, v160, v32
    v_dot2_f32_bf16 v34, v160, s89, v34
    v_dot2_f32_bf16 v33, v161, v161, v33
    v_dot2_f32_bf16 v35, v161, s89, v35
    v_dot2_f32_bf16 v32, v162, v162, v32
    v_dot2_f32_bf16 v34, v162, s89, v34
    v_dot2_f32_bf16 v33, v163, v163, v33
    v_dot2_f32_bf16 v35, v163, s89, v35
    s_waitcnt lgkmcnt(10)
    v_dot2_f32_bf16 v32, v164, v164, v32
    v_dot2_f32_bf16 v34, v164, s89, v34
    v_dot2_f32_bf16 v33, v165, v165, v33
    v_dot2_f32_bf16 v35, v165, s89, v35
    v_dot2_f32_bf16 v32, v166, v166, v32
    v_dot2_f32_bf16 v34, v166, s89, v34
    v_dot2_f32_bf16 v33, v167, v167, v33
    v_dot2_f32_bf16 v35, v167, s89, v35
    s_lshl_b32 s75, s74, 10
    s_add_u32 m0, s75, s76
    s_mul_i32 s75, s74, 43008
    s_add_u32 s75, s75, s78
    buffer_load_dwordx4 v12, s[28:31], s75 offen lds
    s_add_u32 s74, s74, 1
    s_cmp_eq_u32 s74, 7
    s_cselect_b32 s74, 0, s74
    s_waitcnt lgkmcnt(9)
    v_dot2_f32_bf16 v32, v168, v168, v32
    v_dot2_f32_bf16 v34, v168, s89, v34
    v_dot2_f32_bf16 v33, v169, v169, v33
    v_dot2_f32_bf16 v35, v169, s89, v35
    v_dot2_f32_bf16 v32, v170, v170, v32
    v_dot2_f32_bf16 v34, v170, s89, v34
    v_dot2_f32_bf16 v33, v171, v171, v33
    v_dot2_f32_bf16 v35, v171, s89, v35
    s_waitcnt lgkmcnt(8)
    v_dot2_f32_bf16 v32, v172, v172, v32
    v_dot2_f32_bf16 v34, v172, s89, v34
    v_dot2_f32_bf16 v33, v173, v173, v33
    v_dot2_f32_bf16 v35, v173, s89, v35
    v_dot2_f32_bf16 v32, v174, v174, v32
    v_dot2_f32_bf16 v34, v174, s89, v34
    v_dot2_f32_bf16 v33, v175, v175, v33
    v_dot2_f32_bf16 v35, v175, s89, v35
    s_lshl_b32 s75, s74, 10
    s_add_u32 m0, s75, s76
    s_mul_i32 s75, s74, 43008
    s_add_u32 s75, s75, s78
    buffer_load_dwordx4 v12, s[28:31], s75 offen lds
    s_add_u32 s74, s74, 1
    s_cmp_eq_u32 s74, 7
    s_cselect_b32 s74, 0, s74
    ds_read_b128 v[208:211], v90 offset:20480
    ds_read_b128 v[212:215], v91 offset:20480
    ds_read_b128 v[216:219], v92 offset:20480
    ds_read_b128 v[220:223], v93 offset:20480
    s_waitcnt lgkmcnt(11)
    v_dot2_f32_bf16 v32, v176, v176, v32
    v_dot2_f32_bf16 v34, v176, s89, v34
    v_dot2_f32_bf16 v33, v177, v177, v33
    v_dot2_f32_bf16 v35, v177, s89, v35
    v_dot2_f32_bf16 v32, v178, v178, v32
    v_dot2_f32_bf16 v34, v178, s89, v34
    v_dot2_f32_bf16 v33, v179, v179, v33
    v_dot2_f32_bf16 v35, v179, s89, v35
    s_waitcnt lgkmcnt(10)
    v_dot2_f32_bf16 v32, v180, v180, v32
    v_dot2_f32_bf16 v34, v180, s89, v34
    v_dot2_f32_bf16 v33, v181, v181, v33
    v_dot2_f32_bf16 v35, v181, s89, v35
    v_dot2_f32_bf16 v32, v182, v182, v32
    v_dot2_f32_bf16 v34, v182, s89, v34
    v_dot2_f32_bf16 v33, v183, v183, v33
    v_dot2_f32_bf16 v35, v183, s89, v35
    s_lshl_b32 s75, s74, 10
    s_add_u32 m0, s75, s76
    s_mul_i32 s75, s74, 43008
    s_add_u32 s75, s75, s78
    buffer_load_dwordx4 v12, s[28:31], s75 offen lds
    s_add_u32 s74, s74, 1
    s_cmp_eq_u32 s74, 7
    s_cselect_b32 s74, 0, s74
    s_waitcnt lgkmcnt(9)
    v_dot2_f32_bf16 v32, v184, v184, v32
    v_dot2_f32_bf16 v34, v184, s89, v34
    v_dot2_f32_bf16 v33, v185, v185, v33
    v_dot2_f32_bf16 v35, v185, s89, v35
    v_dot2_f32_bf16 v32, v186, v186, v32
    v_dot2_f32_bf16 v34, v186, s89, v34
    v_dot2_f32_bf16 v33, v187, v187, v33
    v_dot2_f32_bf16 v35, v187, s89, v35
    s_waitcnt lgkmcnt(8)
    v_dot2_f32_bf16 v32, v188, v188, v32
    v_dot2_f32_bf16 v34, v188, s89, v34
    v_dot2_f32_bf16 v33, v189, v189, v33
    v_dot2_f32_bf16 v35, v189, s89, v35
    v_dot2_f32_bf16 v32, v190, v190, v32
    v_dot2_f32_bf16 v34, v190, s89, v34
    v_dot2_f32_bf16 v33, v191, v191, v33
    v_dot2_f32_bf16 v35, v191, s89, v35
    s_lshl_b32 s75, s74, 10
    s_add_u32 m0, s75, s76
    s_mul_i32 s75, s74, 43008
    s_add_u32 s75, s75, s78
    buffer_load_dwordx4 v12, s[28:31], s75 offen lds
    s_add_u32 s74, s74, 1
    s_cmp_eq_u32 s74, 7
    s_cselect_b32 s74, 0, s74
    s_waitcnt lgkmcnt(7)
    v_dot2_f32_bf16 v32, v192, v192, v32
    v_dot2_f32_bf16 v34, v192, s89, v34
    v_dot2_f32_bf16 v33, v193, v193, v33
    v_dot2_f32_bf16 v35, v193, s89, v35
    v_dot2_f32_bf16 v32, v194, v194, v32
    v_dot2_f32_bf16 v34, v194, s89, v34
    v_dot2_f32_bf16 v33, v195, v195, v33
    v_dot2_f32_bf16 v35, v195, s89, v35
    s_waitcnt lgkmcnt(6)
    v_dot2_f32_bf16 v32, v196, v196, v32
    v_dot2_f32_bf16 v34, v196, s89, v34
    v_dot2_f32_bf16 v33, v197, v197, v33
    v_dot2_f32_bf16 v35, v197, s89, v35
    v_dot2_f32_bf16 v32, v198, v198, v32
    v_dot2_f32_bf16 v34, v198, s89, v34
    v_dot2_f32_bf16 v33, v199, v199, v33
    v_dot2_f32_bf16 v35, v199, s89, v35
    s_waitcnt lgkmcnt(5)
    v_dot2_f32_bf16 v32, v200, v200, v32
    v_dot2_f32_bf16 v34, v200, s89, v34
    v_dot2_f32_bf16 v33, v201, v201, v33
    v_dot2_f32_bf16 v35, v201, s89, v35
    v_dot2_f32_bf16 v32, v202, v202, v32
    v_dot2_f32_bf16 v34, v202, s89, v34
    v_dot2_f32_bf16 v33, v203, v203, v33
    v_dot2_f32_bf16 v35, v203, s89, v35
    s_waitcnt lgkmcnt(4)
    v_dot2_f32_bf16 v32, v204, v204, v32
    v_dot2_f32_bf16 v34, v204, s89, v34
    v_dot2_f32_bf16 v33, v205, v205, v33
    v_dot2_f32_bf16 v35, v205, s89, v35
    v_dot2_f32_bf16 v32, v206, v206, v32
    v_dot2_f32_bf16 v34, v206, s89, v34
    v_dot2_f32_bf16 v33, v207, v207, v33
    v_dot2_f32_bf16 v35, v207, s89, v35
    s_waitcnt lgkmcnt(3)
    v_dot2_f32_bf16 v32, v208, v208, v32
    v_dot2_f32_bf16 v34, v208, s89, v34
    v_dot2_f32_bf16 v33, v209, v209, v33
    v_dot2_f32_bf16 v35, v209, s89, v35
    v_dot2_f32_bf16 v32, v210, v210, v32
    v_dot2_f32_bf16 v34, v210, s89, v34
    v_dot2_f32_bf16 v33, v211, v211, v33
    v_dot2_f32_bf16 v35, v211, s89, v35
    s_waitcnt lgkmcnt(2)
    v_dot2_f32_bf16 v32, v212, v212, v32
    v_dot2_f32_bf16 v34, v212, s89, v34
    v_dot2_f32_bf16 v33, v213, v213, v33
    v_dot2_f32_bf16 v35, v213, s89, v35
    v_dot2_f32_bf16 v32, v214, v214, v32
    v_dot2_f32_bf16 v34, v214, s89, v34
    v_dot2_f32_bf16 v33, v215, v215, v33
    v_dot2_f32_bf16 v35, v215, s89, v35
    s_waitcnt lgkmcnt(1)
    v_dot2_f32_bf16 v32, v216, v216, v32
    v_dot2_f32_bf16 v34, v216, s89, v34
    v_dot2_f32_bf16 v33, v217, v217, v33
    v_dot2_f32_bf16 v35, v217, s89, v35
    v_dot2_f32_bf16 v32, v218, v218, v32
    v_dot2_f32_bf16 v34, v218, s89, v34
    v_dot2_f32_bf16 v33, v219, v219, v33
    v_dot2_f32_bf16 v35, v219, s89, v35
    s_waitcnt lgkmcnt(0)
    v_dot2_f32_bf16 v32, v220, v220, v32
    v_dot2_f32_bf16 v34, v220, s89, v34
    v_dot2_f32_bf16 v33, v221, v221, v33
    v_dot2_f32_bf16 v35, v221, s89, v35
    v_dot2_f32_bf16 v32, v222, v222, v32
    v_dot2_f32_bf16 v34, v222, s89, v34
    v_dot2_f32_bf16 v33, v223, v223, v33
    v_dot2_f32_bf16 v35, v223, s89, v35
    s_waitcnt vmcnt(8)
    ds_read_b128 v[224:227], v94
    ds_read_b128 v[228:231], v95
    ds_read_b128 v[232:235], v96
    ds_read_b128 v[236:239], v97
    ds_read_b64 v[64:65], v108
    ds_read_b64 v[66:67], v109
    ds_read_b64 v[68:69], v110
    ds_read_b64 v[70:71], v111
    s_waitcnt lgkmcnt(7)
    v_dot2_f32_bf16 v32, v224, v224, v32
    v_dot2_f32_bf16 v34, v224, s89, v34
    v_dot2_f32_bf16 v33, v225, v225, v33
    v_dot2_f32_bf16 v35, v225, s89, v35
    v_dot2_f32_bf16 v32, v226, v226, v32
    v_dot2_f32_bf16 v34, v226, s89, v34
    v_dot2_f32_bf16 v33, v227, v227, v33
    v_dot2_f32_bf16 v35, v227, s89, v35
    s_waitcnt lgkmcnt(6)
    v_dot2_f32_bf16 v32, v228, v228, v32
    v_dot2_f32_bf16 v34, v228, s89, v34
    v_dot2_f32_bf16 v33, v229, v229, v33
    v_dot2_f32_bf16 v35, v229, s89, v35
    v_dot2_f32_bf16 v32, v230, v230, v32
    v_dot2_f32_bf16 v34, v230, s89, v34
    v_dot2_f32_bf16 v33, v231, v231, v33
    v_dot2_f32_bf16 v35, v231, s89, v35
    s_waitcnt lgkmcnt(5)
    v_dot2_f32_bf16 v32, v232, v232, v32
    v_dot2_f32_bf16 v34, v232, s89, v34
    v_dot2_f32_bf16 v33, v233, v233, v33
    v_dot2_f32_bf16 v35, v233, s89, v35
    v_dot2_f32_bf16 v32, v234, v234, v32
    v_dot2_f32_bf16 v34, v234, s89, v34
    v_dot2_f32_bf16 v33, v235, v235, v33
    v_dot2_f32_bf16 v35, v235, s89, v35
    s_waitcnt lgkmcnt(4)
    v_dot2_f32_bf16 v32, v236, v236, v32
    v_dot2_f32_bf16 v34, v236, s89, v34
    v_dot2_f32_bf16 v33, v237, v237, v33
    v_dot2_f32_bf16 v35, v237, s89, v35
    v_dot2_f32_bf16 v32, v238, v238, v32
    v_dot2_f32_bf16 v34, v238, s89, v34
    v_dot2_f32_bf16 v33, v239, v239, v33
    v_dot2_f32_bf16 v35, v239, s89, v35
    s_nop 2
    v_add_f32 v120, v34, v35
    v_add_f32 v121, v32, v33
    v_mov_b32 v122, v120
    s_nop 1
    v_permlane32_swap_b32 v122, v120
    v_add_f32 v120, v120, v122
    v_mov_b32 v122, v121
    s_nop 1
    v_permlane32_swap_b32 v122, v121
    v_add_f32 v121, v121, v122
    v_mul_f32 v120, 0xbb124925, v120
    v_mul_f32 v121, 0x3b124925, v121
    v_fma_f32 v121, -v120, v120, v121
    v_max_f32 v121, 0, v121
    v_add_f32 v121, 0x3727c5ac, v121
    v_rsq_f32 v124, v121
    v_cndmask_b32 v120, v120, 0, s[80:81]
    v_cvt_pk_bf16_f32 v127, v120, 0
    v_lshlrev_b32 v122, 16, v127
    v_sub_f32 v122, v120, v122
    v_cvt_pk_bf16_f32 v126, v120, v122
    v_cmp_ne_u32 s[98:99], 0, v108
    s_waitcnt lgkmcnt(3)
    s_nop 0
    v_cndmask_b32 v112, v112, v64, s[98:99]
    v_lshlrev_b32 v16, 16, v112
    v_and_b32 v17, 0xffff0000, v112
    v_cndmask_b32 v113, v113, v65, s[98:99]
    v_lshlrev_b32 v18, 16, v113
    v_and_b32 v19, 0xffff0000, v113
    v_cmp_ne_u32 s[98:99], 0, v109
    s_waitcnt lgkmcnt(2)
    s_nop 0
    v_cndmask_b32 v114, v114, v66, s[98:99]
    v_lshlrev_b32 v20, 16, v114
    v_and_b32 v21, 0xffff0000, v114
    v_cndmask_b32 v115, v115, v67, s[98:99]
    v_lshlrev_b32 v22, 16, v115
    v_and_b32 v23, 0xffff0000, v115
    v_cmp_ne_u32 s[98:99], 0, v110
    s_waitcnt lgkmcnt(1)
    s_nop 0
    v_cndmask_b32 v116, v116, v68, s[98:99]
    v_lshlrev_b32 v24, 16, v116
    v_and_b32 v25, 0xffff0000, v116
    v_cndmask_b32 v117, v117, v69, s[98:99]
    v_lshlrev_b32 v26, 16, v117
    v_and_b32 v27, 0xffff0000, v117
    v_cmp_ne_u32 s[98:99], 0, v111
    s_waitcnt lgkmcnt(0)
    s_nop 0
    v_cndmask_b32 v118, v118, v70, s[98:99]
    v_lshlrev_b32 v28, 16, v118
    v_and_b32 v29, 0xffff0000, v118
    v_cndmask_b32 v119, v119, v71, s[98:99]
    v_lshlrev_b32 v30, 16, v119
    v_and_b32 v31, 0xffff0000, v119
    ds_read_u16 v104, v100 offset:0
    ds_read_u16 v105, v100 offset:56
    ds_read_u16 v106, v100 offset:112
    ds_read_u16 v107, v100 offset:168
    ds_read_u16 v108, v100 offset:448
    ds_read_u16 v109, v100 offset:504
    ds_read_u16 v110, v100 offset:560
    ds_read_u16 v111, v100 offset:616
    ds_read_u16 v112, v100 offset:896
    ds_read_u16 v113, v100 offset:952
    ds_read_u16 v114, v100 offset:1008
    ds_read_u16 v115, v100 offset:1064
    ds_read_u16 v116, v100 offset:1344
    ds_read_u16 v117, v100 offset:1400
    ds_read_u16 v118, v100 offset:1456
    ds_read_u16 v119, v100 offset:1512
    s_waitcnt lgkmcnt(14)
    v_lshl_or_b32 v104, v105, 16, v104
    v_cndmask_b32 v104, v104, 0, s[16:17]
    v_accvgpr_write_b32 a172, v104
    s_waitcnt lgkmcnt(12)
    v_lshl_or_b32 v106, v107, 16, v106
    v_cndmask_b32 v106, v106, 0, s[16:17]
    v_accvgpr_write_b32 a173, v106
    s_waitcnt lgkmcnt(10)
    v_lshl_or_b32 v108, v109, 16, v108
    v_cndmask_b32 v108, v108, 0, s[16:17]
    v_accvgpr_write_b32 a174, v108
    s_waitcnt lgkmcnt(8)
    v_lshl_or_b32 v110, v111, 16, v110
    v_cndmask_b32 v110, v110, 0, s[16:17]
    v_accvgpr_write_b32 a175, v110
    s_waitcnt lgkmcnt(6)
    v_lshl_or_b32 v112, v113, 16, v112
    v_cndmask_b32 v112, v112, 0, s[16:17]
    v_accvgpr_write_b32 a176, v112
    s_waitcnt lgkmcnt(4)
    v_lshl_or_b32 v114, v115, 16, v114
    v_cndmask_b32 v114, v114, 0, s[16:17]
    v_accvgpr_write_b32 a177, v114
    s_waitcnt lgkmcnt(2)
    v_lshl_or_b32 v116, v117, 16, v116
    v_cndmask_b32 v116, v116, 0, s[16:17]
    v_cndmask_b32 v116, v116, 0, s[80:81]
    v_accvgpr_write_b32 a178, v116
    s_waitcnt lgkmcnt(0)
    v_lshl_or_b32 v118, v119, 16, v118
    v_cndmask_b32 v118, v118, 0, s[16:17]
    v_cndmask_b32 v118, v118, 0, s[80:81]
    v_accvgpr_write_b32 a179, v118
    s_nop 2
    s_mov_b64 vcc, -1
    s_cmp_eq_u32 s62, 0
    s_cbranch_scc1 L_page_0
    s_cmp_eq_u32 s62, 1
    s_cbranch_scc1 L_page_1
    s_cmp_eq_u32 s62, 2
    s_cbranch_scc1 L_page_2
    s_branch L_page_3
L_page_ret0:
    s_mov_b64 vcc, 0
    s_waitcnt vmcnt(0)
    s_barrier
    v_mov_b32 v87, 0
    s_add_u32 m0, s15, 0
    s_nop 0
    buffer_load_dwordx4 v248, s[28:31], s4 offen lds
    s_add_u32 m0, s15, 1024
    s_nop 0
    buffer_load_dwordx4 v249, s[28:31], s5 offen lds
    s_add_u32 m0, s15, 2048
    s_nop 0
    buffer_load_dwordx4 v250, s[36:39], s6 offen lds
    s_add_u32 m0, s15, 3072
    s_nop 0
    buffer_load_dwordx4 v248, s[40:43], s4 offen lds
    s_add_u32 m0, s15, 4096
    s_nop 0
    buffer_load_dwordx4 v249, s[40:43], s5 offen lds
    s_add_u32 m0, s15, 5120
    s_nop 0
    buffer_load_dwordx4 v250, s[44:47], s6 offen lds
    global_load_dword v123, v87, s[20:21] sc1
    v_mov_b32 v80, 0
    v_mov_b32 v81, 0
    v_mov_b32 v82, 0
    v_mov_b32 v83, 0
    s_mov_b32 exec_lo, 0x00020001
    s_mov_b32 exec_hi, 0x00020001
    v_mov_b32 v80, 0x3f803f80
    v_mov_b32 v81, 0x3f803f80
    v_mov_b32 v82, 0x3f803f80
    v_mov_b32 v83, 0x3f803f80
    s_mov_b64 exec, -1
    v_add_u32 v84, s100, v3
    v_add_u32 v85, 57344, v84
    v_and_b32 v86, 31, v0
    s_mul_i32 s90, s62, 384
    s_add_u32 s90, s90, 159744
    v_lshl_add_u32 v86, v86, 2, s90
    ds_read_b64_tr_b16 a[0:1], v84 offset:0
    ds_read_b64_tr_b16 a[2:3], v84 offset:256
    ds_read_b64_tr_b16 a[4:5], v84 offset:28672
    ds_read_b64_tr_b16 a[6:7], v84 offset:28928
    ds_read_b64_tr_b16 a[8:9], v84 offset:1024
    ds_read_b64_tr_b16 a[10:11], v84 offset:1280
    ds_read_b64_tr_b16 a[12:13], v84 offset:29696
    ds_read_b64_tr_b16 a[14:15], v84 offset:29952
    ds_read_b64_tr_b16 a[16:17], v84 offset:2048
    ds_read_b64_tr_b16 a[18:19], v84 offset:2304
    s_waitcnt lgkmcnt(8)
    v_mfma_f32_16x16x32_bf16 v[32:35], v[80:83], a[0:3], 0
    ds_read_b64_tr_b16 a[20:21], v84 offset:30720
    ds_read_b64_tr_b16 a[22:23], v84 offset:30976
    s_waitcnt lgkmcnt(8)
    v_mfma_f32_16x16x32_bf16 v[48:51], v[80:83], a[4:7], 0
    ds_read_b64_tr_b16 a[24:25], v84 offset:3072
    ds_read_b64_tr_b16 a[26:27], v84 offset:3328
    s_waitcnt lgkmcnt(8)
    v_mfma_f32_16x16x32_bf16 v[32:35], v[80:83], a[8:11], v[32:35]
    ds_read_b64_tr_b16 a[28:29], v84 offset:31744
    ds_read_b64_tr_b16 a[30:31], v84 offset:32000
    s_waitcnt lgkmcnt(8)
    v_mfma_f32_16x16x32_bf16 v[48:51], v[80:83], a[12:15], v[48:51]
    ds_read_b64_tr_b16 a[0:1], v84 offset:4096
    ds_read_b64_tr_b16 a[2:3], v84 offset:4352
    s_waitcnt lgkmcnt(8)
    v_mfma_f32_16x16x32_bf16 v[32:35], v[80:83], a[16:19], v[32:35]
    ds_read_b64_tr_b16 a[4:5], v84 offset:32768
    ds_read_b64_tr_b16 a[6:7], v84 offset:33024
    s_waitcnt lgkmcnt(8)
    v_mfma_f32_16x16x32_bf16 v[48:51], v[80:83], a[20:23], v[48:51]
    ds_read_b64_tr_b16 a[8:9], v84 offset:5120
    ds_read_b64_tr_b16 a[10:11], v84 offset:5376
    s_waitcnt lgkmcnt(8)
    v_mfma_f32_16x16x32_bf16 v[32:35], v[80:83], a[24:27], v[32:35]
    ds_read_b64_tr_b16 a[12:13], v84 offset:33792
    ds_read_b64_tr_b16 a[14:15], v84 offset:34048
    s_waitcnt lgkmcnt(8)
    v_mfma_f32_16x16x32_bf16 v[48:51], v[80:83], a[28:31], v[48:51]
    ds_read_b64_tr_b16 a[16:17], v84 offset:6144
    ds_read_b64_tr_b16 a[18:19], v84 offset:6400
    s_waitcnt lgkmcnt(8)
    v_mfma_f32_16x16x32_bf16 v[32:35], v[80:83], a[0:3], v[32:35]
    ds_read_b64_tr_b16 a[20:21], v84 offset:34816
    ds_read_b64_tr_b16 a[22:23], v84 offset:35072
    s_waitcnt lgkmcnt(8)
    v_mfma_f32_16x16x32_bf16 v[48:51], v[80:83], a[4:7], v[48:51]
    s_waitcnt lgkmcnt(6)
    v_mfma_f32_16x16x32_bf16 v[32:35], v[80:83], a[8:11], v[32:35]
    s_waitcnt lgkmcnt(4)
    v_mfma_f32_16x16x32_bf16 v[48:51], v[80:83], a[12:15], v[48:51]
    s_waitcnt lgkmcnt(2)
    v_mfma_f32_16x16x32_bf16 v[32:35], v[80:83], a[16:19], v[32:35]
    s_waitcnt lgkmcnt(0)
    v_mfma_f32_16x16x32_bf16 v[48:51], v[80:83], a[20:23], v[48:51]
    s_mov_b64 exec, 0xffff
    s_nop 4
    ds_write2_b32 v86, v32, v33 offset0:0 offset1:16
    s_mov_b64 exec, -1
    s_mov_b64 exec, 0xffff
    ds_write2_b32 v86, v48, v49 offset0:32 offset1:48
    s_mov_b64 exec, -1
    ds_read_b64_tr_b16 a[128:129], v3 offset:0
    ds_read_b64_tr_b16 a[130:131], v3 offset:256
    ds_read_b64_tr_b16 a[132:133], v3 offset:28672
    ds_read_b64_tr_b16 a[134:135], v3 offset:28928
L_page_0:
    s_cbranch_vccnz L_page_ret0
    ds_read_b64_tr_b16 a[136:137], v3 offset:1024
    ds_read_b64_tr_b16 a[138:139], v3 offset:1280
    ds_read_b64_tr_b16 a[140:141], v3 offset:29696
    ds_read_b64_tr_b16 a[142:143], v3 offset:29952
    ds_read_b64_tr_b16 a[144:145], v3 offset:2048
    ds_read_b64_tr_b16 a[146:147], v3 offset:2304
    ds_read_b64_tr_b16 a[148:149], v3 offset:30720
    ds_read_b64_tr_b16 a[150:151], v3 offset:30976
    s_waitcnt lgkmcnt(8)
    v_mfma_f32_32x32x16_bf16 v[32:47], a[128:131], v[128:131], 0
    ds_read_b64_tr_b16 a[152:153], v3 offset:3072
    ds_read_b64_tr_b16 a[154:155], v3 offset:3328
    ds_read_b64_tr_b16 a[156:157], v3 offset:31744
    ds_read_b64_tr_b16 a[158:159], v3 offset:32000
    v_mfma_f32_32x32x16_bf16 v[48:63], a[132:135], v[128:131], 0
    s_waitcnt lgkmcnt(8)
    v_mfma_f32_32x32x16_bf16 v[32:47], a[136:139], v[132:135], v[32:47]
    ds_read_b64_tr_b16 a[128:129], v3 offset:4096
    ds_read_b64_tr_b16 a[130:131], v3 offset:4352
    ds_read_b64_tr_b16 a[132:133], v3 offset:32768
    ds_read_b64_tr_b16 a[134:135], v3 offset:33024
    s_add_u32 m0, s100, 57344
    s_mul_i32 s90, s62, 301056
    s_add_u32 s90, s90, 0
    buffer_load_dwordx4 v12, s[28:31], s90 offen lds
    v_mfma_f32_32x32x16_bf16 v[48:63], a[140:143], v[132:135], v[48:63]
    s_waitcnt lgkmcnt(0)
    s_barrier
    v_and_b32 v84, 31, v0
    v_mfma_f32_32x32x16_bf16 v[32:47], a[144:147], v[136:139], v[32:47]
    ds_read_b64_tr_b16 a[136:137], v3 offset:5120
    ds_read_b64_tr_b16 a[138:139], v3 offset:5376
    ds_read_b64_tr_b16 a[140:141], v3 offset:33792
    ds_read_b64_tr_b16 a[142:143], v3 offset:34048
    v_mfma_f32_32x32x16_bf16 v[48:63], a[148:151], v[136:139], v[48:63]
    v_lshlrev_b32 v84, 2, v84
    v_add_u32 v84, 159744, v84
    v_mfma_f32_32x32x16_bf16 v[32:47], a[152:155], v[140:143], v[32:47]
    ds_read_b64_tr_b16 a[144:145], v3 offset:6144
    ds_read_b64_tr_b16 a[146:147], v3 offset:6400
    ds_read_b64_tr_b16 a[148:149], v3 offset:34816
    ds_read_b64_tr_b16 a[150:151], v3 offset:35072
    v_mfma_f32_32x32x16_bf16 v[48:63], a[156:159], v[140:143], v[48:63]
    ds_read_b32 v88, v84 offset:0
    ds_read_b32 v89, v84 offset:384
    v_mfma_f32_32x32x16_bf16 v[32:47], a[128:131], v[144:147], v[32:47]
    ds_read_b64_tr_b16 a[152:153], v3 offset:7168
    ds_read_b64_tr_b16 a[154:155], v3 offset:7424
    ds_read_b64_tr_b16 a[156:157], v3 offset:35840
    ds_read_b64_tr_b16 a[158:159], v3 offset:36096
    s_add_u32 m0, s100, 58368
    s_mul_i32 s90, s62, 301056
    s_add_u32 s90, s90, 43008
    buffer_load_dwordx4 v12, s[28:31], s90 offen lds
    v_mfma_f32_32x32x16_bf16 v[48:63], a[132:135], v[144:147], v[48:63]
    ds_read_b32 v90, v84 offset:768
    ds_read_b32 v91, v84 offset:1152
    s_waitcnt lgkmcnt(12)
    v_mfma_f32_32x32x16_bf16 v[32:47], a[136:139], v[148:151], v[32:47]
    ds_read_b64_tr_b16 a[128:129], v3 offset:8192
    ds_read_b64_tr_b16 a[130:131], v3 offset:8448
    ds_read_b64_tr_b16 a[132:133], v3 offset:36864
    ds_read_b64_tr_b16 a[134:135], v3 offset:37120
    v_mfma_f32_32x32x16_bf16 v[48:63], a[140:143], v[148:151], v[48:63]
    ds_read_b32 v92, v84 offset:128
    ds_read_b32 v93, v84 offset:512
    s_waitcnt lgkmcnt(14)
    v_mfma_f32_32x32x16_bf16 v[32:47], a[144:147], v[152:155], v[32:47]
    ds_read_b64_tr_b16 a[136:137], v3 offset:9216
    ds_read_b64_tr_b16 a[138:139], v3 offset:9472
    ds_read_b64_tr_b16 a[140:141], v3 offset:37888
    ds_read_b64_tr_b16 a[142:143], v3 offset:38144
    v_mfma_f32_32x32x16_bf16 v[48:63], a[148:151], v[152:155], v[48:63]
    ds_read_b32 v94, v84 offset:896
    ds_read_b32 v95, v84 offset:1280
    s_waitcnt lgkmcnt(14)
    v_mfma_f32_32x32x16_bf16 v[32:47], a[152:155], v[156:159], v[32:47]
    ds_read_b64_tr_b16 a[144:145], v3 offset:10240
    ds_read_b64_tr_b16 a[146:147], v3 offset:10496
    ds_read_b64_tr_b16 a[148:149], v3 offset:38912
    ds_read_b64_tr_b16 a[150:151], v3 offset:39168
    s_add_u32 m0, s100, 59392
    s_mul_i32 s90, s62, 301056
    s_add_u32 s90, s90, 86016
    buffer_load_dwordx4 v12, s[28:31], s90 offen lds
    v_mfma_f32_32x32x16_bf16 v[48:63], a[156:159], v[156:159], v[48:63]
    v_add_f32 v88, v88, v89
    s_waitcnt lgkmcnt(15)
    v_add_f32 v90, v90, v91
    s_waitcnt lgkmcnt(12)
    v_mfma_f32_32x32x16_bf16 v[32:47], a[128:131], v[160:163], v[32:47]
    ds_read_b64_tr_b16 a[152:153], v3 offset:11264
    ds_read_b64_tr_b16 a[154:155], v3 offset:11520
    ds_read_b64_tr_b16 a[156:157], v3 offset:39936
    ds_read_b64_tr_b16 a[158:159], v3 offset:40192
    v_mfma_f32_32x32x16_bf16 v[48:63], a[132:135], v[160:163], v[48:63]
    v_add_f32 v88, v88, v90
    v_cvt_pk_bf16_f32 v89, v88, v88
    s_waitcnt lgkmcnt(10)
    v_mfma_f32_32x32x16_bf16 v[32:47], a[136:139], v[164:167], v[32:47]
    ds_read_b64_tr_b16 a[128:129], v3 offset:12288
    ds_read_b64_tr_b16 a[130:131], v3 offset:12544
    ds_read_b64_tr_b16 a[132:133], v3 offset:40960
    ds_read_b64_tr_b16 a[134:135], v3 offset:41216
    v_mfma_f32_32x32x16_bf16 v[48:63], a[140:143], v[164:167], v[48:63]
    v_and_b32 v90, 0xffff0000, v89
    v_sub_f32 v90, v88, v90
    s_waitcnt lgkmcnt(8)
    v_mfma_f32_32x32x16_bf16 v[32:47], a[144:147], v[168:171], v[32:47]
    ds_read_b64_tr_b16 a[136:137], v3 offset:13312
    ds_read_b64_tr_b16 a[138:139], v3 offset:13568
    ds_read_b64_tr_b16 a[140:141], v3 offset:41984
    ds_read_b64_tr_b16 a[142:143], v3 offset:42240
    s_add_u32 m0, s100, 60416
    s_mul_i32 s90, s62, 301056
    s_add_u32 s90, s90, 129024
    buffer_load_dwordx4 v12, s[28:31], s90 offen lds
    v_mfma_f32_32x32x16_bf16 v[48:63], a[148:151], v[168:171], v[48:63]
    v_cvt_pk_bf16_f32 v90, v90, 0
    v_accvgpr_write_b32 a160, v89
    s_waitcnt lgkmcnt(8)
    v_mfma_f32_32x32x16_bf16 v[32:47], a[152:155], v[172:175], v[32:47]
    ds_read_b64_tr_b16 a[144:145], v3 offset:14336
    ds_read_b64_tr_b16 a[146:147], v3 offset:14592
    ds_read_b64_tr_b16 a[148:149], v3 offset:43008
    ds_read_b64_tr_b16 a[150:151], v3 offset:43264
    v_mfma_f32_32x32x16_bf16 v[48:63], a[156:159], v[172:175], v[48:63]
    v_accvgpr_write_b32 a161, v90
    v_add_f32 v92, v92, v93
    s_waitcnt lgkmcnt(8)
    v_mfma_f32_32x32x16_bf16 v[32:47], a[128:131], v[176:179], v[32:47]
    ds_read_b64_tr_b16 a[152:153], v3 offset:15360
    ds_read_b64_tr_b16 a[154:155], v3 offset:15616
    ds_read_b64_tr_b16 a[156:157], v3 offset:44032
    ds_read_b64_tr_b16 a[158:159], v3 offset:44288
    v_mfma_f32_32x32x16_bf16 v[48:63], a[132:135], v[176:179], v[48:63]
    v_add_f32 v94, v94, v95
    v_add_f32 v92, v92, v94
    s_waitcnt lgkmcnt(8)
    v_mfma_f32_32x32x16_bf16 v[32:47], a[136:139], v[180:183], v[32:47]
    ds_read_b64_tr_b16 a[128:129], v3 offset:16384
    ds_read_b64_tr_b16 a[130:131], v3 offset:16640
    ds_read_b64_tr_b16 a[132:133], v3 offset:45056
    ds_read_b64_tr_b16 a[134:135], v3 offset:45312
    s_add_u32 m0, s100, 61440
    s_mul_i32 s90, s62, 301056
    s_add_u32 s90, s90, 172032
    buffer_load_dwordx4 v12, s[28:31], s90 offen lds
    v_mfma_f32_32x32x16_bf16 v[48:63], a[140:143], v[180:183], v[48:63]
    v_cvt_pk_bf16_f32 v93, v92, v92
    v_and_b32 v94, 0xffff0000, v93
    s_waitcnt lgkmcnt(8)
    v_mfma_f32_32x32x16_bf16 v[32:47], a[144:147], v[184:187], v[32:47]
    ds_read_b64_tr_b16 a[136:137], v3 offset:17408
    ds_read_b64_tr_b16 a[138:139], v3 offset:17664
    ds_read_b64_tr_b16 a[140:141], v3 offset:46080
    ds_read_b64_tr_b16 a[142:143], v3 offset:46336
    v_mfma_f32_32x32x16_bf16 v[48:63], a[148:151], v[184:187], v[48:63]
    v_sub_f32 v94, v92, v94
    v_cvt_pk_bf16_f32 v94, v94, 0
    s_waitcnt lgkmcnt(8)
    v_mfma_f32_32x32x16_bf16 v[32:47], a[152:155], v[188:191], v[32:47]
    ds_read_b64_tr_b16 a[144:145], v3 offset:18432
    ds_read_b64_tr_b16 a[146:147], v3 offset:18688
    ds_read_b64_tr_b16 a[148:149], v3 offset:47104
    ds_read_b64_tr_b16 a[150:151], v3 offset:47360
    v_mfma_f32_32x32x16_bf16 v[48:63], a[156:159], v[188:191], v[48:63]
    v_accvgpr_write_b32 a162, v93
    v_accvgpr_write_b32 a163, v94
    s_waitcnt lgkmcnt(8)
    v_mfma_f32_32x32x16_bf16 v[32:47], a[128:131], v[192:195], v[32:47]
    ds_read_b64_tr_b16 a[152:153], v3 offset:19456
    ds_read_b64_tr_b16 a[154:155], v3 offset:19712
    ds_read_b64_tr_b16 a[156:157], v3 offset:48128
    ds_read_b64_tr_b16 a[158:159], v3 offset:48384
    s_add_u32 m0, s100, 62464
    s_mul_i32 s90, s62, 301056
    s_add_u32 s90, s90, 215040
    buffer_load_dwordx4 v12, s[28:31], s90 offen lds
    v_mfma_f32_32x32x16_bf16 v[48:63], a[132:135], v[192:195], v[48:63]
    s_waitcnt lgkmcnt(8)
    v_mfma_f32_32x32x16_bf16 v[32:47], a[136:139], v[196:199], v[32:47]
    ds_read_b64_tr_b16 a[128:129], v3 offset:20480
    ds_read_b64_tr_b16 a[130:131], v3 offset:20736
    ds_read_b64_tr_b16 a[132:133], v3 offset:49152
    ds_read_b64_tr_b16 a[134:135], v3 offset:49408
    v_mfma_f32_32x32x16_bf16 v[48:63], a[140:143], v[196:199], v[48:63]
    s_waitcnt lgkmcnt(8)
    v_mfma_f32_32x32x16_bf16 v[32:47], a[144:147], v[200:203], v[32:47]
    ds_read_b64_tr_b16 a[136:137], v3 offset:21504
    ds_read_b64_tr_b16 a[138:139], v3 offset:21760
    ds_read_b64_tr_b16 a[140:141], v3 offset:50176
    ds_read_b64_tr_b16 a[142:143], v3 offset:50432
    v_mfma_f32_32x32x16_bf16 v[48:63], a[148:151], v[200:203], v[48:63]
    s_waitcnt lgkmcnt(8)
    v_mfma_f32_32x32x16_bf16 v[32:47], a[152:155], v[204:207], v[32:47]
    ds_read_b64_tr_b16 a[144:145], v3 offset:22528
    ds_read_b64_tr_b16 a[146:147], v3 offset:22784
    ds_read_b64_tr_b16 a[148:149], v3 offset:51200
    ds_read_b64_tr_b16 a[150:151], v3 offset:51456
    s_add_u32 m0, s100, 63488
    s_mul_i32 s90, s62, 301056
    s_add_u32 s90, s90, 258048
    buffer_load_dwordx4 v12, s[28:31], s90 offen lds
    v_mfma_f32_32x32x16_bf16 v[48:63], a[156:159], v[204:207], v[48:63]
    s_waitcnt lgkmcnt(8)
    v_mfma_f32_32x32x16_bf16 v[32:47], a[128:131], v[208:211], v[32:47]
    ds_read_b64_tr_b16 a[152:153], v3 offset:23552
    ds_read_b64_tr_b16 a[154:155], v3 offset:23808
    ds_read_b64_tr_b16 a[156:157], v3 offset:52224
    ds_read_b64_tr_b16 a[158:159], v3 offset:52480
    s_waitcnt vmcnt(7)
    ds_read_b64_tr_b16 v[64:65], v252 offset:0
    ds_read_b64_tr_b16 v[66:67], v252 offset:256
    ds_read_b64_tr_b16 v[68:69], v252 offset:1024
    ds_read_b64_tr_b16 v[70:71], v252 offset:1280
    v_mfma_f32_32x32x16_bf16 v[48:63], a[132:135], v[208:211], v[48:63]
    s_waitcnt lgkmcnt(12)
    v_mfma_f32_32x32x16_bf16 v[32:47], a[136:139], v[212:215], v[32:47]
    ds_read_b64_tr_b16 a[128:129], v3 offset:24576
    ds_read_b64_tr_b16 a[130:131], v3 offset:24832
    ds_read_b64_tr_b16 a[132:133], v3 offset:53248
    ds_read_b64_tr_b16 a[134:135], v3 offset:53504
    ds_read_b64_tr_b16 v[72:73], v252 offset:2048
    ds_read_b64_tr_b16 v[74:75], v252 offset:2304
    ds_read_b64_tr_b16 v[76:77], v252 offset:3072
    ds_read_b64_tr_b16 v[78:79], v252 offset:3328
    v_mfma_f32_32x32x16_bf16 v[48:63], a[140:143], v[212:215], v[48:63]
    s_waitcnt lgkmcnt(15)
    v_mfma_f32_32x32x16_bf16 v[32:47], a[144:147], v[216:219], v[32:47]
    ds_read_b64_tr_b16 a[136:137], v3 offset:25600
    ds_read_b64_tr_b16 a[138:139], v3 offset:25856
    ds_read_b64_tr_b16 a[140:141], v3 offset:54272
    ds_read_b64_tr_b16 a[142:143], v3 offset:54528
    ds_read_b64_tr_b16 v[240:241], v252 offset:4096
    ds_read_b64_tr_b16 v[242:243], v252 offset:4352
    ds_read_b64_tr_b16 v[244:245], v252 offset:5120
    ds_read_b64_tr_b16 v[246:247], v252 offset:5376
    v_mfma_f32_32x32x16_bf16 v[48:63], a[148:151], v[216:219], v[48:63]
    s_waitcnt lgkmcnt(15)
    v_mfma_f32_32x32x16_bf16 v[32:47], a[152:155], v[220:223], v[32:47]
    ds_read_b64_tr_b16 a[144:145], v3 offset:26624
    ds_read_b64_tr_b16 a[146:147], v3 offset:26880
    ds_read_b64_tr_b16 a[148:149], v3 offset:55296
    ds_read_b64_tr_b16 a[150:151], v3 offset:55552
    buffer_store_dwordx4 v[64:67], v1, s[52:55], s7 offen sc1
    buffer_store_dwordx4 v[68:71], v253, s[52:55], s8 offen sc1
    v_mfma_f32_32x32x16_bf16 v[48:63], a[156:159], v[220:223], v[48:63]
    s_waitcnt lgkmcnt(15)
    v_mfma_f32_32x32x16_bf16 v[32:47], a[128:131], v[224:227], v[32:47]
    ds_read_b64_tr_b16 a[152:153], v3 offset:27648
    ds_read_b64_tr_b16 a[154:155], v3 offset:27904
    ds_read_b64_tr_b16 a[156:157], v3 offset:56320
    ds_read_b64_tr_b16 a[158:159], v3 offset:56576
    s_waitcnt lgkmcnt(15)
    buffer_store_dwordx4 v[72:75], v255, s[52:55], s9 offen sc1
    buffer_store_dwordx4 v[76:79], v1, s[52:55], s12 offen sc1
    v_mfma_f32_32x32x16_bf16 v[48:63], a[132:135], v[224:227], v[48:63]
    s_waitcnt lgkmcnt(12)
    v_mfma_f32_32x32x16_bf16 v[32:47], a[136:139], v[228:231], v[32:47]
    s_waitcnt lgkmcnt(10)
    buffer_store_dwordx4 v[240:243], v253, s[52:55], s13 offen sc1
    s_waitcnt lgkmcnt(8)
    buffer_store_dwordx4 v[244:247], v255, s[52:55], s14 offen sc1
    v_mfma_f32_32x32x16_bf16 v[48:63], a[140:143], v[228:231], v[48:63]
    s_waitcnt lgkmcnt(6)
    v_mfma_f32_32x32x16_bf16 v[32:47], a[144:147], v[232:235], v[32:47]
    s_waitcnt lgkmcnt(2)
    v_mfma_f32_32x32x16_bf16 v[32:47], a[152:155], v[236:239], v[32:47]
    v_mfma_f32_32x32x8_bf16 v[32:47], a[160:161], v[126:127], v[32:47]
    v_mfma_f32_32x32x16_bf16 v[48:63], a[148:151], v[232:235], v[48:63]
    s_waitcnt lgkmcnt(0)
    v_mfma_f32_32x32x16_bf16 v[48:63], a[156:159], v[236:239], v[48:63]
    v_mfma_f32_32x32x8_bf16 v[48:63], a[162:163], v[126:127], v[48:63]
    v_readfirstlane_b32 s89, v123
    s_nop 1
    s_cmp_lg_u32 s89, 0
    s_cbranch_scc1 L_init_1_go
    v_mov_b32 v80, 0
L_init_1:
    global_load_dword v123, v80, s[20:21] sc1
    s_sub_u32 s63, s63, 1
    s_cbranch_scc1 L_init_1_to
    s_waitcnt vmcnt(0)
    v_readfirstlane_b32 s89, v123
    s_nop 1
    s_cmp_eq_u32 s89, 0
    s_cbranch_scc1 L_init_1
    s_branch L_init_1_go
L_init_1_to:
    s_mov_b32 s63, 0
    s_waitcnt vmcnt(0)
L_init_1_go:
    v_mul_f32 v122, 0x3fb8aa3b, v124
    v_pk_mul_f32 v[32:33], v[32:33], v[122:123] op_sel:[0,0] op_sel_hi:[1,0]
    v_pk_mul_f32 v[34:35], v[34:35], v[122:123] op_sel:[0,0] op_sel_hi:[1,0]
    v_pk_mul_f32 v[36:37], v[36:37], v[122:123] op_sel:[0,0] op_sel_hi:[1,0]
    v_pk_mul_f32 v[38:39], v[38:39], v[122:123] op_sel:[0,0] op_sel_hi:[1,0]
    v_pk_mul_f32 v[40:41], v[40:41], v[122:123] op_sel:[0,0] op_sel_hi:[1,0]
    v_pk_mul_f32 v[42:43], v[42:43], v[122:123] op_sel:[0,0] op_sel_hi:[1,0]
    v_pk_mul_f32 v[44:45], v[44:45], v[122:123] op_sel:[0,0] op_sel_hi:[1,0]
    v_pk_mul_f32 v[46:47], v[46:47], v[122:123] op_sel:[0,0] op_sel_hi:[1,0]
    v_cvt_pk_bf16_f32 v80, v32, v33
    v_cvt_pk_bf16_f32 v81, v34, v35
    v_cvt_pk_bf16_f32 v82, v36, v37
    v_cvt_pk_bf16_f32 v83, v38, v39
    v_cvt_pk_bf16_f32 v84, v40, v41
    v_cvt_pk_bf16_f32 v85, v42, v43
    v_cvt_pk_bf16_f32 v86, v44, v45
    v_cvt_pk_bf16_f32 v87, v46, v47
    v_mfma_f32_32x32x16_bf16 v[64:79], a[172:175], v[80:83], 0
    v_mul_f32 v48, v48, v124
    v_mul_f32 v49, v49, v124
    v_mul_f32 v50, v50, v124
    v_mul_f32 v51, v51, v124
    v_mul_f32 v52, v52, v124
    v_mul_f32 v53, v53, v124
    v_mfma_f32_32x32x16_bf16 v[64:79], a[176:179], v[84:87], v[64:79]
    v_mul_f32 v54, v54, v124
    v_mul_f32 v55, v55, v124
    v_mul_f32 v56, v56, v124
    v_mul_f32 v57, v57, v124
    v_mul_f32 v58, v58, v124
    v_mul_f32 v59, v59, v124
    v_mul_f32 v60, v60, v124
    v_mul_f32 v61, v61, v124
    v_mul_f32 v62, v62, v124
    v_mul_f32 v63, v63, v124
    v_cvt_pk_bf16_f32 v104, v48, v49
    v_cvt_pk_bf16_f32 v105, v50, v51
    v_cvt_pk_bf16_f32 v106, v52, v53
    v_cvt_pk_bf16_f32 v107, v54, v55
    v_cvt_pk_bf16_f32 v108, v56, v57
    v_cvt_pk_bf16_f32 v109, v58, v59
    v_cvt_pk_bf16_f32 v110, v60, v61
    v_cvt_pk_bf16_f32 v111, v62, v63
    s_mov_b64 exec, s[80:81]
    v_mov_b32 v110, 0x00003f80
    v_mov_b32 v111, 0
    s_mov_b64 exec, -1
    v_xor_b32 v32, 128, v8
    ds_write_b64 v32, v[104:105]
    v_xor_b32 v33, 144, v8
    ds_write_b64 v33, v[106:107]
    v_xor_b32 v32, 160, v8
    ds_write_b64 v32, v[108:109]
    v_xor_b32 v33, 176, v8
    ds_write_b64 v33, v[110:111]
    v_max3_f32 v120, v64, v65, v66
    v_max3_f32 v121, -v64, -v65, -v66
    v_max3_f32 v120, v120, v67, v68
    v_max3_f32 v121, v121, -v67, -v68
    v_max3_f32 v120, v120, v69, v70
    v_max3_f32 v121, v121, -v69, -v70
    v_max3_f32 v120, v120, v71, v72
    v_max3_f32 v121, v121, -v71, -v72
    v_max3_f32 v120, v120, v73, v74
    v_max3_f32 v121, v121, -v73, -v74
    v_max3_f32 v120, v120, v75, v76
    v_max3_f32 v121, v121, -v75, -v76
    v_max_f32 v120, v120, v77
    v_max_f32_e64 v121, v121, -v77
    s_nop 1
    v_permlane32_swap_b32 v120, v121
    v_max_f32 v121, v120, v121
    v_mov_b32 v120, v121
    s_nop 1
    v_permlane32_swap_b32 v120, v121
    v_pk_add_f32 v[88:89], v[64:65], v[120:121] op_sel:[0,0] op_sel_hi:[1,0] neg_lo:[0,1] neg_hi:[0,1]
    v_pk_add_f32 v[64:65], v[64:65], v[120:121] op_sel:[0,1] op_sel_hi:[1,1] neg_lo:[1,1] neg_hi:[1,1]
    v_pk_add_f32 v[90:91], v[66:67], v[120:121] op_sel:[0,0] op_sel_hi:[1,0] neg_lo:[0,1] neg_hi:[0,1]
    v_pk_add_f32 v[66:67], v[66:67], v[120:121] op_sel:[0,1] op_sel_hi:[1,1] neg_lo:[1,1] neg_hi:[1,1]
    v_pk_add_f32 v[92:93], v[68:69], v[120:121] op_sel:[0,0] op_sel_hi:[1,0] neg_lo:[0,1] neg_hi:[0,1]
    v_pk_add_f32 v[68:69], v[68:69], v[120:121] op_sel:[0,1] op_sel_hi:[1,1] neg_lo:[1,1] neg_hi:[1,1]
    v_pk_add_f32 v[94:95], v[70:71], v[120:121] op_sel:[0,0] op_sel_hi:[1,0] neg_lo:[0,1] neg_hi:[0,1]
    v_pk_add_f32 v[70:71], v[70:71], v[120:121] op_sel:[0,1] op_sel_hi:[1,1] neg_lo:[1,1] neg_hi:[1,1]
    v_pk_add_f32 v[96:97], v[72:73], v[120:121] op_sel:[0,0] op_sel_hi:[1,0] neg_lo:[0,1] neg_hi:[0,1]
    v_pk_add_f32 v[72:73], v[72:73], v[120:121] op_sel:[0,1] op_sel_hi:[1,1] neg_lo:[1,1] neg_hi:[1,1]
    v_pk_add_f32 v[98:99], v[74:75], v[120:121] op_sel:[0,0] op_sel_hi:[1,0] neg_lo:[0,1] neg_hi:[0,1]
    v_pk_add_f32 v[74:75], v[74:75], v[120:121] op_sel:[0,1] op_sel_hi:[1,1] neg_lo:[1,1] neg_hi:[1,1]
    v_pk_add_f32 v[100:101], v[76:77], v[120:121] op_sel:[0,0] op_sel_hi:[1,0] neg_lo:[0,1] neg_hi:[0,1]
    v_pk_add_f32 v[76:77], v[76:77], v[120:121] op_sel:[0,1] op_sel_hi:[1,1] neg_lo:[1,1] neg_hi:[1,1]
    v_exp_f32 v88, v88
    v_exp_f32 v64, v64
    v_exp_f32 v89, v89
    v_exp_f32 v65, v65
    v_exp_f32 v90, v90
    v_exp_f32 v66, v66
    v_exp_f32 v91, v91
    v_exp_f32 v67, v67
    v_exp_f32 v92, v92
    v_exp_f32 v68, v68
    v_exp_f32 v93, v93
    v_exp_f32 v69, v69
    v_exp_f32 v94, v94
    v_exp_f32 v70, v70
    v_exp_f32 v95, v95
    v_exp_f32 v71, v71
    v_exp_f32 v96, v96
    v_exp_f32 v72, v72
    v_exp_f32 v97, v97
    v_exp_f32 v73, v73
    v_exp_f32 v98, v98
    v_exp_f32 v74, v74
    v_exp_f32 v99, v99
    v_exp_f32 v75, v75
    v_exp_f32 v100, v100
    v_exp_f32 v76, v76
    v_exp_f32 v101, v101
    v_exp_f32 v77, v77
    v_pk_add_f32 v[120:121], v[88:89], v[90:91]
    v_pk_add_f32 v[122:123], v[64:65], v[66:67]
    v_pk_add_f32 v[120:121], v[120:121], v[92:93]
    v_pk_add_f32 v[122:123], v[122:123], v[68:69]
    v_pk_add_f32 v[120:121], v[120:121], v[94:95]
    v_pk_add_f32 v[122:123], v[122:123], v[70:71]
    v_pk_add_f32 v[120:121], v[120:121], v[96:97]
    v_pk_add_f32 v[122:123], v[122:123], v[72:73]
    v_pk_add_f32 v[120:121], v[120:121], v[98:99]
    v_pk_add_f32 v[122:123], v[122:123], v[74:75]
    v_pk_add_f32 v[120:121], v[120:121], v[100:101]
    v_pk_add_f32 v[122:123], v[122:123], v[76:77]
    v_add_f32 v120, v120, v121
    v_add_f32 v121, v122, v123
    v_mov_b32 v111, 0
    s_nop 0
    v_permlane32_swap_b32 v120, v121
    v_add_f32 v121, v120, v121
    v_rcp_f32 v121, v121
    v_mov_b32 v119, 0
    v_mov_b32 v120, v121
    s_nop 1
    v_permlane32_swap_b32 v120, v121
    v_pk_mul_f32 v[88:89], v[88:89], v[120:121] op_sel:[0,0] op_sel_hi:[1,0]
    v_pk_mul_f32 v[90:91], v[90:91], v[120:121] op_sel:[0,0] op_sel_hi:[1,0]
    v_pk_mul_f32 v[92:93], v[92:93], v[120:121] op_sel:[0,0] op_sel_hi:[1,0]
    v_pk_mul_f32 v[94:95], v[94:95], v[120:121] op_sel:[0,0] op_sel_hi:[1,0]
    v_pk_mul_f32 v[96:97], v[96:97], v[120:121] op_sel:[0,0] op_sel_hi:[1,0]
    v_pk_mul_f32 v[98:99], v[98:99], v[120:121] op_sel:[0,0] op_sel_hi:[1,0]
    v_pk_mul_f32 v[100:101], v[100:101], v[120:121] op_sel:[0,0] op_sel_hi:[1,0]
    v_cvt_pk_bf16_f32 v104, v88, v89
    v_cvt_pk_bf16_f32 v105, v90, v91
    v_cvt_pk_bf16_f32 v106, v92, v93
    v_cvt_pk_bf16_f32 v107, v94, v95
    v_cvt_pk_bf16_f32 v108, v96, v97
    v_cvt_pk_bf16_f32 v109, v98, v99
    v_cvt_pk_bf16_f32 v110, v100, v101
    ds_write_b64 v8, v[104:105]
    v_xor_b32 v33, 16, v8
    ds_write_b64 v33, v[106:107]
    v_xor_b32 v32, 32, v8
    ds_write_b64 v32, v[108:109]
    v_xor_b32 v33, 48, v8
    ds_write_b64 v33, v[110:111]
    v_pk_mul_f32 v[64:65], v[64:65], v[120:121] op_sel:[0,1] op_sel_hi:[1,1]
    v_pk_mul_f32 v[66:67], v[66:67], v[120:121] op_sel:[0,1] op_sel_hi:[1,1]
    v_pk_mul_f32 v[68:69], v[68:69], v[120:121] op_sel:[0,1] op_sel_hi:[1,1]
    v_pk_mul_f32 v[70:71], v[70:71], v[120:121] op_sel:[0,1] op_sel_hi:[1,1]
    v_pk_mul_f32 v[72:73], v[72:73], v[120:121] op_sel:[0,1] op_sel_hi:[1,1]
    v_pk_mul_f32 v[74:75], v[74:75], v[120:121] op_sel:[0,1] op_sel_hi:[1,1]
    v_pk_mul_f32 v[76:77], v[76:77], v[120:121] op_sel:[0,1] op_sel_hi:[1,1]
    v_cvt_pk_bf16_f32 v112, v64, v65
    v_cvt_pk_bf16_f32 v113, v66, v67
    v_cvt_pk_bf16_f32 v114, v68, v69
    v_cvt_pk_bf16_f32 v115, v70, v71
    v_cvt_pk_bf16_f32 v116, v72, v73
    v_cvt_pk_bf16_f32 v117, v74, v75
    v_cvt_pk_bf16_f32 v118, v76, v77
    v_xor_b32 v32, 64, v8
    ds_write_b64 v32, v[112:113]
    v_xor_b32 v33, 80, v8
    ds_write_b64 v33, v[114:115]
    v_xor_b32 v32, 96, v8
    ds_write_b64 v32, v[116:117]
    v_xor_b32 v33, 112, v8
    ds_write_b64 v33, v[118:119]
    s_lshl_b32 s90, s60, 10
    s_add_u32 s90, s90, s71
    s_add_u32 s90, s90, 24117248
    s_waitcnt vmcnt(0) lgkmcnt(0)
    s_barrier
    ds_read_b64_tr_b16 a[0:1], v9 offset:0
    ds_read_b64_tr_b16 a[2:3], v9 offset:4096
    ds_read_b64_tr_b16 a[4:5], v13 offset:0
    ds_read_b64_tr_b16 a[6:7], v13 offset:4096
    ds_read_b64_tr_b16 a[8:9], v7 offset:0
    ds_read_b64_tr_b16 a[10:11], v7 offset:4096
    ds_read_b64_tr_b16 a[12:13], v9 offset:8192
    ds_read_b64_tr_b16 a[14:15], v9 offset:12288
    ds_read_b64_tr_b16 a[16:17], v13 offset:8192
    ds_read_b64_tr_b16 a[18:19], v13 offset:12288
    ds_read_b64_tr_b16 a[20:21], v7 offset:8192
    ds_read_b64_tr_b16 a[22:23], v7 offset:12288
    s_waitcnt lgkmcnt(8)
    v_mfma_f32_16x16x32_bf16 v[36:39], a[0:3], a[4:7], 0
    ds_read_b64_tr_b16 a[24:25], v9 offset:16384
    ds_read_b64_tr_b16 a[26:27], v9 offset:20480
    ds_read_b64_tr_b16 a[28:29], v13 offset:16384
    ds_read_b64_tr_b16 a[30:31], v13 offset:20480
    ds_read_b64_tr_b16 a[32:33], v7 offset:16384
    ds_read_b64_tr_b16 a[34:35], v7 offset:20480
    s_waitcnt lgkmcnt(12)
    v_mfma_f32_16x16x32_bf16 v[40:43], a[0:3], a[8:11], 0
    s_waitcnt lgkmcnt(8)
    v_mfma_f32_16x16x32_bf16 v[36:39], a[12:15], a[16:19], v[36:39]
    ds_read_b64_tr_b16 a[36:37], v9 offset:24576
    ds_read_b64_tr_b16 a[38:39], v9 offset:28672
    ds_read_b64_tr_b16 a[40:41], v13 offset:24576
    ds_read_b64_tr_b16 a[42:43], v13 offset:28672
    ds_read_b64_tr_b16 a[44:45], v7 offset:24576
    ds_read_b64_tr_b16 a[46:47], v7 offset:28672
    s_waitcnt lgkmcnt(12)
    v_mfma_f32_16x16x32_bf16 v[40:43], a[12:15], a[20:23], v[40:43]
    s_waitcnt lgkmcnt(8)
    v_mfma_f32_16x16x32_bf16 v[36:39], a[24:27], a[28:31], v[36:39]
    s_waitcnt lgkmcnt(6)
    v_mfma_f32_16x16x32_bf16 v[40:43], a[24:27], a[32:35], v[40:43]
    s_waitcnt lgkmcnt(2)
    v_mfma_f32_16x16x32_bf16 v[36:39], a[36:39], a[40:43], v[36:39]
    s_waitcnt lgkmcnt(0)
    v_mfma_f32_16x16x32_bf16 v[40:43], a[36:39], a[44:47], v[40:43]
    s_nop 5
    v_cvt_pk_bf16_f32 v44, v36, v37
    v_cvt_pk_bf16_f32 v45, v38, v39
    v_cvt_pk_bf16_f32 v46, v40, v41
    v_cvt_pk_bf16_f32 v47, v42, v43
    buffer_store_dwordx4 v[44:47], v1, s[52:55], s90 offen sc1
    v_mov_b32 v80, 0
    v_mov_b32 v81, 0
    v_mov_b32 v82, 0
    v_mov_b32 v83, 0
    s_mov_b32 exec_lo, 0x00020001
    s_mov_b32 exec_hi, 0x00020001
    v_mov_b32 v80, 0x3f803f80
    v_mov_b32 v81, 0x3f803f80
    v_mov_b32 v82, 0x3f803f80
    v_mov_b32 v83, 0x3f803f80
    s_mov_b64 exec, -1
    v_add_u32 v84, s100, v3
    v_add_u32 v85, 57344, v84
    v_and_b32 v86, 31, v0
    s_mul_i32 s90, s62, 384
    s_add_u32 s90, s90, 159744
    v_lshl_add_u32 v86, v86, 2, s90
    ds_read_b64_tr_b16 a[0:1], v85 offset:0
    ds_read_b64_tr_b16 a[2:3], v85 offset:256
    ds_read_b64_tr_b16 a[4:5], v85 offset:1024
    ds_read_b64_tr_b16 a[6:7], v85 offset:1280
    ds_read_b64_tr_b16 a[8:9], v85 offset:2048
    ds_read_b64_tr_b16 a[10:11], v85 offset:2304
    ds_read_b64_tr_b16 a[12:13], v85 offset:3072
    ds_read_b64_tr_b16 a[14:15], v85 offset:3328
    ds_read_b64_tr_b16 a[16:17], v85 offset:4096
    ds_read_b64_tr_b16 a[18:19], v85 offset:4352
    s_waitcnt lgkmcnt(8)
    v_mfma_f32_16x16x32_bf16 v[48:51], v[80:83], a[0:3], 0
    ds_read_b64_tr_b16 a[20:21], v85 offset:5120
    ds_read_b64_tr_b16 a[22:23], v85 offset:5376
    s_waitcnt lgkmcnt(8)
    v_mfma_f32_16x16x32_bf16 v[48:51], v[80:83], a[4:7], v[48:51]
    ds_read_b64_tr_b16 a[24:25], v85 offset:6144
    ds_read_b64_tr_b16 a[26:27], v85 offset:6400
    s_waitcnt lgkmcnt(8)
    v_mfma_f32_16x16x32_bf16 v[48:51], v[80:83], a[8:11], v[48:51]
    s_waitcnt lgkmcnt(6)
    v_mfma_f32_16x16x32_bf16 v[48:51], v[80:83], a[12:15], v[48:51]
    s_waitcnt lgkmcnt(4)
    v_mfma_f32_16x16x32_bf16 v[48:51], v[80:83], a[16:19], v[48:51]
    s_waitcnt lgkmcnt(2)
    v_mfma_f32_16x16x32_bf16 v[48:51], v[80:83], a[20:23], v[48:51]
    s_waitcnt lgkmcnt(0)
    v_mfma_f32_16x16x32_bf16 v[48:51], v[80:83], a[24:27], v[48:51]
    s_mov_b64 exec, 0xffff
    s_nop 6
    ds_write2_b32 v86, v48, v49 offset0:64 offset1:80
    s_mov_b64 exec, -1
    ds_read_b64_tr_b16 a[128:129], v4 offset:0
    ds_read_b64_tr_b16 a[130:131], v4 offset:256
    ds_read_b64_tr_b16 a[132:133], v4 offset:1024
    ds_read_b64_tr_b16 a[134:135], v4 offset:1280
    ds_read_b64_tr_b16 a[136:137], v4 offset:2048
    ds_read_b64_tr_b16 a[138:139], v4 offset:2304
    ds_read_b64_tr_b16 a[140:141], v4 offset:3072
    ds_read_b64_tr_b16 a[142:143], v4 offset:3328
    ds_read_b64_tr_b16 a[144:145], v4 offset:4096
    ds_read_b64_tr_b16 a[146:147], v4 offset:4352
    s_waitcnt lgkmcnt(8)
    v_mfma_f32_32x32x16_bf16 v[64:79], a[128:131], v[128:131], 0
    ds_read_b64_tr_b16 a[148:149], v4 offset:5120
    ds_read_b64_tr_b16 a[150:151], v4 offset:5376
    s_waitcnt lgkmcnt(8)
    v_mfma_f32_32x32x16_bf16 v[64:79], a[132:135], v[132:135], v[64:79]
    ds_read_b64_tr_b16 a[152:153], v4 offset:6144
    ds_read_b64_tr_b16 a[154:155], v4 offset:6400
L_page_1:
    s_cbranch_vccnz L_page_ret0
    s_waitcnt lgkmcnt(8)
    v_mfma_f32_32x32x16_bf16 v[64:79], a[136:139], v[136:139], v[64:79]
    ds_read_b64_tr_b16 a[156:157], v4 offset:7168
    ds_read_b64_tr_b16 a[158:159], v4 offset:7424
    s_waitcnt lgkmcnt(8)
    v_mfma_f32_32x32x16_bf16 v[64:79], a[140:143], v[140:143], v[64:79]
    ds_read_b64_tr_b16 a[128:129], v4 offset:8192
    ds_read_b64_tr_b16 a[130:131], v4 offset:8448
    s_waitcnt lgkmcnt(8)
    v_mfma_f32_32x32x16_bf16 v[64:79], a[144:147], v[144:147], v[64:79]
    ds_read_b64_tr_b16 a[132:133], v4 offset:9216
    ds_read_b64_tr_b16 a[134:135], v4 offset:9472
    s_waitcnt lgkmcnt(8)
    v_mfma_f32_32x32x16_bf16 v[64:79], a[148:151], v[148:151], v[64:79]
    ds_read_b64_tr_b16 a[136:137], v4 offset:10240
    ds_read_b64_tr_b16 a[138:139], v4 offset:10496
    s_waitcnt lgkmcnt(8)
    v_mfma_f32_32x32x16_bf16 v[64:79], a[152:155], v[152:155], v[64:79]
    ds_read_b64_tr_b16 a[140:141], v4 offset:11264
    ds_read_b64_tr_b16 a[142:143], v4 offset:11520
    s_waitcnt vmcnt(0)
    s_atomic_add s57, s[66:67], 0
    s_waitcnt lgkmcnt(8)
    v_mfma_f32_32x32x16_bf16 v[64:79], a[156:159], v[156:159], v[64:79]
    ds_read_b64_tr_b16 a[144:145], v4 offset:12288
    ds_read_b64_tr_b16 a[146:147], v4 offset:12544
    s_waitcnt lgkmcnt(8)
    v_mfma_f32_32x32x16_bf16 v[64:79], a[128:131], v[160:163], v[64:79]
    ds_read_b64_tr_b16 a[148:149], v4 offset:13312
    ds_read_b64_tr_b16 a[150:151], v4 offset:13568
    s_waitcnt lgkmcnt(8)
    v_mfma_f32_32x32x16_bf16 v[64:79], a[132:135], v[164:167], v[64:79]
    ds_read_b64_tr_b16 a[152:153], v4 offset:14336
    ds_read_b64_tr_b16 a[154:155], v4 offset:14592
    s_waitcnt lgkmcnt(8)
    v_mfma_f32_32x32x16_bf16 v[64:79], a[136:139], v[168:171], v[64:79]
    ds_read_b64_tr_b16 a[156:157], v4 offset:15360
    ds_read_b64_tr_b16 a[158:159], v4 offset:15616
    s_waitcnt lgkmcnt(8)
    v_mfma_f32_32x32x16_bf16 v[64:79], a[140:143], v[172:175], v[64:79]
    ds_read_b64_tr_b16 a[128:129], v4 offset:16384
    ds_read_b64_tr_b16 a[130:131], v4 offset:16640
    s_waitcnt lgkmcnt(8)
    v_mfma_f32_32x32x16_bf16 v[64:79], a[144:147], v[176:179], v[64:79]
    ds_read_b64_tr_b16 a[132:133], v4 offset:17408
    ds_read_b64_tr_b16 a[134:135], v4 offset:17664
    s_waitcnt lgkmcnt(0)
    s_barrier
    v_and_b32 v84, 31, v0
    v_mfma_f32_32x32x16_bf16 v[64:79], a[148:151], v[180:183], v[64:79]
    ds_read_b64_tr_b16 a[136:137], v4 offset:18432
    ds_read_b64_tr_b16 a[138:139], v4 offset:18688
    v_lshlrev_b32 v84, 2, v84
    v_add_u32 v84, 159744, v84
    v_mfma_f32_32x32x16_bf16 v[64:79], a[152:155], v[184:187], v[64:79]
    ds_read_b64_tr_b16 a[140:141], v4 offset:19456
    ds_read_b64_tr_b16 a[142:143], v4 offset:19712
    ds_read_b32 v96, v84 offset:256
    ds_read_b32 v97, v84 offset:640
    v_mfma_f32_32x32x16_bf16 v[64:79], a[156:159], v[188:191], v[64:79]
    ds_read_b64_tr_b16 a[144:145], v4 offset:20480
    ds_read_b64_tr_b16 a[146:147], v4 offset:20736
    ds_read_b32 v98, v84 offset:1024
    ds_read_b32 v99, v84 offset:1408
    v_mfma_f32_32x32x16_bf16 v[64:79], a[128:131], v[192:195], v[64:79]
    ds_read_b64_tr_b16 a[148:149], v4 offset:21504
    ds_read_b64_tr_b16 a[150:151], v4 offset:21760
    s_waitcnt lgkmcnt(6)
    v_add_f32 v96, v96, v97
    s_waitcnt lgkmcnt(2)
    v_add_f32 v98, v98, v99
    v_mfma_f32_32x32x16_bf16 v[64:79], a[132:135], v[196:199], v[64:79]
    ds_read_b64_tr_b16 a[152:153], v4 offset:22528
    ds_read_b64_tr_b16 a[154:155], v4 offset:22784
    v_add_f32 v96, v96, v98
    v_cvt_pk_bf16_f32 v97, v96, v96
    v_mfma_f32_32x32x16_bf16 v[64:79], a[136:139], v[200:203], v[64:79]
    ds_read_b64_tr_b16 a[156:157], v4 offset:23552
    ds_read_b64_tr_b16 a[158:159], v4 offset:23808
    v_and_b32 v98, 0xffff0000, v97
    v_sub_f32 v98, v96, v98
    v_mfma_f32_32x32x16_bf16 v[64:79], a[140:143], v[204:207], v[64:79]
    ds_read_b64_tr_b16 a[128:129], v4 offset:24576
    ds_read_b64_tr_b16 a[130:131], v4 offset:24832
    v_cvt_pk_bf16_f32 v98, v98, 0
    v_accvgpr_write_b32 a164, v97
    v_mfma_f32_32x32x16_bf16 v[64:79], a[144:147], v[208:211], v[64:79]
    ds_read_b64_tr_b16 a[132:133], v4 offset:25600
    ds_read_b64_tr_b16 a[134:135], v4 offset:25856
    v_accvgpr_write_b32 a165, v98
    s_waitcnt lgkmcnt(8)
    v_mfma_f32_32x32x16_bf16 v[64:79], a[148:151], v[212:215], v[64:79]
    ds_read_b64_tr_b16 a[136:137], v4 offset:26624
    ds_read_b64_tr_b16 a[138:139], v4 offset:26880
    s_waitcnt lgkmcnt(8)
    v_mfma_f32_32x32x16_bf16 v[64:79], a[152:155], v[216:219], v[64:79]
    ds_read_b64_tr_b16 a[140:141], v4 offset:27648
    ds_read_b64_tr_b16 a[142:143], v4 offset:27904
    s_waitcnt lgkmcnt(8)
    v_mfma_f32_32x32x16_bf16 v[64:79], a[156:159], v[220:223], v[64:79]
    s_waitcnt lgkmcnt(6)
    v_mfma_f32_32x32x16_bf16 v[64:79], a[128:131], v[224:227], v[64:79]
    s_waitcnt lgkmcnt(4)
    v_mfma_f32_32x32x16_bf16 v[64:79], a[132:135], v[228:231], v[64:79]
    s_waitcnt lgkmcnt(2)
    v_mfma_f32_32x32x16_bf16 v[64:79], a[136:139], v[232:235], v[64:79]
    s_waitcnt lgkmcnt(0)
    v_mfma_f32_32x32x16_bf16 v[64:79], a[140:143], v[236:239], v[64:79]
    v_mfma_f32_32x32x8_bf16 v[64:79], a[164:165], v[126:127], v[64:79]
    s_mov_b32 s101, 0
    s_atomic_add s101, s[66:67], 0 glc
    v_mul_f32 v122, 0x3fb8aa3b, v124
    s_and_b32 s90, s60, 3
    s_lshl_b32 s90, s90, 12
    s_add_u32 s90, s90, s71
    s_add_u32 s72, s90, 24117248
    s_xor_b32 s73, s72, 4096
    s_xor_b32 s74, s72, 8192
    s_xor_b32 s75, s72, 12288
    s_nop 1
    v_pk_mul_f32 v[64:65], v[64:65], v[122:123] op_sel:[0,0] op_sel_hi:[1,0]
    v_pk_mul_f32 v[66:67], v[66:67], v[122:123] op_sel:[0,0] op_sel_hi:[1,0]
    v_pk_mul_f32 v[68:69], v[68:69], v[122:123] op_sel:[0,0] op_sel_hi:[1,0]
    v_pk_mul_f32 v[70:71], v[70:71], v[122:123] op_sel:[0,0] op_sel_hi:[1,0]
    v_pk_mul_f32 v[72:73], v[72:73], v[122:123] op_sel:[0,0] op_sel_hi:[1,0]
    v_pk_mul_f32 v[74:75], v[74:75], v[122:123] op_sel:[0,0] op_sel_hi:[1,0]
    v_pk_mul_f32 v[76:77], v[76:77], v[122:123] op_sel:[0,0] op_sel_hi:[1,0]
    v_pk_mul_f32 v[78:79], v[78:79], v[122:123] op_sel:[0,0] op_sel_hi:[1,0]
    v_cvt_pk_bf16_f32 v80, v64, v65
    v_cvt_pk_bf16_f32 v81, v66, v67
    v_cvt_pk_bf16_f32 v82, v68, v69
    v_cvt_pk_bf16_f32 v83, v70, v71
    v_cvt_pk_bf16_f32 v84, v72, v73
    v_cvt_pk_bf16_f32 v85, v74, v75
    v_cvt_pk_bf16_f32 v86, v76, v77
    v_cvt_pk_bf16_f32 v87, v78, v79
    v_mfma_f32_32x32x16_bf16 v[64:79], a[172:175], v[80:83], 0
    s_nop 0
    v_mfma_f32_32x32x16_bf16 v[64:79], a[176:179], v[84:87], v[64:79]
    s_nop 11
    v_max3_f32 v120, v64, v65, v66
    v_max3_f32 v121, -v64, -v65, -v66
    v_max3_f32 v120, v120, v67, v68
    v_max3_f32 v121, v121, -v67, -v68
    v_max3_f32 v120, v120, v69, v70
    v_max3_f32 v121, v121, -v69, -v70
    v_max3_f32 v120, v120, v71, v72
    v_max3_f32 v121, v121, -v71, -v72
    v_max3_f32 v120, v120, v73, v74
    v_max3_f32 v121, v121, -v73, -v74
    v_max3_f32 v120, v120, v75, v76
    v_max3_f32 v121, v121, -v75, -v76
    v_max_f32 v120, v120, v77
    v_max_f32_e64 v121, v121, -v77
    s_nop 1
    v_permlane32_swap_b32 v120, v121
    v_max_f32 v121, v120, v121
    v_mov_b32 v120, v121
    s_nop 1
    v_permlane32_swap_b32 v120, v121
    v_pk_add_f32 v[88:89], v[64:65], v[120:121] op_sel:[0,0] op_sel_hi:[1,0] neg_lo:[0,1] neg_hi:[0,1]
    v_pk_add_f32 v[64:65], v[64:65], v[120:121] op_sel:[0,1] op_sel_hi:[1,1] neg_lo:[1,1] neg_hi:[1,1]
    v_pk_add_f32 v[90:91], v[66:67], v[120:121] op_sel:[0,0] op_sel_hi:[1,0] neg_lo:[0,1] neg_hi:[0,1]
    v_pk_add_f32 v[66:67], v[66:67], v[120:121] op_sel:[0,1] op_sel_hi:[1,1] neg_lo:[1,1] neg_hi:[1,1]
    v_pk_add_f32 v[92:93], v[68:69], v[120:121] op_sel:[0,0] op_sel_hi:[1,0] neg_lo:[0,1] neg_hi:[0,1]
    v_pk_add_f32 v[68:69], v[68:69], v[120:121] op_sel:[0,1] op_sel_hi:[1,1] neg_lo:[1,1] neg_hi:[1,1]
    v_pk_add_f32 v[94:95], v[70:71], v[120:121] op_sel:[0,0] op_sel_hi:[1,0] neg_lo:[0,1] neg_hi:[0,1]
    v_pk_add_f32 v[70:71], v[70:71], v[120:121] op_sel:[0,1] op_sel_hi:[1,1] neg_lo:[1,1] neg_hi:[1,1]
    v_pk_add_f32 v[96:97], v[72:73], v[120:121] op_sel:[0,0] op_sel_hi:[1,0] neg_lo:[0,1] neg_hi:[0,1]
    v_pk_add_f32 v[72:73], v[72:73], v[120:121] op_sel:[0,1] op_sel_hi:[1,1] neg_lo:[1,1] neg_hi:[1,1]
    v_pk_add_f32 v[98:99], v[74:75], v[120:121] op_sel:[0,0] op_sel_hi:[1,0] neg_lo:[0,1] neg_hi:[0,1]
    v_pk_add_f32 v[74:75], v[74:75], v[120:121] op_sel:[0,1] op_sel_hi:[1,1] neg_lo:[1,1] neg_hi:[1,1]
    v_pk_add_f32 v[100:101], v[76:77], v[120:121] op_sel:[0,0] op_sel_hi:[1,0] neg_lo:[0,1] neg_hi:[0,1]
    v_pk_add_f32 v[76:77], v[76:77], v[120:121] op_sel:[0,1] op_sel_hi:[1,1] neg_lo:[1,1] neg_hi:[1,1]
    v_exp_f32 v88, v88
    v_exp_f32 v64, v64
    v_exp_f32 v89, v89
    v_exp_f32 v65, v65
    v_exp_f32 v90, v90
    v_exp_f32 v66, v66
    v_exp_f32 v91, v91
    v_exp_f32 v67, v67
    v_exp_f32 v92, v92
    v_exp_f32 v68, v68
    v_exp_f32 v93, v93
    v_exp_f32 v69, v69
    v_exp_f32 v94, v94
    v_exp_f32 v70, v70
    v_exp_f32 v95, v95
    v_exp_f32 v71, v71
    v_exp_f32 v96, v96
    v_exp_f32 v72, v72
    v_exp_f32 v97, v97
    v_exp_f32 v73, v73
    v_exp_f32 v98, v98
    v_exp_f32 v74, v74
    v_exp_f32 v99, v99
    v_exp_f32 v75, v75
    v_exp_f32 v100, v100
    v_exp_f32 v76, v76
    v_exp_f32 v101, v101
    v_exp_f32 v77, v77
    v_pk_add_f32 v[120:121], v[88:89], v[90:91]
    v_pk_add_f32 v[122:123], v[64:65], v[66:67]
    v_pk_add_f32 v[120:121], v[120:121], v[92:93]
    v_pk_add_f32 v[122:123], v[122:123], v[68:69]
    s_waitcnt lgkmcnt(0)
    s_add_u32 s89, s101, 0x7c7c7c7c
    s_and_b32 s89, s89, 0x80808080
    s_cmp_eq_u32 s89, 0x80808080
    s_cbranch_scc1 L_go_3
L_poll_2:
    s_mov_b32 s101, 0
    s_atomic_add s101, s[66:67], 0 glc
    s_sub_u32 s63, s63, 1
    s_cbranch_scc1 L_go_3_to
    s_waitcnt lgkmcnt(0)
    s_add_u32 s89, s101, 0x7c7c7c7c
    s_and_b32 s89, s89, 0x80808080
    s_cmp_eq_u32 s89, 0x80808080
    s_cbranch_scc0 L_poll_2
    s_branch L_go_3
L_go_3_to:
    s_mov_b32 s63, 0
    s_waitcnt lgkmcnt(0)
L_go_3:
    buffer_load_dwordx4 v[128:131], v1, s[52:55], s72 offen offset:0 sc1
    buffer_load_dwordx4 v[132:135], v1, s[52:55], s72 offen offset:1024 sc1
    buffer_load_dwordx4 v[136:139], v1, s[52:55], s72 offen offset:2048 sc1
    buffer_load_dwordx4 v[140:143], v1, s[52:55], s72 offen offset:3072 sc1
    v_pk_add_f32 v[120:121], v[120:121], v[94:95]
    buffer_load_dwordx4 v[144:147], v1, s[52:55], s73 offen offset:0 sc1
    v_pk_add_f32 v[122:123], v[122:123], v[70:71]
    v_pk_add_f32 v[120:121], v[120:121], v[96:97]
    v_pk_add_f32 v[122:123], v[122:123], v[72:73]
    v_pk_add_f32 v[120:121], v[120:121], v[98:99]
    buffer_load_dwordx4 v[148:151], v1, s[52:55], s73 offen offset:1024 sc1
    v_pk_add_f32 v[122:123], v[122:123], v[74:75]
    v_pk_add_f32 v[120:121], v[120:121], v[100:101]
    v_pk_add_f32 v[122:123], v[122:123], v[76:77]
    v_add_f32 v120, v120, v121
    buffer_load_dwordx4 v[152:155], v1, s[52:55], s73 offen offset:2048 sc1
    v_add_f32 v121, v122, v123
    v_mov_b32 v111, 0
    s_nop 0
    v_permlane32_swap_b32 v120, v121
    v_add_f32 v121, v120, v121
    buffer_load_dwordx4 v[156:159], v1, s[52:55], s73 offen offset:3072 sc1
    v_rcp_f32 v121, v121
    v_mov_b32 v119, 0
    v_mov_b32 v120, v121
    s_nop 1
    v_permlane32_swap_b32 v120, v121
    buffer_load_dwordx4 v[160:163], v1, s[52:55], s74 offen offset:0 sc1
    v_pk_mul_f32 v[88:89], v[88:89], v[120:121] op_sel:[0,0] op_sel_hi:[1,0]
    v_pk_mul_f32 v[90:91], v[90:91], v[120:121] op_sel:[0,0] op_sel_hi:[1,0]
    v_pk_mul_f32 v[92:93], v[92:93], v[120:121] op_sel:[0,0] op_sel_hi:[1,0]
    v_pk_mul_f32 v[94:95], v[94:95], v[120:121] op_sel:[0,0] op_sel_hi:[1,0]
    buffer_load_dwordx4 v[164:167], v1, s[52:55], s74 offen offset:1024 sc1
    v_pk_mul_f32 v[96:97], v[96:97], v[120:121] op_sel:[0,0] op_sel_hi:[1,0]
    v_pk_mul_f32 v[98:99], v[98:99], v[120:121] op_sel:[0,0] op_sel_hi:[1,0]
    v_pk_mul_f32 v[100:101], v[100:101], v[120:121] op_sel:[0,0] op_sel_hi:[1,0]
    v_cvt_pk_bf16_f32 v104, v88, v89
    buffer_load_dwordx4 v[168:171], v1, s[52:55], s74 offen offset:2048 sc1
    v_cvt_pk_bf16_f32 v105, v90, v91
    v_cvt_pk_bf16_f32 v106, v92, v93
    v_cvt_pk_bf16_f32 v107, v94, v95
    v_cvt_pk_bf16_f32 v108, v96, v97
    buffer_load_dwordx4 v[172:175], v1, s[52:55], s74 offen offset:3072 sc1
    v_cvt_pk_bf16_f32 v109, v98, v99
    v_cvt_pk_bf16_f32 v110, v100, v101
    v_pk_mul_f32 v[64:65], v[64:65], v[120:121] op_sel:[0,1] op_sel_hi:[1,1]
    v_pk_mul_f32 v[66:67], v[66:67], v[120:121] op_sel:[0,1] op_sel_hi:[1,1]
    buffer_load_dwordx4 v[176:179], v1, s[52:55], s75 offen offset:0 sc1
    v_pk_mul_f32 v[68:69], v[68:69], v[120:121] op_sel:[0,1] op_sel_hi:[1,1]
    v_pk_mul_f32 v[70:71], v[70:71], v[120:121] op_sel:[0,1] op_sel_hi:[1,1]
    v_pk_mul_f32 v[72:73], v[72:73], v[120:121] op_sel:[0,1] op_sel_hi:[1,1]
    v_pk_mul_f32 v[74:75], v[74:75], v[120:121] op_sel:[0,1] op_sel_hi:[1,1]
    buffer_load_dwordx4 v[180:183], v1, s[52:55], s75 offen offset:1024 sc1
    v_pk_mul_f32 v[76:77], v[76:77], v[120:121] op_sel:[0,1] op_sel_hi:[1,1]
    v_cvt_pk_bf16_f32 v112, v64, v65
    v_cvt_pk_bf16_f32 v113, v66, v67
    v_cvt_pk_bf16_f32 v114, v68, v69
    buffer_load_dwordx4 v[184:187], v1, s[52:55], s75 offen offset:2048 sc1
    v_cvt_pk_bf16_f32 v115, v70, v71
    v_cvt_pk_bf16_f32 v116, v72, v73
    v_cvt_pk_bf16_f32 v117, v74, v75
    v_cvt_pk_bf16_f32 v118, v76, v77
    buffer_load_dwordx4 v[188:191], v1, s[52:55], s75 offen offset:3072 sc1
    s_waitcnt vmcnt(15)
    v_dot2_f32_bf16 v80, v128, s93, 0
    v_dot2_f32_bf16 v81, v128, s94, 0
    v_dot2_f32_bf16 v82, v129, s93, 0
    v_dot2_f32_bf16 v83, v129, s94, 0
    v_dot2_f32_bf16 v84, v130, s93, 0
    v_dot2_f32_bf16 v85, v130, s94, 0
    v_dot2_f32_bf16 v86, v131, s93, 0
    v_dot2_f32_bf16 v87, v131, s94, 0
    s_waitcnt vmcnt(14)
    v_dot2_f32_bf16 v80, v132, s93, v80
    v_dot2_f32_bf16 v81, v132, s94, v81
    v_dot2_f32_bf16 v82, v133, s93, v82
    v_dot2_f32_bf16 v83, v133, s94, v83
    v_dot2_f32_bf16 v84, v134, s93, v84
    v_dot2_f32_bf16 v85, v134, s94, v85
    v_dot2_f32_bf16 v86, v135, s93, v86
    v_dot2_f32_bf16 v87, v135, s94, v87
    s_waitcnt vmcnt(13)
    v_dot2_f32_bf16 v80, v136, s93, v80
    v_dot2_f32_bf16 v81, v136, s94, v81
    v_dot2_f32_bf16 v82, v137, s93, v82
    v_dot2_f32_bf16 v83, v137, s94, v83
    v_dot2_f32_bf16 v84, v138, s93, v84
    v_dot2_f32_bf16 v85, v138, s94, v85
    v_dot2_f32_bf16 v86, v139, s93, v86
    v_dot2_f32_bf16 v87, v139, s94, v87
    s_waitcnt vmcnt(12)
    v_dot2_f32_bf16 v80, v140, s93, v80
    v_dot2_f32_bf16 v81, v140, s94, v81
    v_dot2_f32_bf16 v82, v141, s93, v82
    v_dot2_f32_bf16 v83, v141, s94, v83
    v_dot2_f32_bf16 v84, v142, s93, v84
    v_dot2_f32_bf16 v85, v142, s94, v85
    v_dot2_f32_bf16 v86, v143, s93, v86
    v_dot2_f32_bf16 v87, v143, s94, v87
    s_waitcnt vmcnt(11)
    v_dot2_f32_bf16 v80, v144, s93, v80
    v_dot2_f32_bf16 v81, v144, s94, v81
    v_dot2_f32_bf16 v82, v145, s93, v82
    v_dot2_f32_bf16 v83, v145, s94, v83
    v_dot2_f32_bf16 v84, v146, s93, v84
    v_dot2_f32_bf16 v85, v146, s94, v85
    v_dot2_f32_bf16 v86, v147, s93, v86
    v_dot2_f32_bf16 v87, v147, s94, v87
    s_waitcnt vmcnt(10)
    v_dot2_f32_bf16 v80, v148, s93, v80
    v_dot2_f32_bf16 v81, v148, s94, v81
    v_dot2_f32_bf16 v82, v149, s93, v82
    v_dot2_f32_bf16 v83, v149, s94, v83
    v_dot2_f32_bf16 v84, v150, s93, v84
    v_dot2_f32_bf16 v85, v150, s94, v85
    v_dot2_f32_bf16 v86, v151, s93, v86
    v_dot2_f32_bf16 v87, v151, s94, v87
    s_waitcnt vmcnt(9)
    v_dot2_f32_bf16 v80, v152, s93, v80
    v_dot2_f32_bf16 v81, v152, s94, v81
    v_dot2_f32_bf16 v82, v153, s93, v82
    v_dot2_f32_bf16 v83, v153, s94, v83
    v_dot2_f32_bf16 v84, v154, s93, v84
    v_dot2_f32_bf16 v85, v154, s94, v85
    v_dot2_f32_bf16 v86, v155, s93, v86
    v_dot2_f32_bf16 v87, v155, s94, v87
    s_waitcnt vmcnt(8)
    v_dot2_f32_bf16 v80, v156, s93, v80
    v_dot2_f32_bf16 v81, v156, s94, v81
    v_dot2_f32_bf16 v82, v157, s93, v82
    v_dot2_f32_bf16 v83, v157, s94, v83
    v_dot2_f32_bf16 v84, v158, s93, v84
    v_dot2_f32_bf16 v85, v158, s94, v85
    v_dot2_f32_bf16 v86, v159, s93, v86
    v_dot2_f32_bf16 v87, v159, s94, v87
    s_waitcnt vmcnt(7)
    v_dot2_f32_bf16 v80, v160, s93, v80
    v_dot2_f32_bf16 v81, v160, s94, v81
    v_dot2_f32_bf16 v82, v161, s93, v82
    v_dot2_f32_bf16 v83, v161, s94, v83
    v_dot2_f32_bf16 v84, v162, s93, v84
    v_dot2_f32_bf16 v85, v162, s94, v85
    v_dot2_f32_bf16 v86, v163, s93, v86
    v_dot2_f32_bf16 v87, v163, s94, v87
    s_waitcnt vmcnt(6)
    v_dot2_f32_bf16 v80, v164, s93, v80
    v_dot2_f32_bf16 v81, v164, s94, v81
    v_dot2_f32_bf16 v82, v165, s93, v82
    v_dot2_f32_bf16 v83, v165, s94, v83
    v_dot2_f32_bf16 v84, v166, s93, v84
    v_dot2_f32_bf16 v85, v166, s94, v85
    v_dot2_f32_bf16 v86, v167, s93, v86
    v_dot2_f32_bf16 v87, v167, s94, v87
    s_add_u32 m0, s100, 86016
    s_add_u32 s90, s3, 86016
    buffer_load_dwordx4 v1, s[52:55], s90 offen offset:0 sc1 lds
    s_waitcnt vmcnt(6)
    v_dot2_f32_bf16 v80, v168, s93, v80
    v_dot2_f32_bf16 v81, v168, s94, v81
    v_dot2_f32_bf16 v82, v169, s93, v82
    v_dot2_f32_bf16 v83, v169, s94, v83
    v_dot2_f32_bf16 v84, v170, s93, v84
    v_dot2_f32_bf16 v85, v170, s94, v85
    v_dot2_f32_bf16 v86, v171, s93, v86
    v_dot2_f32_bf16 v87, v171, s94, v87
    buffer_load_dwordx4 v1, s[52:55], s90 offen offset:1024 sc1 lds
    s_waitcnt vmcnt(6)
    v_dot2_f32_bf16 v80, v172, s93, v80
    v_dot2_f32_bf16 v81, v172, s94, v81
    v_dot2_f32_bf16 v82, v173, s93, v82
    v_dot2_f32_bf16 v83, v173, s94, v83
    v_dot2_f32_bf16 v84, v174, s93, v84
    v_dot2_f32_bf16 v85, v174, s94, v85
    v_dot2_f32_bf16 v86, v175, s93, v86
    v_dot2_f32_bf16 v87, v175, s94, v87
    buffer_load_dwordx4 v1, s[52:55], s90 offen offset:2048 sc1 lds
    s_waitcnt vmcnt(6)
    v_dot2_f32_bf16 v80, v176, s93, v80
    v_dot2_f32_bf16 v81, v176, s94, v81
    v_dot2_f32_bf16 v82, v177, s93, v82
    v_dot2_f32_bf16 v83, v177, s94, v83
    v_dot2_f32_bf16 v84, v178, s93, v84
    v_dot2_f32_bf16 v85, v178, s94, v85
    v_dot2_f32_bf16 v86, v179, s93, v86
    v_dot2_f32_bf16 v87, v179, s94, v87
    buffer_load_dwordx4 v1, s[52:55], s90 offen offset:3072 sc1 lds
    s_waitcnt vmcnt(6)
    v_dot2_f32_bf16 v80, v180, s93, v80
    v_dot2_f32_bf16 v81, v180, s94, v81
    v_dot2_f32_bf16 v82, v181, s93, v82
    v_dot2_f32_bf16 v83, v181, s94, v83
    v_dot2_f32_bf16 v84, v182, s93, v84
    v_dot2_f32_bf16 v85, v182, s94, v85
    v_dot2_f32_bf16 v86, v183, s93, v86
    v_dot2_f32_bf16 v87, v183, s94, v87
    s_add_u32 m0, s100, 90112
    s_add_u32 s90, s3, 90112
    buffer_load_dwordx4 v1, s[52:55], s90 offen offset:0 sc1 lds
    s_waitcnt vmcnt(6)
    v_dot2_f32_bf16 v80, v184, s93, v80
    v_dot2_f32_bf16 v81, v184, s94, v81
    v_dot2_f32_bf16 v82, v185, s93, v82
    v_dot2_f32_bf16 v83, v185, s94, v83
    v_dot2_f32_bf16 v84, v186, s93, v84
    v_dot2_f32_bf16 v85, v186, s94, v85
    v_dot2_f32_bf16 v86, v187, s93, v86
    v_dot2_f32_bf16 v87, v187, s94, v87
    buffer_load_dwordx4 v1, s[52:55], s90 offen offset:1024 sc1 lds
    s_waitcnt vmcnt(6)
    v_dot2_f32_bf16 v80, v188, s93, v80
    v_dot2_f32_bf16 v81, v188, s94, v81
    v_dot2_f32_bf16 v82, v189, s93, v82
    v_dot2_f32_bf16 v83, v189, s94, v83
    v_dot2_f32_bf16 v84, v190, s93, v84
    v_dot2_f32_bf16 v85, v190, s94, v85
    v_dot2_f32_bf16 v86, v191, s93, v86
    v_dot2_f32_bf16 v87, v191, s94, v87
    buffer_load_dwordx4 v1, s[52:55], s90 offen offset:2048 sc1 lds
    v_cvt_pk_bf16_f32 v88, v80, v81
    v_cvt_pk_bf16_f32 v89, v82, v83
    v_cvt_pk_bf16_f32 v90, v84, v85
    v_cvt_pk_bf16_f32 v91, v86, v87
    ds_write_b64 v103, v[88:89] offset:0
    ds_write_b64 v103, v[90:91] offset:256
    s_waitcnt lgkmcnt(0)
    s_barrier
    ds_read_b128 a[128:131], v102 offset:32768
    ds_read_b128 a[132:135], v102 offset:33792
    ds_read_b128 a[136:139], v102 offset:34816
    ds_read_b128 a[140:143], v102 offset:35840
    s_waitcnt lgkmcnt(3)
    v_mfma_f32_32x32x16_bf16 v[32:47], a[128:131], v[104:107], 0
    s_waitcnt lgkmcnt(2)
    v_mfma_f32_32x32x16_bf16 v[32:47], a[132:135], v[108:111], v[32:47]
    s_waitcnt lgkmcnt(1)
    v_mfma_f32_32x32x16_bf16 v[32:47], a[136:139], v[112:115], v[32:47]
    s_waitcnt lgkmcnt(0)
    v_mfma_f32_32x32x16_bf16 v[32:47], a[140:143], v[116:119], v[32:47]
    s_nop 11
    v_mov_b32 v120, v44
    v_mov_b32 v121, v44
    s_add_u32 s90, s69, 1048576
    s_sub_u32 s91, s90, 4096
    v_permlane32_swap_b32 v120, v121
    v_add_f32 v121, 0x358637bd, v121
    v_rcp_f32 v120, v121
    s_nop 0
    v_pk_mul_f32 v[32:33], v[32:33], v[120:121] op_sel:[0,0] op_sel_hi:[1,0]
    v_pk_mul_f32 v[34:35], v[34:35], v[120:121] op_sel:[0,0] op_sel_hi:[1,0]
    v_pk_mul_f32 v[36:37], v[36:37], v[120:121] op_sel:[0,0] op_sel_hi:[1,0]
    v_pk_mul_f32 v[38:39], v[38:39], v[120:121] op_sel:[0,0] op_sel_hi:[1,0]
    v_cvt_pk_bf16_f32 v88, v32, v33
    v_cvt_pk_bf16_f32 v89, v34, v35
    v_cvt_pk_bf16_f32 v90, v36, v37
    v_cvt_pk_bf16_f32 v91, v38, v39
    buffer_store_dwordx4 v[88:91], v1, s[52:55], s90 offen sc1
    v_pk_mul_f32 v[40:41], v[40:41], v[120:121] op_sel:[0,0] op_sel_hi:[1,0]
    v_pk_mul_f32 v[42:43], v[42:43], v[120:121] op_sel:[0,0] op_sel_hi:[1,0]
    v_pk_mul_f32 v[44:45], v[44:45], v[120:121] op_sel:[0,0] op_sel_hi:[1,0]
    v_pk_mul_f32 v[46:47], v[46:47], v[120:121] op_sel:[0,0] op_sel_hi:[1,0]
    v_cvt_pk_bf16_f32 v92, v40, v41
    v_cvt_pk_bf16_f32 v93, v42, v43
    v_cvt_pk_bf16_f32 v94, v44, v45
    v_cvt_pk_bf16_f32 v95, v46, v47
    s_mov_b64 exec, s[82:83]
    buffer_store_dwordx4 v[92:95], v1, s[52:55], s90 offen offset:1024 sc1
    s_mov_b64 exec, s[80:81]
    buffer_store_dwordx2 v[92:93], v5, s[52:55], s91 offen offset:1536 sc1
    s_mov_b64 exec, -1
    s_waitcnt vmcnt(0)
    s_mov_b32 s101, s56
    s_atomic_add s101, s[64:65], 0 glc
    s_add_u32 m0, s100, 0
    s_add_u32 s90, s3, 1835008
    buffer_load_dwordx4 v1, s[52:55], s90 offen offset:0 sc1 lds
    buffer_load_dwordx4 v1, s[52:55], s90 offen offset:1024 sc1 lds
    buffer_load_dwordx4 v1, s[52:55], s90 offen offset:2048 sc1 lds
    buffer_load_dwordx4 v1, s[52:55], s90 offen offset:3072 sc1 lds
    s_add_u32 m0, s100, 4096
    s_add_u32 s90, s3, 1839104
    buffer_load_dwordx4 v1, s[52:55], s90 offen offset:0 sc1 lds
    buffer_load_dwordx4 v1, s[52:55], s90 offen offset:1024 sc1 lds
    buffer_load_dwordx4 v1, s[52:55], s90 offen offset:2048 sc1 lds
    s_add_u32 m0, s100, 28672
    s_add_u32 s90, s3, 1863680
    buffer_load_dwordx4 v1, s[52:55], s90 offen offset:0 sc1 lds
    buffer_load_dwordx4 v1, s[52:55], s90 offen offset:1024 sc1 lds
    buffer_load_dwordx4 v1, s[52:55], s90 offen offset:2048 sc1 lds
    buffer_load_dwordx4 v1, s[52:55], s90 offen offset:3072 sc1 lds
    s_add_u32 m0, s100, 32768
    s_add_u32 s90, s3, 1867776
    buffer_load_dwordx4 v1, s[52:55], s90 offen offset:0 sc1 lds
    buffer_load_dwordx4 v1, s[52:55], s90 offen offset:1024 sc1 lds
    buffer_load_dwordx4 v1, s[52:55], s90 offen offset:2048 sc1 lds
    s_barrier
    s_add_u32 m0, s100, 57344
    s_add_u32 s90, s3, 1892352
    buffer_load_dwordx4 v1, s[52:55], s90 offen offset:0 sc1 lds
    buffer_load_dwordx4 v1, s[52:55], s90 offen offset:1024 sc1 lds
    buffer_load_dwordx4 v1, s[52:55], s90 offen offset:2048 sc1 lds
    buffer_load_dwordx4 v1, s[52:55], s90 offen offset:3072 sc1 lds
    s_add_u32 m0, s100, 61440
    s_add_u32 s90, s3, 1896448
    buffer_load_dwordx4 v1, s[52:55], s90 offen offset:0 sc1 lds
    buffer_load_dwordx4 v1, s[52:55], s90 offen offset:1024 sc1 lds
    buffer_load_dwordx4 v1, s[52:55], s90 offen offset:2048 sc1 lds
    s_mov_b64 vcc, -1
    s_cmp_eq_u32 s62, 0
    s_cbranch_scc1 L_page_4
    s_cmp_eq_u32 s62, 1
    s_cbranch_scc1 L_page_5
    s_cmp_eq_u32 s62, 2
    s_cbranch_scc1 L_page_6
    s_branch L_page_7
L_page_ret1:
    s_mov_b64 vcc, 0
    v_mov_b32 v80, 0
    v_mov_b32 v81, 0
    v_mov_b32 v82, 0
    v_mov_b32 v83, 0
    s_mov_b32 exec_lo, 0x00020001
    s_mov_b32 exec_hi, 0x00020001
    v_mov_b32 v80, 0x3f803f80
    v_mov_b32 v81, 0x3f803f80
    v_mov_b32 v82, 0x3f803f80
    v_mov_b32 v83, 0x3f803f80
    s_mov_b64 exec, -1
    v_add_u32 v84, s100, v1
    v_add_u32 v85, 57344, v84
    v_and_b32 v86, 31, v0
    s_mul_i32 s90, s62, 384
    s_add_u32 s90, s90, 159744
    v_lshl_add_u32 v86, v86, 2, s90
    s_add_u32 s72, s68, 1048576
    s_xor_b32 s73, s72, 4096
    s_xor_b32 s74, s72, 8192
    s_xor_b32 s75, s72, 12288
    s_xor_b32 s76, s72, 16384
    s_xor_b32 s77, s72, 20480
    s_xor_b32 s78, s72, 24576
    s_xor_b32 s79, s72, 28672
    ds_read_b128 a[128:131], v2 offset:28672
    ds_read_b128 a[132:135], v2 offset:29696
    ds_read_b128 a[136:139], v2 offset:30720
    ds_read_b128 a[140:143], v2 offset:31744
    ds_read_b128 a[144:147], v2 offset:32768
    s_waitcnt lgkmcnt(0)
    s_add_u32 s101, s101, s56
    s_waitcnt lgkmcnt(0)
    s_add_u32 s89, s101, 0x7c7c7c7c
    s_and_b32 s89, s89, 0x80808080
    s_cmp_eq_u32 s89, 0x80808080
    s_cbranch_scc1 L_go_5
L_poll_4:
    s_mov_b32 s101, 0
    s_atomic_add s101, s[64:65], 0 glc
    s_sub_u32 s63, s63, 1
    s_cbranch_scc1 L_go_5_to
    s_waitcnt lgkmcnt(0)
    s_add_u32 s89, s101, 0x7c7c7c7c
    s_and_b32 s89, s89, 0x80808080
    s_cmp_eq_u32 s89, 0x80808080
    s_cbranch_scc0 L_poll_4
    s_branch L_go_5
L_go_5_to:
    s_mov_b32 s63, 0
    s_waitcnt lgkmcnt(0)
L_go_5:
    buffer_load_dwordx4 v[128:131], v1, s[52:55], s72 offen offset:0 sc1
    buffer_load_dwordx4 v[132:135], v1, s[52:55], s72 offen offset:2048 sc1
L_page_2:
    s_cbranch_vccnz L_page_ret0
    buffer_load_dwordx4 v[136:139], v1, s[52:55], s73 offen offset:0 sc1
    buffer_load_dwordx4 v[140:143], v1, s[52:55], s73 offen offset:2048 sc1
    buffer_load_dwordx4 v[144:147], v10, s[52:55], s72 offen offset:1024 sc1
    buffer_load_dwordx4 v[148:151], v10, s[52:55], s73 offen offset:1024 sc1
    buffer_load_dwordx2 v[154:155], v5, s[52:55], s72 offen offset:1536 sc1
    buffer_load_dwordx2 v[156:157], v5, s[52:55], s72 offen offset:3584 sc1
    buffer_load_dwordx2 v[186:187], v5, s[52:55], s74 offen offset:1536 sc1
    buffer_load_dwordx2 v[188:189], v5, s[52:55], s74 offen offset:3584 sc1
    buffer_load_dwordx2 v[218:219], v5, s[52:55], s76 offen offset:1536 sc1
    buffer_load_dwordx2 v[220:221], v5, s[52:55], s76 offen offset:3584 sc1
    buffer_load_dwordx2 v[250:251], v5, s[52:55], s78 offen offset:1536 sc1
    buffer_load_dwordx2 v[252:253], v5, s[52:55], s78 offen offset:3584 sc1
    s_waitcnt vmcnt(13)
    v_mfma_f32_32x32x16_bf16 v[16:31], a[128:131], v[128:131], v[16:31]
    ds_read_b128 a[148:151], v2 offset:33792
    buffer_load_dwordx4 v[160:163], v1, s[52:55], s74 offen offset:0 sc1
    buffer_load_dwordx4 v[164:167], v1, s[52:55], s74 offen offset:2048 sc1
    s_barrier
    ds_read_b128 a[0:3], v84 offset:0
    ds_read_b128 a[4:7], v84 offset:28672
    ds_read_b128 a[8:11], v85 offset:0
    s_waitcnt vmcnt(14)
    v_mfma_f32_32x32x16_bf16 v[16:31], a[132:135], v[132:135], v[16:31]
    ds_read_b128 a[152:155], v2 offset:34816
    buffer_load_dwordx4 v[168:171], v1, s[52:55], s75 offen offset:0 sc1
    buffer_load_dwordx4 v[172:175], v1, s[52:55], s75 offen offset:2048 sc1
    s_waitcnt lgkmcnt(3)
    v_mfma_f32_16x16x32_bf16 v[32:35], v[80:83], a[0:3], 0
    ds_read_b128 a[12:15], v84 offset:1024
    s_waitcnt vmcnt(15)
    v_mfma_f32_32x32x16_bf16 v[16:31], a[136:139], v[136:139], v[16:31]
    ds_read_b128 a[156:159], v2 offset:41984
    buffer_load_dwordx4 v[176:179], v10, s[52:55], s74 offen offset:1024 sc1
    s_waitcnt lgkmcnt(4)
    v_mfma_f32_16x16x32_bf16 v[48:51], v[80:83], a[4:7], 0
    ds_read_b128 a[16:19], v84 offset:29696
    s_waitcnt vmcnt(15)
    v_mfma_f32_32x32x16_bf16 v[16:31], a[140:143], v[140:143], v[16:31]
    ds_read_b128 a[128:131], v2 offset:49152
    buffer_load_dwordx4 v[180:183], v10, s[52:55], s75 offen offset:1024 sc1
    s_waitcnt lgkmcnt(5)
    v_mfma_f32_16x16x32_bf16 v[64:67], v[80:83], a[8:11], 0
    ds_read_b128 a[20:23], v85 offset:1024
    s_waitcnt vmcnt(15)
    v_mfma_f32_32x32x16_bf16 v[16:31], a[144:147], v[144:147], v[16:31]
    ds_read_b128 a[132:135], v2 offset:56320
    buffer_load_dwordx4 v[192:195], v1, s[52:55], s76 offen offset:0 sc1
    s_waitcnt lgkmcnt(5)
    v_mfma_f32_16x16x32_bf16 v[32:35], v[80:83], a[12:15], v[32:35]
    ds_read_b128 a[24:27], v84 offset:2048
    s_waitcnt vmcnt(15)
    v_mfma_f32_32x32x16_bf16 v[16:31], a[148:151], v[148:151], v[16:31]
    ds_read_b128 a[136:139], v2 offset:35840
    buffer_load_dwordx4 v[196:199], v1, s[52:55], s76 offen offset:2048 sc1
    s_waitcnt lgkmcnt(5)
    v_mfma_f32_16x16x32_bf16 v[48:51], v[80:83], a[16:19], v[48:51]
    ds_read_b128 a[28:31], v84 offset:30720
    s_waitcnt vmcnt(14)
    v_mfma_f32_32x32x16_bf16 v[16:31], a[152:155], v[154:157], v[16:31]
    ds_read_b128 a[140:143], v2 offset:36864
    buffer_load_dwordx4 v[200:203], v1, s[52:55], s77 offen offset:0 sc1
    s_waitcnt lgkmcnt(5)
    v_mfma_f32_16x16x32_bf16 v[64:67], v[80:83], a[20:23], v[64:67]
    ds_read_b128 a[0:3], v85 offset:2048
    s_waitcnt vmcnt(13)
    v_mfma_f32_32x32x16_bf16 v[16:31], a[156:159], v[186:189], v[16:31]
    ds_read_b128 a[144:147], v2 offset:37888
    buffer_load_dwordx4 v[204:207], v1, s[52:55], s77 offen offset:2048 sc1
    s_waitcnt lgkmcnt(5)
    v_mfma_f32_16x16x32_bf16 v[32:35], v[80:83], a[24:27], v[32:35]
    ds_read_b128 a[4:7], v84 offset:3072
    s_waitcnt vmcnt(12)
    v_mfma_f32_32x32x16_bf16 v[16:31], a[128:131], v[218:221], v[16:31]
    ds_read_b128 a[148:151], v2 offset:38912
    buffer_load_dwordx4 v[208:211], v10, s[52:55], s76 offen offset:1024 sc1
    s_waitcnt lgkmcnt(5)
    v_mfma_f32_16x16x32_bf16 v[48:51], v[80:83], a[28:31], v[48:51]
    ds_read_b128 a[8:11], v84 offset:31744
    s_waitcnt vmcnt(11)
    v_mfma_f32_32x32x16_bf16 v[16:31], a[132:135], v[250:253], v[16:31]
    ds_read_b128 a[152:155], v2 offset:39936
    buffer_load_dwordx4 v[212:215], v10, s[52:55], s77 offen offset:1024 sc1
    s_waitcnt lgkmcnt(5)
    v_mfma_f32_16x16x32_bf16 v[64:67], v[80:83], a[0:3], v[64:67]
    ds_read_b128 a[12:15], v85 offset:3072
    s_waitcnt vmcnt(11)
    v_mfma_f32_32x32x16_bf16 v[16:31], a[136:139], v[160:163], v[16:31]
    ds_read_b128 a[156:159], v2 offset:40960
    buffer_load_dwordx4 v[224:227], v1, s[52:55], s78 offen offset:0 sc1
    s_waitcnt lgkmcnt(5)
    v_mfma_f32_16x16x32_bf16 v[32:35], v[80:83], a[4:7], v[32:35]
    ds_read_b128 a[16:19], v84 offset:4096
    s_waitcnt vmcnt(11)
    v_mfma_f32_32x32x16_bf16 v[16:31], a[140:143], v[164:167], v[16:31]
    ds_read_b128 a[128:131], v2 offset:43008
    buffer_load_dwordx4 v[228:231], v1, s[52:55], s78 offen offset:2048 sc1
    s_waitcnt lgkmcnt(5)
    v_mfma_f32_16x16x32_bf16 v[48:51], v[80:83], a[8:11], v[48:51]
    ds_read_b128 a[20:23], v84 offset:32768
    s_waitcnt vmcnt(11)
    v_mfma_f32_32x32x16_bf16 v[16:31], a[144:147], v[168:171], v[16:31]
    ds_read_b128 a[132:135], v2 offset:44032
    buffer_load_dwordx4 v[232:235], v1, s[52:55], s79 offen offset:0 sc1
    s_waitcnt lgkmcnt(5)
    v_mfma_f32_16x16x32_bf16 v[64:67], v[80:83], a[12:15], v[64:67]
    ds_read_b128 a[24:27], v85 offset:4096
    s_waitcnt vmcnt(11)
    v_mfma_f32_32x32x16_bf16 v[16:31], a[148:151], v[172:175], v[16:31]
    ds_read_b128 a[136:139], v2 offset:45056
    buffer_load_dwordx4 v[236:239], v1, s[52:55], s79 offen offset:2048 sc1
    s_waitcnt lgkmcnt(5)
    v_mfma_f32_16x16x32_bf16 v[32:35], v[80:83], a[16:19], v[32:35]
    ds_read_b128 a[28:31], v84 offset:5120
    s_waitcnt vmcnt(11)
    v_mfma_f32_32x32x16_bf16 v[16:31], a[152:155], v[176:179], v[16:31]
    ds_read_b128 a[140:143], v2 offset:46080
    buffer_load_dwordx4 v[240:243], v10, s[52:55], s78 offen offset:1024 sc1
    s_waitcnt lgkmcnt(5)
    v_mfma_f32_16x16x32_bf16 v[48:51], v[80:83], a[20:23], v[48:51]
    ds_read_b128 a[0:3], v84 offset:33792
    s_waitcnt vmcnt(11)
    v_mfma_f32_32x32x16_bf16 v[16:31], a[156:159], v[180:183], v[16:31]
    ds_read_b128 a[144:147], v2 offset:47104
    buffer_load_dwordx4 v[244:247], v10, s[52:55], s79 offen offset:1024 sc1
    s_waitcnt lgkmcnt(5)
    v_mfma_f32_16x16x32_bf16 v[64:67], v[80:83], a[24:27], v[64:67]
    ds_read_b128 a[4:7], v85 offset:5120
    s_waitcnt vmcnt(11)
    v_mfma_f32_32x32x16_bf16 v[16:31], a[128:131], v[192:195], v[16:31]
    ds_read_b128 a[148:151], v2 offset:48128
    s_waitcnt lgkmcnt(5)
    v_mfma_f32_16x16x32_bf16 v[32:35], v[80:83], a[28:31], v[32:35]
    ds_read_b128 a[8:11], v84 offset:6144
    s_waitcnt vmcnt(10)
    v_mfma_f32_32x32x16_bf16 v[16:31], a[132:135], v[196:199], v[16:31]
    ds_read_b128 a[152:155], v2 offset:50176
    s_waitcnt lgkmcnt(5)
    v_mfma_f32_16x16x32_bf16 v[48:51], v[80:83], a[0:3], v[48:51]
    ds_read_b128 a[12:15], v84 offset:34816
    s_waitcnt vmcnt(9)
    v_mfma_f32_32x32x16_bf16 v[16:31], a[136:139], v[200:203], v[16:31]
    ds_read_b128 a[156:159], v2 offset:51200
    s_waitcnt lgkmcnt(5)
    v_mfma_f32_16x16x32_bf16 v[64:67], v[80:83], a[4:7], v[64:67]
    ds_read_b128 a[16:19], v85 offset:6144
    s_waitcnt vmcnt(8)
    v_mfma_f32_32x32x16_bf16 v[16:31], a[140:143], v[204:207], v[16:31]
    ds_read_b128 a[128:131], v2 offset:52224
    s_waitcnt lgkmcnt(5)
    v_mfma_f32_16x16x32_bf16 v[32:35], v[80:83], a[8:11], v[32:35]
    s_waitcnt vmcnt(7)
    v_mfma_f32_32x32x16_bf16 v[16:31], a[144:147], v[208:211], v[16:31]
    ds_read_b128 a[132:135], v2 offset:53248
    s_waitcnt lgkmcnt(4)
    v_mfma_f32_16x16x32_bf16 v[48:51], v[80:83], a[12:15], v[48:51]
    s_waitcnt vmcnt(6)
    v_mfma_f32_32x32x16_bf16 v[16:31], a[148:151], v[212:215], v[16:31]
    ds_read_b128 a[136:139], v2 offset:54272
    s_waitcnt lgkmcnt(3)
    v_mfma_f32_16x16x32_bf16 v[64:67], v[80:83], a[16:19], v[64:67]
    s_waitcnt vmcnt(5)
    v_mfma_f32_32x32x16_bf16 v[16:31], a[152:155], v[224:227], v[16:31]
    ds_read_b128 a[140:143], v2 offset:55296
    s_waitcnt vmcnt(4)
    v_mfma_f32_32x32x16_bf16 v[16:31], a[156:159], v[228:231], v[16:31]
    s_waitcnt vmcnt(3) lgkmcnt(3)
    v_mfma_f32_32x32x16_bf16 v[16:31], a[128:131], v[232:235], v[16:31]
    s_waitcnt vmcnt(2) lgkmcnt(2)
    v_mfma_f32_32x32x16_bf16 v[16:31], a[132:135], v[236:239], v[16:31]
    s_mov_b64 exec, 0xffff
    ds_write2_b32 v86, v32, v33 offset0:0 offset1:16
    s_mov_b64 exec, -1
    s_mov_b64 exec, 0xffff
    ds_write2_b32 v86, v48, v49 offset0:32 offset1:48
    s_mov_b64 exec, -1
    s_mov_b64 exec, 0xffff
    ds_write2_b32 v86, v64, v65 offset0:64 offset1:80
    s_mov_b64 exec, -1
    s_waitcnt vmcnt(1) lgkmcnt(4)
    v_mfma_f32_32x32x16_bf16 v[16:31], a[136:139], v[240:243], v[16:31]
    s_waitcnt vmcnt(0) lgkmcnt(3)
    v_mfma_f32_32x32x16_bf16 v[16:31], a[140:143], v[244:247], v[16:31]
    s_waitcnt lgkmcnt(0)
    s_add_u32 s90, s69, 3145728
    s_nop 9
    v_cvt_pk_bf16_f32 v88, v16, v17
    v_cvt_pk_bf16_f32 v89, v18, v19
    v_cvt_pk_bf16_f32 v90, v20, v21
    v_cvt_pk_bf16_f32 v91, v22, v23
    buffer_store_dwordx4 v[88:91], v1, s[52:55], s90 offen sc1
    v_pk_add_f32 v[104:105], v[16:17], v[18:19]
    v_pk_mul_f32 v[106:107], v[16:17], v[16:17]
    v_pk_fma_f32 v[106:107], v[18:19], v[18:19], v[106:107]
    v_pk_add_f32 v[104:105], v[104:105], v[20:21]
    v_pk_fma_f32 v[106:107], v[20:21], v[20:21], v[106:107]
    v_pk_add_f32 v[104:105], v[104:105], v[22:23]
    v_pk_fma_f32 v[106:107], v[22:23], v[22:23], v[106:107]
    v_pk_add_f32 v[104:105], v[104:105], v[24:25]
    v_pk_fma_f32 v[106:107], v[24:25], v[24:25], v[106:107]
    v_pk_add_f32 v[104:105], v[104:105], v[26:27]
    v_pk_fma_f32 v[106:107], v[26:27], v[26:27], v[106:107]
    s_mov_b64 exec, s[82:83]
    v_pk_add_f32 v[104:105], v[104:105], v[28:29]
    v_pk_fma_f32 v[106:107], v[28:29], v[28:29], v[106:107]
    v_pk_add_f32 v[104:105], v[104:105], v[30:31]
    v_pk_fma_f32 v[106:107], v[30:31], v[30:31], v[106:107]
    s_mov_b64 exec, -1
    v_add_f32 v104, v104, v105
    v_add_f32 v106, v106, v107
    v_cvt_pk_bf16_f32 v92, v24, v25
    v_cvt_pk_bf16_f32 v93, v26, v27
    v_cvt_pk_bf16_f32 v94, v28, v29
    v_cvt_pk_bf16_f32 v95, v30, v31
    v_permlane32_swap_b32 v105, v104
    v_permlane32_swap_b32 v107, v106
    s_mov_b64 exec, s[80:81]
    v_add_f32 v94, v104, v105
    v_add_f32 v95, v106, v107
    s_mov_b64 exec, s[86:87]
    v_swap_b32 v92, v94
    v_swap_b32 v93, v95
    s_mov_b64 exec, -1
    buffer_store_dwordx4 v[92:95], v1, s[52:55], s90 offen offset:1024 sc1
    s_waitcnt vmcnt(0)
    s_mov_b32 s101, s56
    s_atomic_add s101, s[64:65], 0 glc
    s_barrier
    s_add_u32 m0, s100, 86016
    s_add_u32 s90, s3, 1921024
    buffer_load_dwordx4 v1, s[52:55], s90 offen offset:0 sc1 lds
    buffer_load_dwordx4 v1, s[52:55], s90 offen offset:1024 sc1 lds
    buffer_load_dwordx4 v1, s[52:55], s90 offen offset:2048 sc1 lds
    buffer_load_dwordx4 v1, s[52:55], s90 offen offset:3072 sc1 lds
    s_add_u32 m0, s100, 90112
    s_add_u32 s90, s3, 1925120
    buffer_load_dwordx4 v1, s[52:55], s90 offen offset:0 sc1 lds
    buffer_load_dwordx4 v1, s[52:55], s90 offen offset:1024 sc1 lds
    buffer_load_dwordx4 v1, s[52:55], s90 offen offset:2048 sc1 lds
    v_and_b32 v84, 31, v0
    v_lshlrev_b32 v84, 2, v84
    v_add_u32 v84, 159744, v84
    ds_read_b32 v88, v84 offset:0
    ds_read_b32 v89, v84 offset:384
    ds_read_b32 v90, v84 offset:768
    ds_read_b32 v91, v84 offset:1152
    ds_read_b32 v92, v84 offset:128
    ds_read_b32 v93, v84 offset:512
    ds_read_b32 v94, v84 offset:896
    ds_read_b32 v95, v84 offset:1280
    ds_read_b32 v96, v84 offset:256
    ds_read_b32 v97, v84 offset:640
    ds_read_b32 v98, v84 offset:1024
    ds_read_b32 v99, v84 offset:1408
    s_waitcnt lgkmcnt(10)
    v_add_f32 v88, v88, v89
    s_waitcnt lgkmcnt(8)
    v_add_f32 v90, v90, v91
    v_add_f32 v88, v88, v90
    v_cvt_pk_bf16_f32 v89, v88, v88
    v_and_b32 v90, 0xffff0000, v89
    v_sub_f32 v90, v88, v90
    v_cvt_pk_bf16_f32 v90, v90, 0
    v_accvgpr_write_b32 a166, v89
    v_accvgpr_write_b32 a167, v90
    s_waitcnt lgkmcnt(6)
    v_add_f32 v92, v92, v93
    s_waitcnt lgkmcnt(4)
    v_add_f32 v94, v94, v95
    v_add_f32 v92, v92, v94
    v_cvt_pk_bf16_f32 v93, v92, v92
    v_and_b32 v94, 0xffff0000, v93
    v_sub_f32 v94, v92, v94
    v_cvt_pk_bf16_f32 v94, v94, 0
    v_accvgpr_write_b32 a168, v93
    v_accvgpr_write_b32 a169, v94
    s_waitcnt lgkmcnt(2)
    v_add_f32 v96, v96, v97
    s_waitcnt lgkmcnt(0)
    v_add_f32 v98, v98, v99
    v_add_f32 v96, v96, v98
    v_cvt_pk_bf16_f32 v97, v96, v96
    v_and_b32 v98, 0xffff0000, v97
    v_sub_f32 v98, v96, v98
    v_cvt_pk_bf16_f32 v98, v98, 0
    v_accvgpr_write_b32 a170, v97
    v_accvgpr_write_b32 a171, v98
    s_add_u32 s72, s68, 3145728
    s_xor_b32 s73, s72, 4096
    s_xor_b32 s74, s72, 8192
    s_xor_b32 s75, s72, 12288
    s_xor_b32 s76, s72, 16384
    s_xor_b32 s77, s72, 20480
    s_xor_b32 s78, s72, 24576
    s_xor_b32 s79, s72, 28672
    ds_read_b128 a[128:131], v1 offset:0
    ds_read_b128 a[132:135], v1 offset:28672
    ds_read_b128 a[136:139], v1 offset:1024
    ds_read_b128 a[140:143], v1 offset:29696
    ds_read_b128 a[144:147], v1 offset:2048
    ds_read_b128 a[148:151], v1 offset:30720
    s_add_u32 s101, s101, s56
    s_waitcnt lgkmcnt(0)
    s_add_u32 s89, s101, 0x78787878
    s_and_b32 s89, s89, 0x80808080
    s_cmp_eq_u32 s89, 0x80808080
    s_cbranch_scc1 L_go_7
L_poll_6:
    s_mov_b32 s101, 0
    s_atomic_add s101, s[64:65], 0 glc
    s_sub_u32 s63, s63, 1
    s_cbranch_scc1 L_go_7_to
    s_waitcnt lgkmcnt(0)
    s_add_u32 s89, s101, 0x78787878
    s_and_b32 s89, s89, 0x80808080
    s_cmp_eq_u32 s89, 0x80808080
    s_cbranch_scc0 L_poll_6
    s_branch L_go_7
L_go_7_to:
    s_mov_b32 s63, 0
    s_waitcnt lgkmcnt(0)
L_go_7:
    buffer_load_dwordx4 v[128:131], v1, s[52:55], s72 offen offset:0 sc1
    buffer_load_dwordx4 v[132:135], v1, s[52:55], s72 offen offset:2048 sc1
    buffer_load_dwordx4 v[136:139], v1, s[52:55], s73 offen offset:0 sc1
    buffer_load_dwordx4 v[140:143], v1, s[52:55], s73 offen offset:2048 sc1
    buffer_load_dwordx4 v[144:147], v10, s[52:55], s72 offen offset:1024 sc1
    buffer_load_dwordx4 v[148:151], v10, s[52:55], s73 offen offset:1024 sc1
    buffer_load_dwordx4 v[152:155], v11, s[52:55], s72 offen offset:1536 sc1
    buffer_load_dwordx4 v[156:159], v11, s[52:55], s72 offen offset:3584 sc1
    buffer_load_dwordx4 v[184:187], v11, s[52:55], s74 offen offset:1536 sc1
    buffer_load_dwordx4 v[188:191], v11, s[52:55], s74 offen offset:3584 sc1
    s_waitcnt vmcnt(9)
    v_mfma_f32_32x32x16_bf16 v[32:47], a[128:131], v[128:131], 0
    ds_read_b128 a[152:155], v1 offset:3072
    ds_read_b128 a[156:159], v1 offset:31744
    buffer_load_dwordx4 v[216:219], v11, s[52:55], s76 offen offset:1536 sc1
    buffer_load_dwordx4 v[220:223], v11, s[52:55], s76 offen offset:3584 sc1
    v_mfma_f32_32x32x16_bf16 v[48:63], v[128:131], a[132:135], 0
    s_waitcnt vmcnt(10)
    v_mfma_f32_32x32x16_bf16 v[32:47], a[136:139], v[132:135], v[32:47]
    ds_read_b128 a[128:131], v1 offset:4096
    ds_read_b128 a[132:135], v1 offset:32768
    buffer_load_dwordx4 v[248:251], v11, s[52:55], s78 offen offset:1536 sc1
    buffer_load_dwordx4 v[252:255], v11, s[52:55], s78 offen offset:3584 sc1
    v_mfma_f32_32x32x16_bf16 v[48:63], v[132:135], a[140:143], v[48:63]
    s_waitcnt vmcnt(11)
    v_mfma_f32_32x32x16_bf16 v[32:47], a[144:147], v[136:139], v[32:47]
    ds_read_b128 a[136:139], v1 offset:5120
    ds_read_b128 a[140:143], v1 offset:33792
    buffer_load_dwordx4 v[160:163], v1, s[52:55], s74 offen offset:0 sc1
    buffer_load_dwordx4 v[164:167], v1, s[52:55], s74 offen offset:2048 sc1
    v_mfma_f32_32x32x16_bf16 v[48:63], v[136:139], a[148:151], v[48:63]
    s_waitcnt vmcnt(12) lgkmcnt(4)
    v_mfma_f32_32x32x16_bf16 v[32:47], a[152:155], v[140:143], v[32:47]
    ds_read_b128 a[144:147], v1 offset:6144
    ds_read_b128 a[148:151], v1 offset:34816
    buffer_load_dwordx4 v[168:171], v1, s[52:55], s75 offen offset:0 sc1
    buffer_load_dwordx4 v[172:175], v1, s[52:55], s75 offen offset:2048 sc1
    v_mfma_f32_32x32x16_bf16 v[48:63], v[140:143], a[156:159], v[48:63]
    s_waitcnt vmcnt(13) lgkmcnt(4)
    v_mfma_f32_32x32x16_bf16 v[32:47], a[128:131], v[144:147], v[32:47]
    ds_read_b128 a[152:155], v1 offset:13312
    ds_read_b128 a[156:159], v1 offset:41984
    buffer_load_dwordx4 v[176:179], v10, s[52:55], s74 offen offset:1024 sc1
    v_mfma_f32_32x32x16_bf16 v[48:63], v[144:147], a[132:135], v[48:63]
    s_waitcnt vmcnt(13) lgkmcnt(4)
    v_mfma_f32_32x32x16_bf16 v[32:47], a[136:139], v[148:151], v[32:47]
    ds_read_b128 a[128:131], v1 offset:20480
    ds_read_b128 a[132:135], v1 offset:49152
    buffer_load_dwordx4 v[180:183], v10, s[52:55], s75 offen offset:1024 sc1
    v_mfma_f32_32x32x16_bf16 v[48:63], v[148:151], a[140:143], v[48:63]
    s_waitcnt vmcnt(12) lgkmcnt(4)
    v_mfma_f32_32x32x16_bf16 v[32:47], a[144:147], v[154:157], v[32:47]
    ds_read_b128 a[136:139], v1 offset:27648
    ds_read_b128 a[140:143], v1 offset:56320
    buffer_load_dwordx4 v[192:195], v1, s[52:55], s76 offen offset:0 sc1
    v_mfma_f32_32x32x16_bf16 v[48:63], v[154:157], a[148:151], v[48:63]
    s_waitcnt vmcnt(11) lgkmcnt(4)
    v_mfma_f32_32x32x16_bf16 v[32:47], a[152:155], v[186:189], v[32:47]
    ds_read_b128 a[144:147], v1 offset:7168
    ds_read_b128 a[148:151], v1 offset:35840
    buffer_load_dwordx4 v[196:199], v1, s[52:55], s76 offen offset:2048 sc1
    v_mfma_f32_32x32x16_bf16 v[48:63], v[186:189], a[156:159], v[48:63]
    s_waitcnt vmcnt(10) lgkmcnt(4)
    v_mfma_f32_32x32x16_bf16 v[32:47], a[128:131], v[218:221], v[32:47]
    ds_read_b128 a[152:155], v1 offset:8192
    ds_read_b128 a[156:159], v1 offset:36864
    buffer_load_dwordx4 v[200:203], v1, s[52:55], s77 offen offset:0 sc1
    v_mfma_f32_32x32x16_bf16 v[48:63], v[218:221], a[132:135], v[48:63]
    s_waitcnt vmcnt(9) lgkmcnt(4)
    v_mfma_f32_32x32x16_bf16 v[32:47], a[136:139], v[250:253], v[32:47]
    ds_read_b128 a[128:131], v1 offset:9216
    ds_read_b128 a[132:135], v1 offset:37888
    buffer_load_dwordx4 v[204:207], v1, s[52:55], s77 offen offset:2048 sc1
    v_mfma_f32_32x32x16_bf16 v[48:63], v[250:253], a[140:143], v[48:63]
    s_waitcnt vmcnt(9) lgkmcnt(4)
    v_mfma_f32_32x32x16_bf16 v[32:47], a[144:147], v[160:163], v[32:47]
    ds_read_b128 a[136:139], v1 offset:10240
    ds_read_b128 a[140:143], v1 offset:38912
    buffer_load_dwordx4 v[208:211], v10, s[52:55], s76 offen offset:1024 sc1
    v_add_f32 v120, v152, v158
    v_add_f32 v121, v153, v159
    v_mfma_f32_32x32x16_bf16 v[48:63], v[160:163], a[148:151], v[48:63]
    v_add_f32 v120, v120, v184
    v_add_f32 v121, v121, v185
    s_waitcnt vmcnt(9) lgkmcnt(4)
    v_mfma_f32_32x32x16_bf16 v[32:47], a[152:155], v[164:167], v[32:47]
    ds_read_b128 a[144:147], v1 offset:11264
    ds_read_b128 a[148:151], v1 offset:39936
    buffer_load_dwordx4 v[212:215], v10, s[52:55], s77 offen offset:1024 sc1
    v_add_f32 v120, v120, v190
    v_add_f32 v121, v121, v191
    v_mfma_f32_32x32x16_bf16 v[48:63], v[164:167], a[156:159], v[48:63]
    v_add_f32 v120, v120, v216
    v_add_f32 v121, v121, v217
    s_waitcnt vmcnt(9) lgkmcnt(4)
    v_mfma_f32_32x32x16_bf16 v[32:47], a[128:131], v[168:171], v[32:47]
    ds_read_b128 a[152:155], v1 offset:12288
    ds_read_b128 a[156:159], v1 offset:40960
    buffer_load_dwordx4 v[224:227], v1, s[52:55], s78 offen offset:0 sc1
    v_add_f32 v120, v120, v222
    v_add_f32 v121, v121, v223
    v_mfma_f32_32x32x16_bf16 v[48:63], v[168:171], a[132:135], v[48:63]
    v_add_f32 v120, v120, v248
    v_add_f32 v121, v121, v249
    s_waitcnt vmcnt(9) lgkmcnt(4)
    v_mfma_f32_32x32x16_bf16 v[32:47], a[136:139], v[172:175], v[32:47]
    ds_read_b128 a[128:131], v1 offset:14336
    ds_read_b128 a[132:135], v1 offset:43008
    buffer_load_dwordx4 v[228:231], v1, s[52:55], s78 offen offset:2048 sc1
    v_add_f32 v120, v120, v254
    v_add_f32 v121, v121, v255
    v_mfma_f32_32x32x16_bf16 v[48:63], v[172:175], a[140:143], v[48:63]
    v_mov_b32 v122, v120
    s_nop 1
    v_permlane32_swap_b32 v122, v120
    s_waitcnt vmcnt(9) lgkmcnt(4)
    v_mfma_f32_32x32x16_bf16 v[32:47], a[144:147], v[176:179], v[32:47]
    ds_read_b128 a[136:139], v1 offset:15360
    ds_read_b128 a[140:143], v1 offset:44032
    buffer_load_dwordx4 v[232:235], v1, s[52:55], s79 offen offset:0 sc1
    v_add_f32 v120, v120, v122
    v_mov_b32 v122, v121
    v_mfma_f32_32x32x16_bf16 v[48:63], v[176:179], a[148:151], v[48:63]
    s_nop 0
    v_permlane32_swap_b32 v122, v121
    v_add_f32 v121, v121, v122
    s_waitcnt vmcnt(9) lgkmcnt(4)
    v_mfma_f32_32x32x16_bf16 v[32:47], a[152:155], v[180:183], v[32:47]
    ds_read_b128 a[144:147], v1 offset:16384
    ds_read_b128 a[148:151], v1 offset:45056
    buffer_load_dwordx4 v[236:239], v1, s[52:55], s79 offen offset:2048 sc1
    v_mul_f32 v120, 0xbb124925, v120
    v_mul_f32 v121, 0x3b124925, v121
    v_mfma_f32_32x32x16_bf16 v[48:63], v[180:183], a[156:159], v[48:63]
    v_fma_f32 v121, -v120, v120, v121
    v_max_f32 v121, 0, v121
    s_waitcnt vmcnt(9) lgkmcnt(4)
    v_mfma_f32_32x32x16_bf16 v[32:47], a[128:131], v[192:195], v[32:47]
    ds_read_b128 a[152:155], v1 offset:17408
    ds_read_b128 a[156:159], v1 offset:46080
    buffer_load_dwordx4 v[240:243], v10, s[52:55], s78 offen offset:1024 sc1
    v_add_f32 v121, 0x3727c5ac, v121
    v_rsq_f32 v124, v121
    v_mfma_f32_32x32x16_bf16 v[48:63], v[192:195], a[132:135], v[48:63]
    v_cndmask_b32 v120, v120, 0, s[80:81]
    v_cvt_pk_bf16_f32 v127, v120, 0
    s_waitcnt vmcnt(9) lgkmcnt(4)
    v_mfma_f32_32x32x16_bf16 v[32:47], a[136:139], v[196:199], v[32:47]
    ds_read_b128 a[128:131], v1 offset:18432
    ds_read_b128 a[132:135], v1 offset:47104
    buffer_load_dwordx4 v[244:247], v10, s[52:55], s79 offen offset:1024 sc1
    v_lshlrev_b32 v122, 16, v127
    v_sub_f32 v122, v120, v122
    v_mfma_f32_32x32x16_bf16 v[48:63], v[196:199], a[140:143], v[48:63]
    v_cvt_pk_bf16_f32 v126, v120, v122
    s_nop 1
    v_mfma_f32_32x32x8_bf16 v[32:47], a[166:167], v[126:127], v[32:47]
    s_waitcnt vmcnt(9) lgkmcnt(4)
    v_mfma_f32_32x32x16_bf16 v[32:47], a[144:147], v[200:203], v[32:47]
    ds_read_b128 a[136:139], v1 offset:19456
    ds_read_b128 a[140:143], v1 offset:48128
    v_mfma_f32_32x32x8_bf16 v[48:63], v[126:127], a[168:169], v[48:63]
    v_and_b32 v122, 31, v0
    v_mfma_f32_32x32x16_bf16 v[48:63], v[200:203], a[148:151], v[48:63]
    s_lshl_b32 s90, s62, 7
    s_add_u32 s90, s90, 161280
    v_lshl_add_u32 v122, v122, 2, s90
    s_waitcnt vmcnt(8) lgkmcnt(4)
    v_mfma_f32_32x32x16_bf16 v[32:47], a[152:155], v[204:207], v[32:47]
    ds_read_b128 a[144:147], v1 offset:21504
    ds_read_b128 a[148:151], v1 offset:50176
    ds_write_b32 v122, v124
    v_lshrrev_b32 v122, 5, v0
    v_mfma_f32_32x32x16_bf16 v[48:63], v[204:207], a[156:159], v[48:63]
    v_lshl_add_u32 v122, v122, 4, s90
    ds_read_b128 v[104:107], v122 offset:0
    s_waitcnt vmcnt(7) lgkmcnt(6)
    v_mfma_f32_32x32x16_bf16 v[32:47], a[128:131], v[208:211], v[32:47]
    ds_read_b128 a[152:155], v1 offset:22528
    ds_read_b128 a[156:159], v1 offset:51200
    ds_read_b128 v[108:111], v122 offset:32
    ds_read_b128 v[112:115], v122 offset:64
    v_mfma_f32_32x32x16_bf16 v[48:63], v[208:211], a[132:135], v[48:63]
    ds_read_b128 v[116:119], v122 offset:96
    v_and_b32 v123, 31, v0
    s_waitcnt vmcnt(6) lgkmcnt(9)
    v_mfma_f32_32x32x16_bf16 v[32:47], a[136:139], v[212:215], v[32:47]
    ds_read_b128 a[128:131], v1 offset:23552
    ds_read_b128 a[132:135], v1 offset:52224
    v_cmp_eq_u32 s[98:99], 28, v123
    v_mov_b32 v123, 0x3f803f80
    v_mfma_f32_32x32x16_bf16 v[48:63], v[212:215], a[140:143], v[48:63]
    v_cndmask_b32 v123, 0, v123, s[98:99]
    s_waitcnt vmcnt(5) lgkmcnt(9)
    v_mfma_f32_32x32x16_bf16 v[32:47], a[144:147], v[224:227], v[32:47]
    ds_read_b128 a[136:139], v1 offset:24576
    ds_read_b128 a[140:143], v1 offset:53248
    v_mfma_f32_32x32x16_bf16 v[48:63], v[224:227], a[148:151], v[48:63]
    s_waitcnt vmcnt(4) lgkmcnt(7)
    v_mfma_f32_32x32x16_bf16 v[32:47], a[152:155], v[228:231], v[32:47]
    ds_read_b128 a[144:147], v1 offset:25600
    ds_read_b128 a[148:151], v1 offset:54272
    v_mfma_f32_32x32x16_bf16 v[48:63], v[228:231], a[156:159], v[48:63]
    s_waitcnt vmcnt(3) lgkmcnt(5)
    v_mfma_f32_32x32x16_bf16 v[32:47], a[128:131], v[232:235], v[32:47]
    ds_read_b128 a[152:155], v1 offset:26624
    ds_read_b128 a[156:159], v1 offset:55296
    s_waitcnt vmcnt(2) lgkmcnt(5)
    v_mfma_f32_32x32x16_bf16 v[32:47], a[136:139], v[236:239], v[32:47]
    s_waitcnt vmcnt(1) lgkmcnt(3)
    v_mfma_f32_32x32x16_bf16 v[32:47], a[144:147], v[240:243], v[32:47]
    s_waitcnt vmcnt(0) lgkmcnt(1)
    v_mfma_f32_32x32x16_bf16 v[32:47], a[152:155], v[244:247], v[32:47]
    v_mfma_f32_32x32x16_bf16 v[48:63], v[232:235], a[132:135], v[48:63]
    v_mfma_f32_32x32x16_bf16 v[48:63], v[236:239], a[140:143], v[48:63]
    s_nop 7
    v_mfma_f32_32x32x16_bf16 v[48:63], v[240:243], a[148:151], v[48:63]
    s_nop 0
    v_mul_f32 v32, v32, v124
    v_mul_f32 v33, v33, v124
    v_cvt_pk_bf16_f32 v80, v32, v33
    v_mul_f32 v34, v34, v124
    v_mul_f32 v35, v35, v124
    v_cvt_pk_bf16_f32 v81, v34, v35
    s_waitcnt lgkmcnt(0)
    v_mfma_f32_32x32x16_bf16 v[48:63], v[244:247], a[156:159], v[48:63]
    v_mul_f32 v36, v36, v124
    v_mul_f32 v37, v37, v124
    v_cvt_pk_bf16_f32 v82, v36, v37
    v_mul_f32 v38, v38, v124
    v_mul_f32 v39, v39, v124
    v_cvt_pk_bf16_f32 v83, v38, v39
    v_mul_f32 v40, v40, v124
    v_mul_f32 v41, v41, v124
    v_cvt_pk_bf16_f32 v84, v40, v41
    v_mul_f32 v42, v42, v124
    v_mul_f32 v43, v43, v124
    v_cvt_pk_bf16_f32 v85, v42, v43
    v_mul_f32 v44, v44, v124
    v_mul_f32 v45, v45, v124
    v_cvt_pk_bf16_f32 v86, v44, v45
    v_mul_f32 v46, v46, v124
    v_mul_f32 v47, v47, v124
    v_cvt_pk_bf16_f32 v87, v46, v47
    s_mov_b64 exec, s[80:81]
    v_mov_b32 v86, 0x3f803f80
    v_mov_b32 v87, 0x00003f80
    s_mov_b64 exec, -1
    s_lshl_b32 s90, s60, 12
    s_add_u32 s90, s90, s70
    s_add_u32 s90, s90, 15728640
    s_mov_b32 s73, s90
    buffer_store_dwordx4 v[80:83], v1, s[52:55], s90 offen sc1
    buffer_store_dwordx4 v[84:87], v1, s[52:55], s90 offen offset:1024 sc1
    v_pk_mul_f32 v[48:49], v[48:49], v[104:105]
    v_pk_mul_f32 v[50:51], v[50:51], v[106:107]
    v_pk_mul_f32 v[52:53], v[52:53], v[108:109]
    v_pk_mul_f32 v[54:55], v[54:55], v[110:111]
    v_pk_mul_f32 v[56:57], v[56:57], v[112:113]
    v_pk_mul_f32 v[58:59], v[58:59], v[114:115]
    v_pk_mul_f32 v[60:61], v[60:61], v[116:117]
    v_pk_mul_f32 v[62:63], v[62:63], v[118:119]
    v_cvt_pk_bf16_f32 v88, v48, v49
    v_cvt_pk_bf16_f32 v89, v50, v51
    v_cvt_pk_bf16_f32 v90, v52, v53
    v_cvt_pk_bf16_f32 v91, v54, v55
    v_cvt_pk_bf16_f32 v92, v56, v57
    v_cvt_pk_bf16_f32 v93, v58, v59
    v_cvt_pk_bf16_f32 v94, v60, v61
    v_cvt_pk_bf16_f32 v95, v62, v63
    s_mov_b64 exec, s[84:85]
    v_mov_b32 v88, v123
    v_mov_b32 v89, v123
    v_mov_b32 v90, v123
    v_mov_b32 v91, v123
    v_mov_b32 v92, v123
    v_mov_b32 v93, v123
    v_mov_b32 v94, v123
    v_mov_b32 v95, v123
    s_mov_b64 exec, -1
    buffer_store_dwordx4 v[88:91], v1, s[52:55], s90 offen offset:2048 sc1
    buffer_store_dwordx4 v[92:95], v1, s[52:55], s90 offen offset:3072 sc1
    ds_read_b128 a[128:131], v2 offset:0
    ds_read_b128 a[132:135], v2 offset:1024
    ds_read_b128 a[136:139], v2 offset:2048
    ds_read_b128 a[140:143], v2 offset:3072
    ds_read_b128 a[144:147], v2 offset:4096
    s_waitcnt lgkmcnt(4)
    v_mfma_f32_32x32x16_bf16 v[64:79], a[128:131], v[128:131], 0
    ds_read_b128 a[148:151], v2 offset:5120
    s_lshl_b32 s90, s62, 11
    v_add_u32 v112, s90, v102
L_page_3:
    s_cbranch_vccnz L_page_ret0
    s_waitcnt lgkmcnt(4)
    v_mfma_f32_32x32x16_bf16 v[64:79], a[132:135], v[132:135], v[64:79]
    ds_read_b128 a[152:155], v2 offset:6144
    s_add_u32 s90, s62, 1
    s_and_b32 s90, s90, 3
    s_waitcnt lgkmcnt(4)
    v_mfma_f32_32x32x16_bf16 v[64:79], a[136:139], v[136:139], v[64:79]
    ds_read_b128 a[156:159], v2 offset:13312
    s_lshl_b32 s91, s90, 11
    v_add_u32 v113, s91, v102
    s_waitcnt lgkmcnt(4)
    v_mfma_f32_32x32x16_bf16 v[64:79], a[140:143], v[140:143], v[64:79]
    ds_read_b128 a[128:131], v2 offset:20480
    s_mul_i32 s91, s90, 12288
    v_add_u32 v117, s91, v1
    s_waitcnt lgkmcnt(4)
    v_mfma_f32_32x32x16_bf16 v[64:79], a[144:147], v[144:147], v[64:79]
    ds_read_b128 a[132:135], v2 offset:27648
    s_add_u32 s90, s62, 2
    s_and_b32 s90, s90, 3
    s_waitcnt lgkmcnt(4)
    v_mfma_f32_32x32x16_bf16 v[64:79], a[148:151], v[148:151], v[64:79]
    ds_read_b128 a[136:139], v2 offset:7168
    s_lshl_b32 s91, s90, 11
    v_add_u32 v114, s91, v102
    s_waitcnt lgkmcnt(4)
    v_mfma_f32_32x32x16_bf16 v[64:79], a[152:155], v[154:157], v[64:79]
    ds_read_b128 a[140:143], v2 offset:8192
    s_mul_i32 s91, s90, 12288
    v_add_u32 v118, s91, v1
    s_waitcnt lgkmcnt(4)
    v_mfma_f32_32x32x16_bf16 v[64:79], a[156:159], v[186:189], v[64:79]
    ds_read_b128 a[144:147], v2 offset:9216
    s_add_u32 s90, s62, 3
    s_and_b32 s90, s90, 3
    s_waitcnt lgkmcnt(4)
    v_mfma_f32_32x32x16_bf16 v[64:79], a[128:131], v[218:221], v[64:79]
    ds_read_b128 a[148:151], v2 offset:10240
    s_lshl_b32 s91, s90, 11
    v_add_u32 v115, s91, v102
    s_waitcnt lgkmcnt(4)
    v_mfma_f32_32x32x16_bf16 v[64:79], a[132:135], v[250:253], v[64:79]
    ds_read_b128 a[152:155], v2 offset:11264
    s_mul_i32 s91, s90, 12288
    v_add_u32 v119, s91, v1
    s_waitcnt lgkmcnt(4)
    v_mfma_f32_32x32x16_bf16 v[64:79], a[136:139], v[160:163], v[64:79]
    ds_read_b128 a[156:159], v2 offset:12288
    s_mul_i32 s91, s62, 12288
    v_add_u32 v116, s91, v1
    s_waitcnt lgkmcnt(4)
    v_mfma_f32_32x32x16_bf16 v[64:79], a[140:143], v[164:167], v[64:79]
    ds_read_b128 a[128:131], v2 offset:14336
    s_lshl_b32 s91, s62, 2
    s_add_u32 s91, s91, 161792
    s_waitcnt lgkmcnt(4)
    v_mfma_f32_32x32x16_bf16 v[64:79], a[144:147], v[168:171], v[64:79]
    ds_read_b128 a[132:135], v2 offset:15360
    v_mov_b32 v120, s91
    v_mov_b32 v121, 161792
    s_waitcnt lgkmcnt(4)
    v_mfma_f32_32x32x16_bf16 v[64:79], a[148:151], v[172:175], v[64:79]
    ds_read_b128 a[136:139], v2 offset:16384
    s_add_u32 s92, s70, 15728640
    v_add_u32 v123, s92, v1
    s_waitcnt vmcnt(0)
    s_atomic_add s57, s[66:67], 0
    s_waitcnt lgkmcnt(4)
    v_mfma_f32_32x32x16_bf16 v[64:79], a[152:155], v[176:179], v[64:79]
    ds_read_b128 a[140:143], v2 offset:17408
    s_waitcnt lgkmcnt(4)
    v_mfma_f32_32x32x16_bf16 v[64:79], a[156:159], v[180:183], v[64:79]
    ds_read_b128 a[144:147], v2 offset:18432
    s_waitcnt lgkmcnt(4)
    v_mfma_f32_32x32x16_bf16 v[64:79], a[128:131], v[192:195], v[64:79]
    ds_read_b128 a[148:151], v2 offset:19456
    v_mfma_f32_32x32x8_bf16 v[64:79], a[170:171], v[126:127], v[64:79]
    s_waitcnt lgkmcnt(4)
    v_mfma_f32_32x32x16_bf16 v[64:79], a[132:135], v[196:199], v[64:79]
    ds_read_b128 a[152:155], v2 offset:21504
    s_waitcnt lgkmcnt(4)
    v_mfma_f32_32x32x16_bf16 v[64:79], a[136:139], v[200:203], v[64:79]
    ds_read_b128 a[156:159], v2 offset:22528
    s_waitcnt lgkmcnt(4)
    v_mfma_f32_32x32x16_bf16 v[64:79], a[140:143], v[204:207], v[64:79]
    ds_read_b128 a[128:131], v2 offset:23552
    s_waitcnt lgkmcnt(4)
    v_mfma_f32_32x32x16_bf16 v[64:79], a[144:147], v[208:211], v[64:79]
    ds_read_b128 a[132:135], v2 offset:24576
    s_waitcnt lgkmcnt(4)
    v_mfma_f32_32x32x16_bf16 v[64:79], a[148:151], v[212:215], v[64:79]
    ds_read_b128 a[136:139], v2 offset:25600
    s_waitcnt lgkmcnt(4)
    v_mfma_f32_32x32x16_bf16 v[64:79], a[152:155], v[224:227], v[64:79]
    ds_read_b128 a[140:143], v2 offset:26624
    s_waitcnt lgkmcnt(4)
    v_mfma_f32_32x32x16_bf16 v[64:79], a[156:159], v[228:231], v[64:79]
    s_waitcnt lgkmcnt(3)
    v_mfma_f32_32x32x16_bf16 v[64:79], a[128:131], v[232:235], v[64:79]
    s_waitcnt lgkmcnt(2)
    v_mfma_f32_32x32x16_bf16 v[64:79], a[132:135], v[236:239], v[64:79]
    s_waitcnt lgkmcnt(1)
    v_mfma_f32_32x32x16_bf16 v[64:79], a[136:139], v[240:243], v[64:79]
    s_waitcnt lgkmcnt(0)
    v_mfma_f32_32x32x16_bf16 v[64:79], a[140:143], v[244:247], v[64:79]
    s_mov_b32 s101, 0
    s_atomic_add s101, s[66:67], 0 glc
    v_mul_f32 v122, 0x3e8b97f6, v124
    s_nop 8
    v_pk_mul_f32 v[64:65], v[64:65], v[122:123] op_sel:[0,0] op_sel_hi:[1,0]
    v_pk_mul_f32 v[66:67], v[66:67], v[122:123] op_sel:[0,0] op_sel_hi:[1,0]
    v_pk_mul_f32 v[68:69], v[68:69], v[122:123] op_sel:[0,0] op_sel_hi:[1,0]
    v_pk_mul_f32 v[70:71], v[70:71], v[122:123] op_sel:[0,0] op_sel_hi:[1,0]
    v_pk_mul_f32 v[72:73], v[72:73], v[122:123] op_sel:[0,0] op_sel_hi:[1,0]
    v_pk_mul_f32 v[74:75], v[74:75], v[122:123] op_sel:[0,0] op_sel_hi:[1,0]
    v_pk_mul_f32 v[76:77], v[76:77], v[122:123] op_sel:[0,0] op_sel_hi:[1,0]
    v_pk_mul_f32 v[78:79], v[78:79], v[122:123] op_sel:[0,0] op_sel_hi:[1,0]
    v_cvt_pk_bf16_f32 v104, v64, v65
    v_cvt_pk_bf16_f32 v105, v66, v67
    v_cvt_pk_bf16_f32 v106, v68, v69
    v_cvt_pk_bf16_f32 v107, v70, v71
    v_cvt_pk_bf16_f32 v108, v72, v73
    v_cvt_pk_bf16_f32 v109, v74, v75
    v_cvt_pk_bf16_f32 v110, v76, v77
    v_cvt_pk_bf16_f32 v111, v78, v79
    s_mov_b64 exec, s[80:81]
    v_mov_b32 v110, 0
    v_mov_b32 v111, 0
    s_mov_b64 exec, -1
    v_mfma_f32_32x32x16_bf16 v[32:47], v[80:83], v[104:107], 0
    v_mfma_f32_32x32x16_bf16 v[32:47], v[84:87], v[108:111], v[32:47]
    s_mov_b32 s95, 0
    s_nop 10
    v_max3_f32 v15, v32, v33, v34
    v_max3_f32 v15, v15, v35, v36
    v_max3_f32 v15, v15, v37, v38
    v_max3_f32 v15, v15, v39, v40
    v_max3_f32 v15, v15, v41, v42
    v_max3_f32 v15, v15, v43, v44
    v_max3_f32 v15, v15, v45, v46
    v_max_f32 v15, v15, v47
    v_mov_b32 v72, v15
    s_nop 1
    v_permlane32_swap_b32 v72, v15
    v_max_f32 v15, v15, v72
    s_nop 2
L_attn_8:
    v_cvt_pk_bf16_f32 v72, -v15, 0
    v_lshlrev_b32 v73, 16, v72
    v_sub_f32_e64 v73, -v15, v73
    v_cvt_pk_bf16_f32 v72, -v15, v73
    v_and_b32 v74, 0xffff0000, v72
    v_sub_f32 v73, v73, v74
    s_mov_b64 exec, s[80:81]
    v_mov_b32 v110, v72
    v_cvt_pk_bf16_f32 v111, v73, 0
    s_mov_b64 exec, -1
    ds_write_b128 v112, v[104:107] offset:36864
    ds_write_b128 v112, v[108:111] offset:37888
    s_lshl_b32 s72, s60, 12
    s_xor_b32 s91, s72, 4096
    s_waitcnt lgkmcnt(0)
    s_add_u32 s89, s101, 0x78787878
    s_and_b32 s89, s89, s59
    s_cmp_eq_u32 s89, s59
    s_cbranch_scc1 L_go_10
L_poll_9:
    s_mov_b32 s101, 0
    s_atomic_add s101, s[66:67], 0 glc
    s_sub_u32 s63, s63, 1
    s_cbranch_scc1 L_go_10_to
    s_waitcnt lgkmcnt(0)
    s_add_u32 s89, s101, 0x78787878
    s_and_b32 s89, s89, s59
    s_cmp_eq_u32 s89, s59
    s_cbranch_scc0 L_poll_9
    s_branch L_go_10
L_go_10_to:
    s_mov_b32 s63, 0
    s_waitcnt lgkmcnt(0)
L_go_10:
    buffer_load_dwordx4 a[0:3], v123, s[52:55], s91 offen offset:0 sc1
    buffer_load_dwordx4 a[4:7], v123, s[52:55], s91 offen offset:1024 sc1
    buffer_load_dwordx4 a[8:11], v123, s[52:55], s91 offen offset:2048 sc1
    buffer_load_dwordx4 a[12:15], v123, s[52:55], s91 offen offset:3072 sc1
    s_barrier
    ds_read_b128 a[180:183], v113 offset:36864
    ds_read_b128 a[184:187], v113 offset:37888
    ds_read_b128 a[188:191], v114 offset:36864
    ds_read_b128 a[192:195], v114 offset:37888
    ds_read_b128 a[196:199], v115 offset:36864
    ds_read_b128 a[200:203], v115 offset:37888
    v_mfma_f32_32x32x16_bf16 v[32:47], v[80:83], v[104:107], 0
    v_mfma_f32_32x32x16_bf16 v[32:47], v[84:87], v[108:111], v[32:47]
    s_waitcnt lgkmcnt(5)
    v_mfma_f32_32x32x16_bf16 v[48:63], v[80:83], a[180:183], 0
    s_xor_b32 s91, s72, 8192
    buffer_load_dwordx4 a[16:19], v123, s[52:55], s91 offen offset:0 sc1
    buffer_load_dwordx4 a[20:23], v123, s[52:55], s91 offen offset:1024 sc1
    buffer_load_dwordx4 a[24:27], v123, s[52:55], s91 offen offset:2048 sc1
    buffer_load_dwordx4 a[28:31], v123, s[52:55], s91 offen offset:3072 sc1
    s_nop 4
    v_exp_f32 v32, v32
    v_exp_f32 v33, v33
    v_exp_f32 v34, v34
    v_cvt_pk_bf16_f32 v64, v32, v33
    v_exp_f32 v35, v35
    s_nop 0
    v_cvt_pk_bf16_f32 v65, v34, v35
    v_exp_f32 v36, v36
    v_exp_f32 v37, v37
    v_exp_f32 v38, v38
    v_cvt_pk_bf16_f32 v66, v36, v37
    v_exp_f32 v39, v39
    s_waitcnt lgkmcnt(4)
    v_mfma_f32_32x32x16_bf16 v[48:63], v[84:87], a[184:187], v[48:63]
    s_xor_b32 s91, s72, 12288
    v_cvt_pk_bf16_f32 v67, v38, v39
    v_exp_f32 v40, v40
    v_exp_f32 v41, v41
    v_exp_f32 v42, v42
    v_cvt_pk_bf16_f32 v68, v40, v41
    v_exp_f32 v43, v43
    v_mfma_f32_32x32x16_bf16 v[128:143], v[88:91], v[64:67], 0
    v_cvt_pk_bf16_f32 v69, v42, v43
    v_exp_f32 v44, v44
    v_exp_f32 v45, v45
    v_exp_f32 v46, v46
    v_exp_f32 v47, v47
    v_cvt_pk_bf16_f32 v70, v44, v45
    v_cvt_pk_bf16_f32 v71, v46, v47
    s_waitcnt lgkmcnt(3)
    v_mfma_f32_32x32x16_bf16 v[32:47], v[80:83], a[188:191], 0
    v_exp_f32 v48, v48
    v_exp_f32 v49, v49
    v_exp_f32 v50, v50
    v_cvt_pk_bf16_f32 v64, v48, v49
    v_exp_f32 v51, v51
    v_mfma_f32_32x32x16_bf16 v[128:143], v[92:95], v[68:71], v[128:143]
    v_cvt_pk_bf16_f32 v65, v50, v51
    v_exp_f32 v52, v52
    v_exp_f32 v53, v53
    v_exp_f32 v54, v54
    v_cvt_pk_bf16_f32 v66, v52, v53
    v_exp_f32 v55, v55
    s_waitcnt lgkmcnt(2)
    v_mfma_f32_32x32x16_bf16 v[32:47], v[84:87], a[192:195], v[32:47]
    v_cvt_pk_bf16_f32 v67, v54, v55
    v_exp_f32 v56, v56
    v_exp_f32 v57, v57
    v_exp_f32 v58, v58
    v_cvt_pk_bf16_f32 v68, v56, v57
    v_exp_f32 v59, v59
    v_mfma_f32_32x32x16_bf16 v[144:159], v[88:91], v[64:67], 0
    v_cvt_pk_bf16_f32 v69, v58, v59
    v_exp_f32 v60, v60
    v_exp_f32 v61, v61
    v_exp_f32 v62, v62
    v_exp_f32 v63, v63
    v_cvt_pk_bf16_f32 v70, v60, v61
    v_cvt_pk_bf16_f32 v71, v62, v63
    s_waitcnt lgkmcnt(1)
    v_mfma_f32_32x32x16_bf16 v[48:63], v[80:83], a[196:199], 0
    buffer_load_dwordx4 a[32:35], v123, s[52:55], s91 offen offset:0 sc1
    buffer_load_dwordx4 a[36:39], v123, s[52:55], s91 offen offset:1024 sc1
    buffer_load_dwordx4 a[40:43], v123, s[52:55], s91 offen offset:2048 sc1
    buffer_load_dwordx4 a[44:47], v123, s[52:55], s91 offen offset:3072 sc1
    v_exp_f32 v32, v32
    v_exp_f32 v33, v33
    v_exp_f32 v34, v34
    v_cvt_pk_bf16_f32 v64, v32, v33
    v_exp_f32 v35, v35
    v_mfma_f32_32x32x16_bf16 v[144:159], v[92:95], v[68:71], v[144:159]
    v_cvt_pk_bf16_f32 v65, v34, v35
    v_exp_f32 v36, v36
    v_exp_f32 v37, v37
    v_exp_f32 v38, v38
    v_cvt_pk_bf16_f32 v66, v36, v37
    v_exp_f32 v39, v39
    s_waitcnt lgkmcnt(0)
    v_mfma_f32_32x32x16_bf16 v[48:63], v[84:87], a[200:203], v[48:63]
    s_xor_b32 s91, s72, 16384
    v_cvt_pk_bf16_f32 v67, v38, v39
    v_exp_f32 v40, v40
    v_exp_f32 v41, v41
    v_exp_f32 v42, v42
    v_cvt_pk_bf16_f32 v68, v40, v41
    v_exp_f32 v43, v43
    v_mfma_f32_32x32x16_bf16 v[160:175], v[88:91], v[64:67], 0
    s_waitcnt vmcnt(10)
    v_cvt_pk_bf16_f32 v69, v42, v43
    v_exp_f32 v44, v44
    v_exp_f32 v45, v45
    v_exp_f32 v46, v46
    v_exp_f32 v47, v47
    v_cvt_pk_bf16_f32 v70, v44, v45
    v_cvt_pk_bf16_f32 v71, v46, v47
    v_mfma_f32_32x32x16_bf16 v[32:47], a[0:3], v[104:107], 0
    v_exp_f32 v48, v48
    v_exp_f32 v49, v49
    v_exp_f32 v50, v50
    v_cvt_pk_bf16_f32 v64, v48, v49
    v_exp_f32 v51, v51
    v_mfma_f32_32x32x16_bf16 v[160:175], v[92:95], v[68:71], v[160:175]
    v_cvt_pk_bf16_f32 v65, v50, v51
    v_exp_f32 v52, v52
    v_exp_f32 v53, v53
    v_exp_f32 v54, v54
    v_cvt_pk_bf16_f32 v66, v52, v53
    v_exp_f32 v55, v55
    v_mfma_f32_32x32x16_bf16 v[32:47], a[4:7], v[108:111], v[32:47]
    v_cvt_pk_bf16_f32 v67, v54, v55
    v_exp_f32 v56, v56
    v_exp_f32 v57, v57
    v_exp_f32 v58, v58
    v_cvt_pk_bf16_f32 v68, v56, v57
    v_exp_f32 v59, v59
    v_mfma_f32_32x32x16_bf16 v[176:191], v[88:91], v[64:67], 0
    v_cvt_pk_bf16_f32 v69, v58, v59
    v_exp_f32 v60, v60
    v_exp_f32 v61, v61
    v_exp_f32 v62, v62
    v_exp_f32 v63, v63
    v_cvt_pk_bf16_f32 v70, v60, v61
    v_cvt_pk_bf16_f32 v71, v62, v63
    v_mfma_f32_32x32x16_bf16 v[48:63], a[0:3], a[180:183], 0
    v_exp_f32 v32, v32
    v_exp_f32 v33, v33
    v_exp_f32 v34, v34
    v_cvt_pk_bf16_f32 v64, v32, v33
    v_exp_f32 v35, v35
    v_mfma_f32_32x32x16_bf16 v[176:191], v[92:95], v[68:71], v[176:191]
    v_cvt_pk_bf16_f32 v65, v34, v35
    v_exp_f32 v36, v36
    v_exp_f32 v37, v37
    v_exp_f32 v38, v38
    v_cvt_pk_bf16_f32 v66, v36, v37
    v_exp_f32 v39, v39
    v_mfma_f32_32x32x16_bf16 v[48:63], a[4:7], a[184:187], v[48:63]
    s_waitcnt vmcnt(8)
    s_mov_b32 s101, 0
    v_cvt_pk_bf16_f32 v67, v38, v39
    v_exp_f32 v40, v40
    v_exp_f32 v41, v41
    v_exp_f32 v42, v42
    v_cvt_pk_bf16_f32 v68, v40, v41
    v_exp_f32 v43, v43
    v_mfma_f32_32x32x16_bf16 v[128:143], a[8:11], v[64:67], v[128:143]
    s_atomic_add s101, s[66:67], 0 glc
    v_cvt_pk_bf16_f32 v69, v42, v43
    v_exp_f32 v44, v44
    v_exp_f32 v45, v45
    v_exp_f32 v46, v46
    v_exp_f32 v47, v47
    v_cvt_pk_bf16_f32 v70, v44, v45
    v_cvt_pk_bf16_f32 v71, v46, v47
    v_mfma_f32_32x32x16_bf16 v[32:47], a[0:3], a[188:191], 0
    v_exp_f32 v48, v48
    v_exp_f32 v49, v49
    v_exp_f32 v50, v50
    v_cvt_pk_bf16_f32 v64, v48, v49
    v_exp_f32 v51, v51
    v_mfma_f32_32x32x16_bf16 v[128:143], a[12:15], v[68:71], v[128:143]
    v_cvt_pk_bf16_f32 v65, v50, v51
    v_exp_f32 v52, v52
    v_exp_f32 v53, v53
    v_exp_f32 v54, v54
    v_cvt_pk_bf16_f32 v66, v52, v53
    v_exp_f32 v55, v55
    v_mfma_f32_32x32x16_bf16 v[32:47], a[4:7], a[192:195], v[32:47]
    v_cvt_pk_bf16_f32 v67, v54, v55
    v_exp_f32 v56, v56
    v_exp_f32 v57, v57
    v_exp_f32 v58, v58
    v_cvt_pk_bf16_f32 v68, v56, v57
    v_exp_f32 v59, v59
    v_mfma_f32_32x32x16_bf16 v[144:159], a[8:11], v[64:67], v[144:159]
    v_cvt_pk_bf16_f32 v69, v58, v59
    v_exp_f32 v60, v60
    v_exp_f32 v61, v61
    v_exp_f32 v62, v62
    v_exp_f32 v63, v63
    v_cvt_pk_bf16_f32 v70, v60, v61
    v_cvt_pk_bf16_f32 v71, v62, v63
    v_mfma_f32_32x32x16_bf16 v[48:63], a[0:3], a[196:199], 0
    v_exp_f32 v32, v32
    v_exp_f32 v33, v33
    v_exp_f32 v34, v34
    v_cvt_pk_bf16_f32 v64, v32, v33
    v_exp_f32 v35, v35
    v_mfma_f32_32x32x16_bf16 v[144:159], a[12:15], v[68:71], v[144:159]
    v_cvt_pk_bf16_f32 v65, v34, v35
    v_exp_f32 v36, v36
    v_exp_f32 v37, v37
    v_exp_f32 v38, v38
    v_cvt_pk_bf16_f32 v66, v36, v37
    v_exp_f32 v39, v39
    v_mfma_f32_32x32x16_bf16 v[48:63], a[4:7], a[200:203], v[48:63]
    v_cvt_pk_bf16_f32 v67, v38, v39
    v_exp_f32 v40, v40
    v_exp_f32 v41, v41
    v_exp_f32 v42, v42
    v_cvt_pk_bf16_f32 v68, v40, v41
    v_exp_f32 v43, v43
    v_mfma_f32_32x32x16_bf16 v[160:175], a[8:11], v[64:67], v[160:175]
    s_waitcnt vmcnt(6)
    s_waitcnt lgkmcnt(0)
    v_cvt_pk_bf16_f32 v69, v42, v43
    v_exp_f32 v44, v44
    v_exp_f32 v45, v45
    v_exp_f32 v46, v46
    v_exp_f32 v47, v47
    v_cvt_pk_bf16_f32 v70, v44, v45
    v_cvt_pk_bf16_f32 v71, v46, v47
    v_mfma_f32_32x32x16_bf16 v[32:47], a[16:19], v[104:107], 0
    s_add_u32 s89, s101, 0x78787878
    v_exp_f32 v48, v48
    v_exp_f32 v49, v49
    v_exp_f32 v50, v50
    v_cvt_pk_bf16_f32 v64, v48, v49
    v_exp_f32 v51, v51
    v_mfma_f32_32x32x16_bf16 v[160:175], a[12:15], v[68:71], v[160:175]
    s_and_b32 s89, s89, 0x80808080
    v_cvt_pk_bf16_f32 v65, v50, v51
    v_exp_f32 v52, v52
    v_exp_f32 v53, v53
    v_exp_f32 v54, v54
    v_cvt_pk_bf16_f32 v66, v52, v53
    v_exp_f32 v55, v55
    v_mfma_f32_32x32x16_bf16 v[32:47], a[20:23], v[108:111], v[32:47]
    s_cmp_eq_u32 s89, 0x80808080
    s_cbranch_scc0 L_rest_11
L_rest_11_ok:
    v_cvt_pk_bf16_f32 v67, v54, v55
    v_exp_f32 v56, v56
    v_exp_f32 v57, v57
    v_exp_f32 v58, v58
    v_cvt_pk_bf16_f32 v68, v56, v57
    v_exp_f32 v59, v59
    v_mfma_f32_32x32x16_bf16 v[176:191], a[8:11], v[64:67], v[176:191]
    v_cvt_pk_bf16_f32 v69, v58, v59
    v_exp_f32 v60, v60
    v_exp_f32 v61, v61
    v_exp_f32 v62, v62
    v_exp_f32 v63, v63
    v_cvt_pk_bf16_f32 v70, v60, v61
    v_cvt_pk_bf16_f32 v71, v62, v63
    v_mfma_f32_32x32x16_bf16 v[48:63], a[16:19], a[180:183], 0
    buffer_load_dwordx4 a[48:51], v123, s[52:55], s91 offen offset:0 sc1
    buffer_load_dwordx4 a[52:55], v123, s[52:55], s91 offen offset:1024 sc1
    buffer_load_dwordx4 a[56:59], v123, s[52:55], s91 offen offset:2048 sc1
    buffer_load_dwordx4 a[60:63], v123, s[52:55], s91 offen offset:3072 sc1
    v_exp_f32 v32, v32
    v_exp_f32 v33, v33
    v_exp_f32 v34, v34
    v_cvt_pk_bf16_f32 v64, v32, v33
    v_exp_f32 v35, v35
    v_mfma_f32_32x32x16_bf16 v[176:191], a[12:15], v[68:71], v[176:191]
    v_cvt_pk_bf16_f32 v65, v34, v35
    v_exp_f32 v36, v36
    v_exp_f32 v37, v37
    v_exp_f32 v38, v38
    v_cvt_pk_bf16_f32 v66, v36, v37
    v_exp_f32 v39, v39
    v_mfma_f32_32x32x16_bf16 v[48:63], a[20:23], a[184:187], v[48:63]
    s_waitcnt vmcnt(8)
    v_cvt_pk_bf16_f32 v67, v38, v39
    v_exp_f32 v40, v40
    v_exp_f32 v41, v41
    v_exp_f32 v42, v42
    v_cvt_pk_bf16_f32 v68, v40, v41
    v_exp_f32 v43, v43
    v_mfma_f32_32x32x16_bf16 v[128:143], a[24:27], v[64:67], v[128:143]
    s_xor_b32 s91, s72, 20480
    v_cvt_pk_bf16_f32 v69, v42, v43
    v_exp_f32 v44, v44
    v_exp_f32 v45, v45
    v_exp_f32 v46, v46
    v_exp_f32 v47, v47
    v_cvt_pk_bf16_f32 v70, v44, v45
    v_cvt_pk_bf16_f32 v71, v46, v47
    v_mfma_f32_32x32x16_bf16 v[32:47], a[16:19], a[188:191], 0
    v_exp_f32 v48, v48
    v_exp_f32 v49, v49
    v_exp_f32 v50, v50
    v_cvt_pk_bf16_f32 v64, v48, v49
    v_exp_f32 v51, v51
    v_mfma_f32_32x32x16_bf16 v[128:143], a[28:31], v[68:71], v[128:143]
    v_cvt_pk_bf16_f32 v65, v50, v51
    v_exp_f32 v52, v52
    v_exp_f32 v53, v53
    v_exp_f32 v54, v54
    v_cvt_pk_bf16_f32 v66, v52, v53
    v_exp_f32 v55, v55
    v_mfma_f32_32x32x16_bf16 v[32:47], a[20:23], a[192:195], v[32:47]
    v_cvt_pk_bf16_f32 v67, v54, v55
    v_exp_f32 v56, v56
    v_exp_f32 v57, v57
    v_exp_f32 v58, v58
    v_cvt_pk_bf16_f32 v68, v56, v57
    v_exp_f32 v59, v59
    v_mfma_f32_32x32x16_bf16 v[144:159], a[24:27], v[64:67], v[144:159]
    v_cvt_pk_bf16_f32 v69, v58, v59
    v_exp_f32 v60, v60
    v_exp_f32 v61, v61
    v_exp_f32 v62, v62
    v_exp_f32 v63, v63
    v_cvt_pk_bf16_f32 v70, v60, v61
    v_cvt_pk_bf16_f32 v71, v62, v63
    v_mfma_f32_32x32x16_bf16 v[48:63], a[16:19], a[196:199], 0
    buffer_load_dwordx4 a[64:67], v123, s[52:55], s91 offen offset:0 sc1
    buffer_load_dwordx4 a[68:71], v123, s[52:55], s91 offen offset:1024 sc1
    buffer_load_dwordx4 a[72:75], v123, s[52:55], s91 offen offset:2048 sc1
    buffer_load_dwordx4 a[76:79], v123, s[52:55], s91 offen offset:3072 sc1
    v_exp_f32 v32, v32
    v_exp_f32 v33, v33
    v_exp_f32 v34, v34
    v_cvt_pk_bf16_f32 v64, v32, v33
    v_exp_f32 v35, v35
    v_mfma_f32_32x32x16_bf16 v[144:159], a[28:31], v[68:71], v[144:159]
    v_cvt_pk_bf16_f32 v65, v34, v35
    v_exp_f32 v36, v36
    v_exp_f32 v37, v37
    v_exp_f32 v38, v38
    v_cvt_pk_bf16_f32 v66, v36, v37
    v_exp_f32 v39, v39
    v_mfma_f32_32x32x16_bf16 v[48:63], a[20:23], a[200:203], v[48:63]
    s_xor_b32 s91, s72, 24576
    v_cvt_pk_bf16_f32 v67, v38, v39
    v_exp_f32 v40, v40
    v_exp_f32 v41, v41
    v_exp_f32 v42, v42
    v_cvt_pk_bf16_f32 v68, v40, v41
    v_exp_f32 v43, v43
    v_mfma_f32_32x32x16_bf16 v[160:175], a[24:27], v[64:67], v[160:175]
    s_waitcnt vmcnt(10)
    v_cvt_pk_bf16_f32 v69, v42, v43
    v_exp_f32 v44, v44
    v_exp_f32 v45, v45
    v_exp_f32 v46, v46
    v_exp_f32 v47, v47
    v_cvt_pk_bf16_f32 v70, v44, v45
    v_cvt_pk_bf16_f32 v71, v46, v47
    v_mfma_f32_32x32x16_bf16 v[32:47], a[32:35], v[104:107], 0
    v_exp_f32 v48, v48
    v_exp_f32 v49, v49
    v_exp_f32 v50, v50
    v_cvt_pk_bf16_f32 v64, v48, v49
    v_exp_f32 v51, v51
    v_mfma_f32_32x32x16_bf16 v[160:175], a[28:31], v[68:71], v[160:175]
    v_cvt_pk_bf16_f32 v65, v50, v51
    v_exp_f32 v52, v52
    v_exp_f32 v53, v53
    v_exp_f32 v54, v54
    v_cvt_pk_bf16_f32 v66, v52, v53
    v_exp_f32 v55, v55
    v_mfma_f32_32x32x16_bf16 v[32:47], a[36:39], v[108:111], v[32:47]
    v_cvt_pk_bf16_f32 v67, v54, v55
    v_exp_f32 v56, v56
    v_exp_f32 v57, v57
    v_exp_f32 v58, v58
    v_cvt_pk_bf16_f32 v68, v56, v57
    v_exp_f32 v59, v59
    v_mfma_f32_32x32x16_bf16 v[176:191], a[24:27], v[64:67], v[176:191]
    v_cvt_pk_bf16_f32 v69, v58, v59
    v_exp_f32 v60, v60
    v_exp_f32 v61, v61
    v_exp_f32 v62, v62
    v_exp_f32 v63, v63
    v_cvt_pk_bf16_f32 v70, v60, v61
    v_cvt_pk_bf16_f32 v71, v62, v63
    v_mfma_f32_32x32x16_bf16 v[48:63], a[32:35], a[180:183], 0
    buffer_load_dwordx4 a[80:83], v123, s[52:55], s91 offen offset:0 sc1
    buffer_load_dwordx4 a[84:87], v123, s[52:55], s91 offen offset:1024 sc1
    buffer_load_dwordx4 a[88:91], v123, s[52:55], s91 offen offset:2048 sc1
    buffer_load_dwordx4 a[92:95], v123, s[52:55], s91 offen offset:3072 sc1
    v_exp_f32 v32, v32
    v_exp_f32 v33, v33
    v_exp_f32 v34, v34
    v_cvt_pk_bf16_f32 v64, v32, v33
    v_exp_f32 v35, v35
    v_mfma_f32_32x32x16_bf16 v[176:191], a[28:31], v[68:71], v[176:191]
    v_cvt_pk_bf16_f32 v65, v34, v35
    v_exp_f32 v36, v36
    v_exp_f32 v37, v37
    v_exp_f32 v38, v38
    v_cvt_pk_bf16_f32 v66, v36, v37
    v_exp_f32 v39, v39
    v_mfma_f32_32x32x16_bf16 v[48:63], a[36:39], a[184:187], v[48:63]
    s_waitcnt vmcnt(12)
    v_cvt_pk_bf16_f32 v67, v38, v39
    v_exp_f32 v40, v40
    v_exp_f32 v41, v41
    v_exp_f32 v42, v42
    v_cvt_pk_bf16_f32 v68, v40, v41
    v_exp_f32 v43, v43
    v_mfma_f32_32x32x16_bf16 v[128:143], a[40:43], v[64:67], v[128:143]
    s_xor_b32 s91, s72, 28672
    v_cvt_pk_bf16_f32 v69, v42, v43
    v_exp_f32 v44, v44
    v_exp_f32 v45, v45
    v_exp_f32 v46, v46
    v_exp_f32 v47, v47
    v_cvt_pk_bf16_f32 v70, v44, v45
    v_cvt_pk_bf16_f32 v71, v46, v47
    v_mfma_f32_32x32x16_bf16 v[32:47], a[32:35], a[188:191], 0
    v_exp_f32 v48, v48
    v_exp_f32 v49, v49
    v_exp_f32 v50, v50
    v_cvt_pk_bf16_f32 v64, v48, v49
    v_exp_f32 v51, v51
    v_mfma_f32_32x32x16_bf16 v[128:143], a[44:47], v[68:71], v[128:143]
    v_cvt_pk_bf16_f32 v65, v50, v51
    v_exp_f32 v52, v52
    v_exp_f32 v53, v53
    v_exp_f32 v54, v54
    v_cvt_pk_bf16_f32 v66, v52, v53
    v_exp_f32 v55, v55
    v_mfma_f32_32x32x16_bf16 v[32:47], a[36:39], a[192:195], v[32:47]
    v_cvt_pk_bf16_f32 v67, v54, v55
    v_exp_f32 v56, v56
    v_exp_f32 v57, v57
    v_exp_f32 v58, v58
    v_cvt_pk_bf16_f32 v68, v56, v57
    v_exp_f32 v59, v59
    v_mfma_f32_32x32x16_bf16 v[144:159], a[40:43], v[64:67], v[144:159]
    v_cvt_pk_bf16_f32 v69, v58, v59
    v_exp_f32 v60, v60
    v_exp_f32 v61, v61
    v_exp_f32 v62, v62
    v_exp_f32 v63, v63
    v_cvt_pk_bf16_f32 v70, v60, v61
    v_cvt_pk_bf16_f32 v71, v62, v63
    v_mfma_f32_32x32x16_bf16 v[48:63], a[32:35], a[196:199], 0
    buffer_load_dwordx4 a[96:99], v123, s[52:55], s91 offen offset:0 sc1
    buffer_load_dwordx4 a[100:103], v123, s[52:55], s91 offen offset:1024 sc1
    buffer_load_dwordx4 a[104:107], v123, s[52:55], s91 offen offset:2048 sc1
    buffer_load_dwordx4 a[108:111], v123, s[52:55], s91 offen offset:3072 sc1
    v_exp_f32 v32, v32
    v_exp_f32 v33, v33
    v_exp_f32 v34, v34
    v_cvt_pk_bf16_f32 v64, v32, v33
    v_exp_f32 v35, v35
    v_mfma_f32_32x32x16_bf16 v[144:159], a[44:47], v[68:71], v[144:159]
    v_cvt_pk_bf16_f32 v65, v34, v35
    v_exp_f32 v36, v36
    v_exp_f32 v37, v37
    v_exp_f32 v38, v38
    v_cvt_pk_bf16_f32 v66, v36, v37
    v_exp_f32 v39, v39
    v_mfma_f32_32x32x16_bf16 v[48:63], a[36:39], a[200:203], v[48:63]
    s_xor_b32 s91, s72, 32768
    v_cvt_pk_bf16_f32 v67, v38, v39
    v_exp_f32 v40, v40
    v_exp_f32 v41, v41
    v_exp_f32 v42, v42
    v_cvt_pk_bf16_f32 v68, v40, v41
    v_exp_f32 v43, v43
    v_mfma_f32_32x32x16_bf16 v[160:175], a[40:43], v[64:67], v[160:175]
    s_waitcnt vmcnt(14)
    v_cvt_pk_bf16_f32 v69, v42, v43
    v_exp_f32 v44, v44
    v_exp_f32 v45, v45
    v_exp_f32 v46, v46
    v_exp_f32 v47, v47
    v_cvt_pk_bf16_f32 v70, v44, v45
    v_cvt_pk_bf16_f32 v71, v46, v47
    v_mfma_f32_32x32x16_bf16 v[32:47], a[48:51], v[104:107], 0
    v_exp_f32 v48, v48
    v_exp_f32 v49, v49
    v_exp_f32 v50, v50
    v_cvt_pk_bf16_f32 v64, v48, v49
    v_exp_f32 v51, v51
    v_mfma_f32_32x32x16_bf16 v[160:175], a[44:47], v[68:71], v[160:175]
    v_cvt_pk_bf16_f32 v65, v50, v51
    v_exp_f32 v52, v52
    v_exp_f32 v53, v53
    v_exp_f32 v54, v54
    v_cvt_pk_bf16_f32 v66, v52, v53
    v_exp_f32 v55, v55
    v_mfma_f32_32x32x16_bf16 v[32:47], a[52:55], v[108:111], v[32:47]
    v_cvt_pk_bf16_f32 v67, v54, v55
    v_exp_f32 v56, v56
    v_exp_f32 v57, v57
    v_exp_f32 v58, v58
    v_cvt_pk_bf16_f32 v68, v56, v57
    v_exp_f32 v59, v59
    v_mfma_f32_32x32x16_bf16 v[176:191], a[40:43], v[64:67], v[176:191]
    v_cvt_pk_bf16_f32 v69, v58, v59
    v_exp_f32 v60, v60
    v_exp_f32 v61, v61
    v_exp_f32 v62, v62
    v_exp_f32 v63, v63
    v_cvt_pk_bf16_f32 v70, v60, v61
    v_cvt_pk_bf16_f32 v71, v62, v63
L_page_4:
    s_cbranch_vccnz L_page_8
    v_mfma_f32_32x32x16_bf16 v[48:63], a[48:51], a[180:183], 0
    buffer_load_dwordx4 a[112:115], v123, s[52:55], s91 offen offset:0 sc1
    buffer_load_dwordx4 a[116:119], v123, s[52:55], s91 offen offset:1024 sc1
    buffer_load_dwordx4 a[120:123], v123, s[52:55], s91 offen offset:2048 sc1
    buffer_load_dwordx4 a[124:127], v123, s[52:55], s91 offen offset:3072 sc1
    v_exp_f32 v32, v32
    v_exp_f32 v33, v33
    v_exp_f32 v34, v34
    v_cvt_pk_bf16_f32 v64, v32, v33
    v_exp_f32 v35, v35
    v_mfma_f32_32x32x16_bf16 v[176:191], a[44:47], v[68:71], v[176:191]
    v_cvt_pk_bf16_f32 v65, v34, v35
    v_exp_f32 v36, v36
    v_exp_f32 v37, v37
    v_exp_f32 v38, v38
    v_cvt_pk_bf16_f32 v66, v36, v37
    v_exp_f32 v39, v39
    v_mfma_f32_32x32x16_bf16 v[48:63], a[52:55], a[184:187], v[48:63]
    s_waitcnt vmcnt(16)
    v_cvt_pk_bf16_f32 v67, v38, v39
    v_exp_f32 v40, v40
    v_exp_f32 v41, v41
    v_exp_f32 v42, v42
    v_cvt_pk_bf16_f32 v68, v40, v41
    v_exp_f32 v43, v43
    v_mfma_f32_32x32x16_bf16 v[128:143], a[56:59], v[64:67], v[128:143]
    s_xor_b32 s91, s72, 36864
    v_cvt_pk_bf16_f32 v69, v42, v43
    v_exp_f32 v44, v44
    v_exp_f32 v45, v45
    v_exp_f32 v46, v46
    v_exp_f32 v47, v47
    v_cvt_pk_bf16_f32 v70, v44, v45
    v_cvt_pk_bf16_f32 v71, v46, v47
    v_mfma_f32_32x32x16_bf16 v[32:47], a[48:51], a[188:191], 0
    v_exp_f32 v48, v48
    v_exp_f32 v49, v49
    v_exp_f32 v50, v50
    v_cvt_pk_bf16_f32 v64, v48, v49
    v_exp_f32 v51, v51
    v_mfma_f32_32x32x16_bf16 v[128:143], a[60:63], v[68:71], v[128:143]
    v_cvt_pk_bf16_f32 v65, v50, v51
    v_exp_f32 v52, v52
    v_exp_f32 v53, v53
    v_exp_f32 v54, v54
    v_cvt_pk_bf16_f32 v66, v52, v53
    v_exp_f32 v55, v55
    v_mfma_f32_32x32x16_bf16 v[32:47], a[52:55], a[192:195], v[32:47]
    v_cvt_pk_bf16_f32 v67, v54, v55
    v_exp_f32 v56, v56
    v_exp_f32 v57, v57
    v_exp_f32 v58, v58
    v_cvt_pk_bf16_f32 v68, v56, v57
    v_exp_f32 v59, v59
    v_mfma_f32_32x32x16_bf16 v[144:159], a[56:59], v[64:67], v[144:159]
    v_cvt_pk_bf16_f32 v69, v58, v59
    v_exp_f32 v60, v60
    v_exp_f32 v61, v61
    v_exp_f32 v62, v62
    v_exp_f32 v63, v63
    v_cvt_pk_bf16_f32 v70, v60, v61
    v_cvt_pk_bf16_f32 v71, v62, v63
    v_mfma_f32_32x32x16_bf16 v[48:63], a[48:51], a[196:199], 0
    buffer_load_dwordx4 a[0:3], v123, s[52:55], s91 offen offset:0 sc1
    buffer_load_dwordx4 a[4:7], v123, s[52:55], s91 offen offset:1024 sc1
    buffer_load_dwordx4 a[8:11], v123, s[52:55], s91 offen offset:2048 sc1
    buffer_load_dwordx4 a[12:15], v123, s[52:55], s91 offen offset:3072 sc1
    v_exp_f32 v32, v32
    v_exp_f32 v33, v33
    v_exp_f32 v34, v34
    v_cvt_pk_bf16_f32 v64, v32, v33
    v_exp_f32 v35, v35
    v_mfma_f32_32x32x16_bf16 v[144:159], a[60:63], v[68:71], v[144:159]
    v_cvt_pk_bf16_f32 v65, v34, v35
    v_exp_f32 v36, v36
    v_exp_f32 v37, v37
    v_exp_f32 v38, v38
    v_cvt_pk_bf16_f32 v66, v36, v37
    v_exp_f32 v39, v39
    v_mfma_f32_32x32x16_bf16 v[48:63], a[52:55], a[200:203], v[48:63]
    s_xor_b32 s91, s72, 40960
    v_cvt_pk_bf16_f32 v67, v38, v39
    v_exp_f32 v40, v40
    v_exp_f32 v41, v41
    v_exp_f32 v42, v42
    v_cvt_pk_bf16_f32 v68, v40, v41
    v_exp_f32 v43, v43
    v_mfma_f32_32x32x16_bf16 v[160:175], a[56:59], v[64:67], v[160:175]
    s_waitcnt vmcnt(18)
    v_cvt_pk_bf16_f32 v69, v42, v43
    v_exp_f32 v44, v44
    v_exp_f32 v45, v45
    v_exp_f32 v46, v46
    v_exp_f32 v47, v47
    v_cvt_pk_bf16_f32 v70, v44, v45
    v_cvt_pk_bf16_f32 v71, v46, v47
    v_mfma_f32_32x32x16_bf16 v[32:47], a[64:67], v[104:107], 0
    v_exp_f32 v48, v48
    v_exp_f32 v49, v49
    v_exp_f32 v50, v50
    v_cvt_pk_bf16_f32 v64, v48, v49
    v_exp_f32 v51, v51
    v_mfma_f32_32x32x16_bf16 v[160:175], a[60:63], v[68:71], v[160:175]
    v_cvt_pk_bf16_f32 v65, v50, v51
    v_exp_f32 v52, v52
    v_exp_f32 v53, v53
    v_exp_f32 v54, v54
    v_cvt_pk_bf16_f32 v66, v52, v53
    v_exp_f32 v55, v55
    v_mfma_f32_32x32x16_bf16 v[32:47], a[68:71], v[108:111], v[32:47]
    v_cvt_pk_bf16_f32 v67, v54, v55
    v_exp_f32 v56, v56
    v_exp_f32 v57, v57
    v_exp_f32 v58, v58
    v_cvt_pk_bf16_f32 v68, v56, v57
    v_exp_f32 v59, v59
    v_mfma_f32_32x32x16_bf16 v[176:191], a[56:59], v[64:67], v[176:191]
    v_cvt_pk_bf16_f32 v69, v58, v59
    v_exp_f32 v60, v60
    v_exp_f32 v61, v61
    v_exp_f32 v62, v62
    v_exp_f32 v63, v63
    v_cvt_pk_bf16_f32 v70, v60, v61
    v_cvt_pk_bf16_f32 v71, v62, v63
    v_mfma_f32_32x32x16_bf16 v[48:63], a[64:67], a[180:183], 0
    buffer_load_dwordx4 a[16:19], v123, s[52:55], s91 offen offset:0 sc1
    buffer_load_dwordx4 a[20:23], v123, s[52:55], s91 offen offset:1024 sc1
    buffer_load_dwordx4 a[24:27], v123, s[52:55], s91 offen offset:2048 sc1
    buffer_load_dwordx4 a[28:31], v123, s[52:55], s91 offen offset:3072 sc1
    v_exp_f32 v32, v32
    v_exp_f32 v33, v33
    v_exp_f32 v34, v34
    v_cvt_pk_bf16_f32 v64, v32, v33
    v_exp_f32 v35, v35
    v_mfma_f32_32x32x16_bf16 v[176:191], a[60:63], v[68:71], v[176:191]
    v_cvt_pk_bf16_f32 v65, v34, v35
    v_exp_f32 v36, v36
    v_exp_f32 v37, v37
    v_exp_f32 v38, v38
    v_cvt_pk_bf16_f32 v66, v36, v37
    v_exp_f32 v39, v39
    v_mfma_f32_32x32x16_bf16 v[48:63], a[68:71], a[184:187], v[48:63]
    s_waitcnt vmcnt(20)
    v_cvt_pk_bf16_f32 v67, v38, v39
    v_exp_f32 v40, v40
    v_exp_f32 v41, v41
    v_exp_f32 v42, v42
    v_cvt_pk_bf16_f32 v68, v40, v41
    v_exp_f32 v43, v43
    v_mfma_f32_32x32x16_bf16 v[128:143], a[72:75], v[64:67], v[128:143]
    s_xor_b32 s91, s72, 45056
    v_cvt_pk_bf16_f32 v69, v42, v43
    v_exp_f32 v44, v44
    v_exp_f32 v45, v45
    v_exp_f32 v46, v46
    v_exp_f32 v47, v47
    v_cvt_pk_bf16_f32 v70, v44, v45
    v_cvt_pk_bf16_f32 v71, v46, v47
    v_mfma_f32_32x32x16_bf16 v[32:47], a[64:67], a[188:191], 0
    v_exp_f32 v48, v48
    v_exp_f32 v49, v49
    v_exp_f32 v50, v50
    v_cvt_pk_bf16_f32 v64, v48, v49
    v_exp_f32 v51, v51
    v_mfma_f32_32x32x16_bf16 v[128:143], a[76:79], v[68:71], v[128:143]
    v_cvt_pk_bf16_f32 v65, v50, v51
    v_exp_f32 v52, v52
    v_exp_f32 v53, v53
    v_exp_f32 v54, v54
    v_cvt_pk_bf16_f32 v66, v52, v53
    v_exp_f32 v55, v55
    v_mfma_f32_32x32x16_bf16 v[32:47], a[68:71], a[192:195], v[32:47]
    v_cvt_pk_bf16_f32 v67, v54, v55
    v_exp_f32 v56, v56
    v_exp_f32 v57, v57
    v_exp_f32 v58, v58
    v_cvt_pk_bf16_f32 v68, v56, v57
    v_exp_f32 v59, v59
    v_mfma_f32_32x32x16_bf16 v[144:159], a[72:75], v[64:67], v[144:159]
    v_cvt_pk_bf16_f32 v69, v58, v59
    v_exp_f32 v60, v60
    v_exp_f32 v61, v61
    v_exp_f32 v62, v62
    v_exp_f32 v63, v63
    v_cvt_pk_bf16_f32 v70, v60, v61
    v_cvt_pk_bf16_f32 v71, v62, v63
    v_mfma_f32_32x32x16_bf16 v[48:63], a[64:67], a[196:199], 0
    buffer_load_dwordx4 a[32:35], v123, s[52:55], s91 offen offset:0 sc1
    buffer_load_dwordx4 a[36:39], v123, s[52:55], s91 offen offset:1024 sc1
    buffer_load_dwordx4 a[40:43], v123, s[52:55], s91 offen offset:2048 sc1
    buffer_load_dwordx4 a[44:47], v123, s[52:55], s91 offen offset:3072 sc1
    v_exp_f32 v32, v32
    v_exp_f32 v33, v33
    v_exp_f32 v34, v34
    v_cvt_pk_bf16_f32 v64, v32, v33
    v_exp_f32 v35, v35
    v_mfma_f32_32x32x16_bf16 v[144:159], a[76:79], v[68:71], v[144:159]
    v_cvt_pk_bf16_f32 v65, v34, v35
    v_exp_f32 v36, v36
    v_exp_f32 v37, v37
    v_exp_f32 v38, v38
    v_cvt_pk_bf16_f32 v66, v36, v37
    v_exp_f32 v39, v39
    v_mfma_f32_32x32x16_bf16 v[48:63], a[68:71], a[200:203], v[48:63]
    s_xor_b32 s91, s72, 49152
    v_cvt_pk_bf16_f32 v67, v38, v39
    v_exp_f32 v40, v40
    v_exp_f32 v41, v41
    v_exp_f32 v42, v42
    v_cvt_pk_bf16_f32 v68, v40, v41
    v_exp_f32 v43, v43
    v_mfma_f32_32x32x16_bf16 v[160:175], a[72:75], v[64:67], v[160:175]
    s_waitcnt vmcnt(22)
    v_cvt_pk_bf16_f32 v69, v42, v43
    v_exp_f32 v44, v44
    v_exp_f32 v45, v45
    v_exp_f32 v46, v46
    v_exp_f32 v47, v47
    v_cvt_pk_bf16_f32 v70, v44, v45
    v_cvt_pk_bf16_f32 v71, v46, v47
    v_mfma_f32_32x32x16_bf16 v[32:47], a[80:83], v[104:107], 0
    v_exp_f32 v48, v48
    v_exp_f32 v49, v49
    v_exp_f32 v50, v50
    v_cvt_pk_bf16_f32 v64, v48, v49
    v_exp_f32 v51, v51
    v_mfma_f32_32x32x16_bf16 v[160:175], a[76:79], v[68:71], v[160:175]
    v_cvt_pk_bf16_f32 v65, v50, v51
    v_exp_f32 v52, v52
    v_exp_f32 v53, v53
    v_exp_f32 v54, v54
    v_cvt_pk_bf16_f32 v66, v52, v53
    v_exp_f32 v55, v55
    v_mfma_f32_32x32x16_bf16 v[32:47], a[84:87], v[108:111], v[32:47]
    v_cvt_pk_bf16_f32 v67, v54, v55
    v_exp_f32 v56, v56
    v_exp_f32 v57, v57
    v_exp_f32 v58, v58
    v_cvt_pk_bf16_f32 v68, v56, v57
    v_exp_f32 v59, v59
    v_mfma_f32_32x32x16_bf16 v[176:191], a[72:75], v[64:67], v[176:191]
    v_cvt_pk_bf16_f32 v69, v58, v59
    v_exp_f32 v60, v60
    v_exp_f32 v61, v61
    v_exp_f32 v62, v62
    v_exp_f32 v63, v63
    v_cvt_pk_bf16_f32 v70, v60, v61
    v_cvt_pk_bf16_f32 v71, v62, v63
    v_mfma_f32_32x32x16_bf16 v[48:63], a[80:83], a[180:183], 0
    buffer_load_dwordx4 a[48:51], v123, s[52:55], s91 offen offset:0 sc1
    buffer_load_dwordx4 a[52:55], v123, s[52:55], s91 offen offset:1024 sc1
    buffer_load_dwordx4 a[56:59], v123, s[52:55], s91 offen offset:2048 sc1
    buffer_load_dwordx4 a[60:63], v123, s[52:55], s91 offen offset:3072 sc1
    v_exp_f32 v32, v32
    v_exp_f32 v33, v33
    v_exp_f32 v34, v34
    v_cvt_pk_bf16_f32 v64, v32, v33
    v_exp_f32 v35, v35
    v_mfma_f32_32x32x16_bf16 v[176:191], a[76:79], v[68:71], v[176:191]
    v_cvt_pk_bf16_f32 v65, v34, v35
    v_exp_f32 v36, v36
    v_exp_f32 v37, v37
    v_exp_f32 v38, v38
    v_cvt_pk_bf16_f32 v66, v36, v37
    v_exp_f32 v39, v39
    v_mfma_f32_32x32x16_bf16 v[48:63], a[84:87], a[184:187], v[48:63]
    s_waitcnt vmcnt(24)
    v_cvt_pk_bf16_f32 v67, v38, v39
    v_exp_f32 v40, v40
    v_exp_f32 v41, v41
    v_exp_f32 v42, v42
    v_cvt_pk_bf16_f32 v68, v40, v41
    v_exp_f32 v43, v43
    v_mfma_f32_32x32x16_bf16 v[128:143], a[88:91], v[64:67], v[128:143]
    s_xor_b32 s91, s72, 53248
    v_cvt_pk_bf16_f32 v69, v42, v43
    v_exp_f32 v44, v44
    v_exp_f32 v45, v45
    v_exp_f32 v46, v46
    v_exp_f32 v47, v47
    v_cvt_pk_bf16_f32 v70, v44, v45
    v_cvt_pk_bf16_f32 v71, v46, v47
    v_mfma_f32_32x32x16_bf16 v[32:47], a[80:83], a[188:191], 0
    v_exp_f32 v48, v48
    v_exp_f32 v49, v49
    v_exp_f32 v50, v50
    v_cvt_pk_bf16_f32 v64, v48, v49
    v_exp_f32 v51, v51
    v_mfma_f32_32x32x16_bf16 v[128:143], a[92:95], v[68:71], v[128:143]
    v_cvt_pk_bf16_f32 v65, v50, v51
    v_exp_f32 v52, v52
    v_exp_f32 v53, v53
    v_exp_f32 v54, v54
    v_cvt_pk_bf16_f32 v66, v52, v53
    v_exp_f32 v55, v55
    v_mfma_f32_32x32x16_bf16 v[32:47], a[84:87], a[192:195], v[32:47]
    v_cvt_pk_bf16_f32 v67, v54, v55
    v_exp_f32 v56, v56
    v_exp_f32 v57, v57
    v_exp_f32 v58, v58
    v_cvt_pk_bf16_f32 v68, v56, v57
    v_exp_f32 v59, v59
    v_mfma_f32_32x32x16_bf16 v[144:159], a[88:91], v[64:67], v[144:159]
    v_cvt_pk_bf16_f32 v69, v58, v59
    v_exp_f32 v60, v60
    v_exp_f32 v61, v61
    v_exp_f32 v62, v62
    v_exp_f32 v63, v63
    v_cvt_pk_bf16_f32 v70, v60, v61
    v_cvt_pk_bf16_f32 v71, v62, v63
    v_mfma_f32_32x32x16_bf16 v[48:63], a[80:83], a[196:199], 0
    buffer_load_dwordx4 a[64:67], v123, s[52:55], s91 offen offset:0 sc1
    buffer_load_dwordx4 a[68:71], v123, s[52:55], s91 offen offset:1024 sc1
    buffer_load_dwordx4 a[72:75], v123, s[52:55], s91 offen offset:2048 sc1
    buffer_load_dwordx4 a[76:79], v123, s[52:55], s91 offen offset:3072 sc1
    v_exp_f32 v32, v32
    v_exp_f32 v33, v33
    v_exp_f32 v34, v34
    v_cvt_pk_bf16_f32 v64, v32, v33
    v_exp_f32 v35, v35
    v_mfma_f32_32x32x16_bf16 v[144:159], a[92:95], v[68:71], v[144:159]
    v_cvt_pk_bf16_f32 v65, v34, v35
    v_exp_f32 v36, v36
    v_exp_f32 v37, v37
    v_exp_f32 v38, v38
    v_cvt_pk_bf16_f32 v66, v36, v37
    v_exp_f32 v39, v39
    v_mfma_f32_32x32x16_bf16 v[48:63], a[84:87], a[200:203], v[48:63]
    s_xor_b32 s91, s72, 57344
    v_cvt_pk_bf16_f32 v67, v38, v39
    v_exp_f32 v40, v40
    v_exp_f32 v41, v41
    v_exp_f32 v42, v42
    v_cvt_pk_bf16_f32 v68, v40, v41
    v_exp_f32 v43, v43
    v_mfma_f32_32x32x16_bf16 v[160:175], a[88:91], v[64:67], v[160:175]
    s_waitcnt vmcnt(26)
    v_cvt_pk_bf16_f32 v69, v42, v43
    v_exp_f32 v44, v44
    v_exp_f32 v45, v45
    v_exp_f32 v46, v46
    v_exp_f32 v47, v47
    v_cvt_pk_bf16_f32 v70, v44, v45
    v_cvt_pk_bf16_f32 v71, v46, v47
    v_mfma_f32_32x32x16_bf16 v[32:47], a[96:99], v[104:107], 0
    v_exp_f32 v48, v48
    v_exp_f32 v49, v49
    v_exp_f32 v50, v50
    v_cvt_pk_bf16_f32 v64, v48, v49
    v_exp_f32 v51, v51
    v_mfma_f32_32x32x16_bf16 v[160:175], a[92:95], v[68:71], v[160:175]
    v_cvt_pk_bf16_f32 v65, v50, v51
    v_exp_f32 v52, v52
    v_exp_f32 v53, v53
    v_exp_f32 v54, v54
    v_cvt_pk_bf16_f32 v66, v52, v53
    v_exp_f32 v55, v55
    v_mfma_f32_32x32x16_bf16 v[32:47], a[100:103], v[108:111], v[32:47]
    v_cvt_pk_bf16_f32 v67, v54, v55
    v_exp_f32 v56, v56
    v_exp_f32 v57, v57
    v_exp_f32 v58, v58
    v_cvt_pk_bf16_f32 v68, v56, v57
    v_exp_f32 v59, v59
    v_mfma_f32_32x32x16_bf16 v[176:191], a[88:91], v[64:67], v[176:191]
    v_cvt_pk_bf16_f32 v69, v58, v59
    v_exp_f32 v60, v60
    v_exp_f32 v61, v61
    v_exp_f32 v62, v62
    v_exp_f32 v63, v63
    v_cvt_pk_bf16_f32 v70, v60, v61
    v_cvt_pk_bf16_f32 v71, v62, v63
    v_mfma_f32_32x32x16_bf16 v[48:63], a[96:99], a[180:183], 0
    v_exp_f32 v32, v32
    v_exp_f32 v33, v33
    v_exp_f32 v34, v34
    v_cvt_pk_bf16_f32 v64, v32, v33
    v_exp_f32 v35, v35
    v_mfma_f32_32x32x16_bf16 v[176:191], a[92:95], v[68:71], v[176:191]
    v_cvt_pk_bf16_f32 v65, v34, v35
    v_exp_f32 v36, v36
    v_exp_f32 v37, v37
    v_exp_f32 v38, v38
    v_cvt_pk_bf16_f32 v66, v36, v37
    v_exp_f32 v39, v39
    v_mfma_f32_32x32x16_bf16 v[48:63], a[100:103], a[184:187], v[48:63]
    s_waitcnt vmcnt(24)
    v_cvt_pk_bf16_f32 v67, v38, v39
    v_exp_f32 v40, v40
    v_exp_f32 v41, v41
    v_exp_f32 v42, v42
    v_cvt_pk_bf16_f32 v68, v40, v41
    v_exp_f32 v43, v43
    v_mfma_f32_32x32x16_bf16 v[128:143], a[104:107], v[64:67], v[128:143]
    v_cvt_pk_bf16_f32 v69, v42, v43
    v_exp_f32 v44, v44
    v_exp_f32 v45, v45
    v_exp_f32 v46, v46
    v_exp_f32 v47, v47
    v_cvt_pk_bf16_f32 v70, v44, v45
    v_cvt_pk_bf16_f32 v71, v46, v47
    v_mfma_f32_32x32x16_bf16 v[32:47], a[96:99], a[188:191], 0
    v_exp_f32 v48, v48
    v_exp_f32 v49, v49
    v_exp_f32 v50, v50
    v_cvt_pk_bf16_f32 v64, v48, v49
    v_exp_f32 v51, v51
    v_mfma_f32_32x32x16_bf16 v[128:143], a[108:111], v[68:71], v[128:143]
    v_cvt_pk_bf16_f32 v65, v50, v51
    v_exp_f32 v52, v52
    v_exp_f32 v53, v53
    v_exp_f32 v54, v54
    v_cvt_pk_bf16_f32 v66, v52, v53
    v_exp_f32 v55, v55
    v_mfma_f32_32x32x16_bf16 v[32:47], a[100:103], a[192:195], v[32:47]
    v_cvt_pk_bf16_f32 v67, v54, v55
    v_exp_f32 v56, v56
    v_exp_f32 v57, v57
    v_exp_f32 v58, v58
    v_cvt_pk_bf16_f32 v68, v56, v57
    v_exp_f32 v59, v59
    v_mfma_f32_32x32x16_bf16 v[144:159], a[104:107], v[64:67], v[144:159]
    v_cvt_pk_bf16_f32 v69, v58, v59
    v_exp_f32 v60, v60
    v_exp_f32 v61, v61
    v_exp_f32 v62, v62
    v_exp_f32 v63, v63
    v_cvt_pk_bf16_f32 v70, v60, v61
    v_cvt_pk_bf16_f32 v71, v62, v63
    v_mfma_f32_32x32x16_bf16 v[48:63], a[96:99], a[196:199], 0
    buffer_load_dwordx4 a[80:83], v123, s[52:55], s91 offen offset:0 sc1
    buffer_load_dwordx4 a[84:87], v123, s[52:55], s91 offen offset:1024 sc1
    buffer_load_dwordx4 a[88:91], v123, s[52:55], s91 offen offset:2048 sc1
    buffer_load_dwordx4 a[92:95], v123, s[52:55], s91 offen offset:3072 sc1
    v_exp_f32 v32, v32
    v_exp_f32 v33, v33
    v_exp_f32 v34, v34
    v_cvt_pk_bf16_f32 v64, v32, v33
    v_exp_f32 v35, v35
    v_mfma_f32_32x32x16_bf16 v[144:159], a[108:111], v[68:71], v[144:159]
    v_cvt_pk_bf16_f32 v65, v34, v35
    v_exp_f32 v36, v36
    v_exp_f32 v37, v37
    v_exp_f32 v38, v38
    v_cvt_pk_bf16_f32 v66, v36, v37
    v_exp_f32 v39, v39
    v_mfma_f32_32x32x16_bf16 v[48:63], a[100:103], a[200:203], v[48:63]
    s_xor_b32 s91, s72, 61440
    v_cvt_pk_bf16_f32 v67, v38, v39
    v_exp_f32 v40, v40
    v_exp_f32 v41, v41
    v_exp_f32 v42, v42
    v_cvt_pk_bf16_f32 v68, v40, v41
    v_exp_f32 v43, v43
    v_mfma_f32_32x32x16_bf16 v[160:175], a[104:107], v[64:67], v[160:175]
    s_waitcnt vmcnt(26)
    v_cvt_pk_bf16_f32 v69, v42, v43
    v_exp_f32 v44, v44
    v_exp_f32 v45, v45
    v_exp_f32 v46, v46
    v_exp_f32 v47, v47
    v_cvt_pk_bf16_f32 v70, v44, v45
    v_cvt_pk_bf16_f32 v71, v46, v47
    v_mfma_f32_32x32x16_bf16 v[32:47], a[112:115], v[104:107], 0
    v_exp_f32 v48, v48
    v_exp_f32 v49, v49
    v_exp_f32 v50, v50
    v_cvt_pk_bf16_f32 v64, v48, v49
    v_exp_f32 v51, v51
    v_mfma_f32_32x32x16_bf16 v[160:175], a[108:111], v[68:71], v[160:175]
    v_cvt_pk_bf16_f32 v65, v50, v51
    v_exp_f32 v52, v52
    v_exp_f32 v53, v53
    v_exp_f32 v54, v54
    v_cvt_pk_bf16_f32 v66, v52, v53
    v_exp_f32 v55, v55
    v_mfma_f32_32x32x16_bf16 v[32:47], a[116:119], v[108:111], v[32:47]
    v_cvt_pk_bf16_f32 v67, v54, v55
    v_exp_f32 v56, v56
    v_exp_f32 v57, v57
    v_exp_f32 v58, v58
    v_cvt_pk_bf16_f32 v68, v56, v57
    v_exp_f32 v59, v59
    v_mfma_f32_32x32x16_bf16 v[176:191], a[104:107], v[64:67], v[176:191]
    v_cvt_pk_bf16_f32 v69, v58, v59
    v_exp_f32 v60, v60
    v_exp_f32 v61, v61
    v_exp_f32 v62, v62
    v_exp_f32 v63, v63
    v_cvt_pk_bf16_f32 v70, v60, v61
    v_cvt_pk_bf16_f32 v71, v62, v63
    v_mfma_f32_32x32x16_bf16 v[48:63], a[112:115], a[180:183], 0
    v_exp_f32 v32, v32
    v_exp_f32 v33, v33
    v_exp_f32 v34, v34
    v_cvt_pk_bf16_f32 v64, v32, v33
    v_exp_f32 v35, v35
    v_mfma_f32_32x32x16_bf16 v[176:191], a[108:111], v[68:71], v[176:191]
    v_cvt_pk_bf16_f32 v65, v34, v35
    v_exp_f32 v36, v36
    v_exp_f32 v37, v37
    v_exp_f32 v38, v38
    v_cvt_pk_bf16_f32 v66, v36, v37
    v_exp_f32 v39, v39
    v_mfma_f32_32x32x16_bf16 v[48:63], a[116:119], a[184:187], v[48:63]
    s_waitcnt vmcnt(24)
    v_cvt_pk_bf16_f32 v67, v38, v39
    v_exp_f32 v40, v40
    v_exp_f32 v41, v41
    v_exp_f32 v42, v42
    v_cvt_pk_bf16_f32 v68, v40, v41
    v_exp_f32 v43, v43
    v_mfma_f32_32x32x16_bf16 v[128:143], a[120:123], v[64:67], v[128:143]
    v_cvt_pk_bf16_f32 v69, v42, v43
    v_exp_f32 v44, v44
    v_exp_f32 v45, v45
    v_exp_f32 v46, v46
    v_exp_f32 v47, v47
    v_cvt_pk_bf16_f32 v70, v44, v45
    v_cvt_pk_bf16_f32 v71, v46, v47
    v_mfma_f32_32x32x16_bf16 v[32:47], a[112:115], a[188:191], 0
    v_exp_f32 v48, v48
    v_exp_f32 v49, v49
    v_exp_f32 v50, v50
    v_cvt_pk_bf16_f32 v64, v48, v49
    v_exp_f32 v51, v51
    v_mfma_f32_32x32x16_bf16 v[128:143], a[124:127], v[68:71], v[128:143]
    v_cvt_pk_bf16_f32 v65, v50, v51
    v_exp_f32 v52, v52
    v_exp_f32 v53, v53
    v_exp_f32 v54, v54
    v_cvt_pk_bf16_f32 v66, v52, v53
    v_exp_f32 v55, v55
    v_mfma_f32_32x32x16_bf16 v[32:47], a[116:119], a[192:195], v[32:47]
    v_cvt_pk_bf16_f32 v67, v54, v55
    v_exp_f32 v56, v56
    v_exp_f32 v57, v57
    v_exp_f32 v58, v58
    v_cvt_pk_bf16_f32 v68, v56, v57
    v_exp_f32 v59, v59
    v_mfma_f32_32x32x16_bf16 v[144:159], a[120:123], v[64:67], v[144:159]
    v_cvt_pk_bf16_f32 v69, v58, v59
    v_exp_f32 v60, v60
    v_exp_f32 v61, v61
    v_exp_f32 v62, v62
    v_exp_f32 v63, v63
    v_cvt_pk_bf16_f32 v70, v60, v61
    v_cvt_pk_bf16_f32 v71, v62, v63
    v_mfma_f32_32x32x16_bf16 v[48:63], a[112:115], a[196:199], 0
    buffer_load_dwordx4 a[96:99], v123, s[52:55], s91 offen offset:0 sc1
    buffer_load_dwordx4 a[100:103], v123, s[52:55], s91 offen offset:1024 sc1
    buffer_load_dwordx4 a[104:107], v123, s[52:55], s91 offen offset:2048 sc1
    buffer_load_dwordx4 a[108:111], v123, s[52:55], s91 offen offset:3072 sc1
    v_exp_f32 v32, v32
    v_exp_f32 v33, v33
    v_exp_f32 v34, v34
    v_cvt_pk_bf16_f32 v64, v32, v33
    v_exp_f32 v35, v35
    v_mfma_f32_32x32x16_bf16 v[144:159], a[124:127], v[68:71], v[144:159]
    v_cvt_pk_bf16_f32 v65, v34, v35
    v_exp_f32 v36, v36
    v_exp_f32 v37, v37
    v_exp_f32 v38, v38
    v_cvt_pk_bf16_f32 v66, v36, v37
    v_exp_f32 v39, v39
    v_mfma_f32_32x32x16_bf16 v[48:63], a[116:119], a[200:203], v[48:63]
    v_cvt_pk_bf16_f32 v67, v38, v39
    v_exp_f32 v40, v40
    v_exp_f32 v41, v41
    v_exp_f32 v42, v42
    v_cvt_pk_bf16_f32 v68, v40, v41
    v_exp_f32 v43, v43
    v_mfma_f32_32x32x16_bf16 v[160:175], a[120:123], v[64:67], v[160:175]
    s_waitcnt vmcnt(26)
    v_cvt_pk_bf16_f32 v69, v42, v43
    v_exp_f32 v44, v44
    v_exp_f32 v45, v45
    v_exp_f32 v46, v46
    v_exp_f32 v47, v47
    v_cvt_pk_bf16_f32 v70, v44, v45
    v_cvt_pk_bf16_f32 v71, v46, v47
    v_mfma_f32_32x32x16_bf16 v[32:47], a[0:3], v[104:107], 0
    v_exp_f32 v48, v48
    v_exp_f32 v49, v49
    v_exp_f32 v50, v50
    v_cvt_pk_bf16_f32 v64, v48, v49
    v_exp_f32 v51, v51
    v_mfma_f32_32x32x16_bf16 v[160:175], a[124:127], v[68:71], v[160:175]
    v_cvt_pk_bf16_f32 v65, v50, v51
    v_exp_f32 v52, v52
    v_exp_f32 v53, v53
    v_exp_f32 v54, v54
    v_cvt_pk_bf16_f32 v66, v52, v53
    v_exp_f32 v55, v55
    v_mfma_f32_32x32x16_bf16 v[32:47], a[4:7], v[108:111], v[32:47]
    v_cvt_pk_bf16_f32 v67, v54, v55
    v_exp_f32 v56, v56
    v_exp_f32 v57, v57
    v_exp_f32 v58, v58
    v_cvt_pk_bf16_f32 v68, v56, v57
    v_exp_f32 v59, v59
    v_mfma_f32_32x32x16_bf16 v[176:191], a[120:123], v[64:67], v[176:191]
    v_cvt_pk_bf16_f32 v69, v58, v59
    v_exp_f32 v60, v60
    v_exp_f32 v61, v61
    v_exp_f32 v62, v62
    v_exp_f32 v63, v63
    v_cvt_pk_bf16_f32 v70, v60, v61
    v_cvt_pk_bf16_f32 v71, v62, v63
    v_mfma_f32_32x32x16_bf16 v[48:63], a[0:3], a[180:183], 0
    v_exp_f32 v32, v32
    v_exp_f32 v33, v33
    v_exp_f32 v34, v34
    v_cvt_pk_bf16_f32 v64, v32, v33
    v_exp_f32 v35, v35
    v_mfma_f32_32x32x16_bf16 v[176:191], a[124:127], v[68:71], v[176:191]
    v_cvt_pk_bf16_f32 v65, v34, v35
    v_exp_f32 v36, v36
    v_exp_f32 v37, v37
    v_exp_f32 v38, v38
    v_cvt_pk_bf16_f32 v66, v36, v37
    v_exp_f32 v39, v39
    v_mfma_f32_32x32x16_bf16 v[48:63], a[4:7], a[184:187], v[48:63]
    s_waitcnt vmcnt(24)
    v_cvt_pk_bf16_f32 v67, v38, v39
    v_exp_f32 v40, v40
    v_exp_f32 v41, v41
    v_exp_f32 v42, v42
    v_cvt_pk_bf16_f32 v68, v40, v41
    v_exp_f32 v43, v43
    v_mfma_f32_32x32x16_bf16 v[128:143], a[8:11], v[64:67], v[128:143]
    v_cvt_pk_bf16_f32 v69, v42, v43
    v_exp_f32 v44, v44
    v_exp_f32 v45, v45
    v_exp_f32 v46, v46
    v_exp_f32 v47, v47
    v_cvt_pk_bf16_f32 v70, v44, v45
    v_cvt_pk_bf16_f32 v71, v46, v47
    v_mfma_f32_32x32x16_bf16 v[32:47], a[0:3], a[188:191], 0
    v_exp_f32 v48, v48
    v_exp_f32 v49, v49
    v_exp_f32 v50, v50
    v_cvt_pk_bf16_f32 v64, v48, v49
    v_exp_f32 v51, v51
    v_mfma_f32_32x32x16_bf16 v[128:143], a[12:15], v[68:71], v[128:143]
    v_cvt_pk_bf16_f32 v65, v50, v51
    v_exp_f32 v52, v52
    v_exp_f32 v53, v53
    v_exp_f32 v54, v54
    v_cvt_pk_bf16_f32 v66, v52, v53
    v_exp_f32 v55, v55
    v_mfma_f32_32x32x16_bf16 v[32:47], a[4:7], a[192:195], v[32:47]
    v_cvt_pk_bf16_f32 v67, v54, v55
    v_exp_f32 v56, v56
    v_exp_f32 v57, v57
    v_exp_f32 v58, v58
    v_cvt_pk_bf16_f32 v68, v56, v57
    v_exp_f32 v59, v59
    v_mfma_f32_32x32x16_bf16 v[144:159], a[8:11], v[64:67], v[144:159]
    v_cvt_pk_bf16_f32 v69, v58, v59
    v_exp_f32 v60, v60
    v_exp_f32 v61, v61
    v_exp_f32 v62, v62
    v_exp_f32 v63, v63
    v_cvt_pk_bf16_f32 v70, v60, v61
    v_cvt_pk_bf16_f32 v71, v62, v63
    v_mfma_f32_32x32x16_bf16 v[48:63], a[0:3], a[196:199], 0
    v_exp_f32 v32, v32
    v_exp_f32 v33, v33
    v_exp_f32 v34, v34
    v_cvt_pk_bf16_f32 v64, v32, v33
    v_exp_f32 v35, v35
    v_mfma_f32_32x32x16_bf16 v[144:159], a[12:15], v[68:71], v[144:159]
    v_cvt_pk_bf16_f32 v65, v34, v35
    v_exp_f32 v36, v36
    v_exp_f32 v37, v37
    v_exp_f32 v38, v38
    v_cvt_pk_bf16_f32 v66, v36, v37
    v_exp_f32 v39, v39
    v_mfma_f32_32x32x16_bf16 v[48:63], a[4:7], a[200:203], v[48:63]
    v_cvt_pk_bf16_f32 v67, v38, v39
    v_exp_f32 v40, v40
    v_exp_f32 v41, v41
    v_exp_f32 v42, v42
    v_cvt_pk_bf16_f32 v68, v40, v41
    v_exp_f32 v43, v43
    v_mfma_f32_32x32x16_bf16 v[160:175], a[8:11], v[64:67], v[160:175]
    s_waitcnt vmcnt(22)
    v_cvt_pk_bf16_f32 v69, v42, v43
    v_exp_f32 v44, v44
    v_exp_f32 v45, v45
    v_exp_f32 v46, v46
    v_exp_f32 v47, v47
    v_cvt_pk_bf16_f32 v70, v44, v45
    v_cvt_pk_bf16_f32 v71, v46, v47
    v_mfma_f32_32x32x16_bf16 v[32:47], a[16:19], v[104:107], 0
    v_exp_f32 v48, v48
    v_exp_f32 v49, v49
    v_exp_f32 v50, v50
    v_cvt_pk_bf16_f32 v64, v48, v49
    v_exp_f32 v51, v51
    v_mfma_f32_32x32x16_bf16 v[160:175], a[12:15], v[68:71], v[160:175]
    v_cvt_pk_bf16_f32 v65, v50, v51
L_page_5:
    s_cbranch_vccnz L_page_9
    v_exp_f32 v52, v52
    v_exp_f32 v53, v53
    v_exp_f32 v54, v54
    v_cvt_pk_bf16_f32 v66, v52, v53
    v_exp_f32 v55, v55
    v_mfma_f32_32x32x16_bf16 v[32:47], a[20:23], v[108:111], v[32:47]
    v_cvt_pk_bf16_f32 v67, v54, v55
    v_exp_f32 v56, v56
    v_exp_f32 v57, v57
    v_exp_f32 v58, v58
    v_cvt_pk_bf16_f32 v68, v56, v57
    v_exp_f32 v59, v59
    v_mfma_f32_32x32x16_bf16 v[176:191], a[8:11], v[64:67], v[176:191]
    v_cvt_pk_bf16_f32 v69, v58, v59
    v_exp_f32 v60, v60
    v_exp_f32 v61, v61
    v_exp_f32 v62, v62
    v_exp_f32 v63, v63
    v_cvt_pk_bf16_f32 v70, v60, v61
    v_cvt_pk_bf16_f32 v71, v62, v63
    v_mfma_f32_32x32x16_bf16 v[48:63], a[16:19], a[180:183], 0
    v_exp_f32 v32, v32
    v_exp_f32 v33, v33
    v_exp_f32 v34, v34
    v_cvt_pk_bf16_f32 v64, v32, v33
    v_exp_f32 v35, v35
    v_mfma_f32_32x32x16_bf16 v[176:191], a[12:15], v[68:71], v[176:191]
    v_cvt_pk_bf16_f32 v65, v34, v35
    v_exp_f32 v36, v36
    v_exp_f32 v37, v37
    v_exp_f32 v38, v38
    v_cvt_pk_bf16_f32 v66, v36, v37
    v_exp_f32 v39, v39
    v_mfma_f32_32x32x16_bf16 v[48:63], a[20:23], a[184:187], v[48:63]
    s_waitcnt vmcnt(20)
    v_cvt_pk_bf16_f32 v67, v38, v39
    v_exp_f32 v40, v40
    v_exp_f32 v41, v41
    v_exp_f32 v42, v42
    v_cvt_pk_bf16_f32 v68, v40, v41
    v_exp_f32 v43, v43
    v_mfma_f32_32x32x16_bf16 v[128:143], a[24:27], v[64:67], v[128:143]
    v_cvt_pk_bf16_f32 v69, v42, v43
    v_exp_f32 v44, v44
    v_exp_f32 v45, v45
    v_exp_f32 v46, v46
    v_exp_f32 v47, v47
    v_cvt_pk_bf16_f32 v70, v44, v45
    v_cvt_pk_bf16_f32 v71, v46, v47
    v_mfma_f32_32x32x16_bf16 v[32:47], a[16:19], a[188:191], 0
    v_exp_f32 v48, v48
    v_exp_f32 v49, v49
    v_exp_f32 v50, v50
    v_cvt_pk_bf16_f32 v64, v48, v49
    v_exp_f32 v51, v51
    v_mfma_f32_32x32x16_bf16 v[128:143], a[28:31], v[68:71], v[128:143]
    v_cvt_pk_bf16_f32 v65, v50, v51
    v_exp_f32 v52, v52
    v_exp_f32 v53, v53
    v_exp_f32 v54, v54
    v_cvt_pk_bf16_f32 v66, v52, v53
    v_exp_f32 v55, v55
    v_mfma_f32_32x32x16_bf16 v[32:47], a[20:23], a[192:195], v[32:47]
    v_cvt_pk_bf16_f32 v67, v54, v55
    v_exp_f32 v56, v56
    v_exp_f32 v57, v57
    v_exp_f32 v58, v58
    v_cvt_pk_bf16_f32 v68, v56, v57
    v_exp_f32 v59, v59
    v_mfma_f32_32x32x16_bf16 v[144:159], a[24:27], v[64:67], v[144:159]
    v_cvt_pk_bf16_f32 v69, v58, v59
    v_exp_f32 v60, v60
    v_exp_f32 v61, v61
    v_exp_f32 v62, v62
    v_exp_f32 v63, v63
    v_cvt_pk_bf16_f32 v70, v60, v61
    v_cvt_pk_bf16_f32 v71, v62, v63
    v_mfma_f32_32x32x16_bf16 v[48:63], a[16:19], a[196:199], 0
    v_exp_f32 v32, v32
    v_exp_f32 v33, v33
    v_exp_f32 v34, v34
    v_cvt_pk_bf16_f32 v64, v32, v33
    v_exp_f32 v35, v35
    v_mfma_f32_32x32x16_bf16 v[144:159], a[28:31], v[68:71], v[144:159]
    v_cvt_pk_bf16_f32 v65, v34, v35
    v_exp_f32 v36, v36
    v_exp_f32 v37, v37
    v_exp_f32 v38, v38
    v_cvt_pk_bf16_f32 v66, v36, v37
    v_exp_f32 v39, v39
    v_mfma_f32_32x32x16_bf16 v[48:63], a[20:23], a[200:203], v[48:63]
    v_cvt_pk_bf16_f32 v67, v38, v39
    v_exp_f32 v40, v40
    v_exp_f32 v41, v41
    v_exp_f32 v42, v42
    v_cvt_pk_bf16_f32 v68, v40, v41
    v_exp_f32 v43, v43
    v_mfma_f32_32x32x16_bf16 v[160:175], a[24:27], v[64:67], v[160:175]
    s_waitcnt vmcnt(18)
    v_cvt_pk_bf16_f32 v69, v42, v43
    v_exp_f32 v44, v44
    v_exp_f32 v45, v45
    v_exp_f32 v46, v46
    v_exp_f32 v47, v47
    v_cvt_pk_bf16_f32 v70, v44, v45
    v_cvt_pk_bf16_f32 v71, v46, v47
    v_mfma_f32_32x32x16_bf16 v[32:47], a[32:35], v[104:107], 0
    v_exp_f32 v48, v48
    v_exp_f32 v49, v49
    v_exp_f32 v50, v50
    v_cvt_pk_bf16_f32 v64, v48, v49
    v_exp_f32 v51, v51
    v_mfma_f32_32x32x16_bf16 v[160:175], a[28:31], v[68:71], v[160:175]
    v_cvt_pk_bf16_f32 v65, v50, v51
    v_exp_f32 v52, v52
    v_exp_f32 v53, v53
    v_exp_f32 v54, v54
    v_cvt_pk_bf16_f32 v66, v52, v53
    v_exp_f32 v55, v55
    v_mfma_f32_32x32x16_bf16 v[32:47], a[36:39], v[108:111], v[32:47]
    v_cvt_pk_bf16_f32 v67, v54, v55
    v_exp_f32 v56, v56
    v_exp_f32 v57, v57
    v_exp_f32 v58, v58
    v_cvt_pk_bf16_f32 v68, v56, v57
    v_exp_f32 v59, v59
    v_mfma_f32_32x32x16_bf16 v[176:191], a[24:27], v[64:67], v[176:191]
    v_cvt_pk_bf16_f32 v69, v58, v59
    v_exp_f32 v60, v60
    v_exp_f32 v61, v61
    v_exp_f32 v62, v62
    v_exp_f32 v63, v63
    v_cvt_pk_bf16_f32 v70, v60, v61
    v_cvt_pk_bf16_f32 v71, v62, v63
    v_mfma_f32_32x32x16_bf16 v[48:63], a[32:35], a[180:183], 0
    v_exp_f32 v32, v32
    v_exp_f32 v33, v33
    v_exp_f32 v34, v34
    v_cvt_pk_bf16_f32 v64, v32, v33
    v_exp_f32 v35, v35
    v_mfma_f32_32x32x16_bf16 v[176:191], a[28:31], v[68:71], v[176:191]
    v_cvt_pk_bf16_f32 v65, v34, v35
    v_exp_f32 v36, v36
    v_exp_f32 v37, v37
    v_exp_f32 v38, v38
    v_cvt_pk_bf16_f32 v66, v36, v37
    v_exp_f32 v39, v39
    v_mfma_f32_32x32x16_bf16 v[48:63], a[36:39], a[184:187], v[48:63]
    s_waitcnt vmcnt(16)
    v_cvt_pk_bf16_f32 v67, v38, v39
    v_exp_f32 v40, v40
    v_exp_f32 v41, v41
    v_exp_f32 v42, v42
    v_cvt_pk_bf16_f32 v68, v40, v41
    v_exp_f32 v43, v43
    v_mfma_f32_32x32x16_bf16 v[128:143], a[40:43], v[64:67], v[128:143]
    v_cvt_pk_bf16_f32 v69, v42, v43
    v_exp_f32 v44, v44
    v_exp_f32 v45, v45
    v_exp_f32 v46, v46
    v_exp_f32 v47, v47
    v_cvt_pk_bf16_f32 v70, v44, v45
    v_cvt_pk_bf16_f32 v71, v46, v47
    v_mfma_f32_32x32x16_bf16 v[32:47], a[32:35], a[188:191], 0
    v_exp_f32 v48, v48
    v_exp_f32 v49, v49
    v_exp_f32 v50, v50
    v_cvt_pk_bf16_f32 v64, v48, v49
    v_exp_f32 v51, v51
    v_mfma_f32_32x32x16_bf16 v[128:143], a[44:47], v[68:71], v[128:143]
    v_cvt_pk_bf16_f32 v65, v50, v51
    v_exp_f32 v52, v52
    v_exp_f32 v53, v53
    v_exp_f32 v54, v54
    v_cvt_pk_bf16_f32 v66, v52, v53
    v_exp_f32 v55, v55
    v_mfma_f32_32x32x16_bf16 v[32:47], a[36:39], a[192:195], v[32:47]
    v_cvt_pk_bf16_f32 v67, v54, v55
    v_exp_f32 v56, v56
    v_exp_f32 v57, v57
    v_exp_f32 v58, v58
    v_cvt_pk_bf16_f32 v68, v56, v57
    v_exp_f32 v59, v59
    v_mfma_f32_32x32x16_bf16 v[144:159], a[40:43], v[64:67], v[144:159]
    v_cvt_pk_bf16_f32 v69, v58, v59
    v_exp_f32 v60, v60
    v_exp_f32 v61, v61
    v_exp_f32 v62, v62
    v_exp_f32 v63, v63
    v_cvt_pk_bf16_f32 v70, v60, v61
    v_cvt_pk_bf16_f32 v71, v62, v63
    v_mfma_f32_32x32x16_bf16 v[48:63], a[32:35], a[196:199], 0
    v_exp_f32 v32, v32
    v_exp_f32 v33, v33
    v_exp_f32 v34, v34
    v_cvt_pk_bf16_f32 v64, v32, v33
    v_exp_f32 v35, v35
    v_mfma_f32_32x32x16_bf16 v[144:159], a[44:47], v[68:71], v[144:159]
    v_cvt_pk_bf16_f32 v65, v34, v35
    v_exp_f32 v36, v36
    v_exp_f32 v37, v37
    v_exp_f32 v38, v38
    v_cvt_pk_bf16_f32 v66, v36, v37
    v_exp_f32 v39, v39
    v_mfma_f32_32x32x16_bf16 v[48:63], a[36:39], a[200:203], v[48:63]
    v_cvt_pk_bf16_f32 v67, v38, v39
    v_exp_f32 v40, v40
    v_exp_f32 v41, v41
    v_exp_f32 v42, v42
    v_cvt_pk_bf16_f32 v68, v40, v41
    v_exp_f32 v43, v43
    v_mfma_f32_32x32x16_bf16 v[160:175], a[40:43], v[64:67], v[160:175]
    s_waitcnt vmcnt(14)
    v_cvt_pk_bf16_f32 v69, v42, v43
    v_exp_f32 v44, v44
    v_exp_f32 v45, v45
    v_exp_f32 v46, v46
    v_exp_f32 v47, v47
    v_cvt_pk_bf16_f32 v70, v44, v45
    v_cvt_pk_bf16_f32 v71, v46, v47
    v_mfma_f32_32x32x16_bf16 v[32:47], a[48:51], v[104:107], 0
    v_exp_f32 v48, v48
    v_exp_f32 v49, v49
    v_exp_f32 v50, v50
    v_cvt_pk_bf16_f32 v64, v48, v49
    v_exp_f32 v51, v51
    v_mfma_f32_32x32x16_bf16 v[160:175], a[44:47], v[68:71], v[160:175]
    v_cvt_pk_bf16_f32 v65, v50, v51
    v_exp_f32 v52, v52
    v_exp_f32 v53, v53
    v_exp_f32 v54, v54
    v_cvt_pk_bf16_f32 v66, v52, v53
    v_exp_f32 v55, v55
    v_mfma_f32_32x32x16_bf16 v[32:47], a[52:55], v[108:111], v[32:47]
    v_cvt_pk_bf16_f32 v67, v54, v55
    v_exp_f32 v56, v56
    v_exp_f32 v57, v57
    v_exp_f32 v58, v58
    v_cvt_pk_bf16_f32 v68, v56, v57
    v_exp_f32 v59, v59
    v_mfma_f32_32x32x16_bf16 v[176:191], a[40:43], v[64:67], v[176:191]
    v_cvt_pk_bf16_f32 v69, v58, v59
    v_exp_f32 v60, v60
    v_exp_f32 v61, v61
    v_exp_f32 v62, v62
    v_exp_f32 v63, v63
    v_cvt_pk_bf16_f32 v70, v60, v61
    v_cvt_pk_bf16_f32 v71, v62, v63
    v_mfma_f32_32x32x16_bf16 v[48:63], a[48:51], a[180:183], 0
    v_exp_f32 v32, v32
    v_exp_f32 v33, v33
    v_exp_f32 v34, v34
    v_cvt_pk_bf16_f32 v64, v32, v33
    v_exp_f32 v35, v35
    v_mfma_f32_32x32x16_bf16 v[176:191], a[44:47], v[68:71], v[176:191]
    v_cvt_pk_bf16_f32 v65, v34, v35
    v_exp_f32 v36, v36
    v_exp_f32 v37, v37
    v_exp_f32 v38, v38
    v_cvt_pk_bf16_f32 v66, v36, v37
    v_exp_f32 v39, v39
    v_mfma_f32_32x32x16_bf16 v[48:63], a[52:55], a[184:187], v[48:63]
    s_waitcnt vmcnt(12)
    v_cvt_pk_bf16_f32 v67, v38, v39
    v_exp_f32 v40, v40
    v_exp_f32 v41, v41
    v_exp_f32 v42, v42
    v_cvt_pk_bf16_f32 v68, v40, v41
    v_exp_f32 v43, v43
    v_mfma_f32_32x32x16_bf16 v[128:143], a[56:59], v[64:67], v[128:143]
    v_cvt_pk_bf16_f32 v69, v42, v43
    v_exp_f32 v44, v44
    v_exp_f32 v45, v45
    v_exp_f32 v46, v46
    v_exp_f32 v47, v47
    v_cvt_pk_bf16_f32 v70, v44, v45
    v_cvt_pk_bf16_f32 v71, v46, v47
    v_mfma_f32_32x32x16_bf16 v[32:47], a[48:51], a[188:191], 0
    v_exp_f32 v48, v48
    v_exp_f32 v49, v49
    v_exp_f32 v50, v50
    v_cvt_pk_bf16_f32 v64, v48, v49
    v_exp_f32 v51, v51
    v_mfma_f32_32x32x16_bf16 v[128:143], a[60:63], v[68:71], v[128:143]
    v_cvt_pk_bf16_f32 v65, v50, v51
    v_exp_f32 v52, v52
    v_exp_f32 v53, v53
    v_exp_f32 v54, v54
    v_cvt_pk_bf16_f32 v66, v52, v53
    v_exp_f32 v55, v55
    v_mfma_f32_32x32x16_bf16 v[32:47], a[52:55], a[192:195], v[32:47]
    v_cvt_pk_bf16_f32 v67, v54, v55
    v_exp_f32 v56, v56
    v_exp_f32 v57, v57
    v_exp_f32 v58, v58
    v_cvt_pk_bf16_f32 v68, v56, v57
    v_exp_f32 v59, v59
    v_mfma_f32_32x32x16_bf16 v[144:159], a[56:59], v[64:67], v[144:159]
    v_cvt_pk_bf16_f32 v69, v58, v59
    v_exp_f32 v60, v60
    v_exp_f32 v61, v61
    v_exp_f32 v62, v62
    v_exp_f32 v63, v63
    v_cvt_pk_bf16_f32 v70, v60, v61
    v_cvt_pk_bf16_f32 v71, v62, v63
    v_mfma_f32_32x32x16_bf16 v[48:63], a[48:51], a[196:199], 0
    v_exp_f32 v32, v32
    v_exp_f32 v33, v33
    v_exp_f32 v34, v34
    v_cvt_pk_bf16_f32 v64, v32, v33
    v_exp_f32 v35, v35
    v_mfma_f32_32x32x16_bf16 v[144:159], a[60:63], v[68:71], v[144:159]
    v_cvt_pk_bf16_f32 v65, v34, v35
    v_exp_f32 v36, v36
    v_exp_f32 v37, v37
    v_exp_f32 v38, v38
    v_cvt_pk_bf16_f32 v66, v36, v37
    v_exp_f32 v39, v39
    v_mfma_f32_32x32x16_bf16 v[48:63], a[52:55], a[200:203], v[48:63]
    v_cvt_pk_bf16_f32 v67, v38, v39
    v_exp_f32 v40, v40
    v_exp_f32 v41, v41
    v_exp_f32 v42, v42
    v_cvt_pk_bf16_f32 v68, v40, v41
    v_exp_f32 v43, v43
    v_mfma_f32_32x32x16_bf16 v[160:175], a[56:59], v[64:67], v[160:175]
    s_waitcnt vmcnt(10)
    v_cvt_pk_bf16_f32 v69, v42, v43
    v_exp_f32 v44, v44
    v_exp_f32 v45, v45
    v_exp_f32 v46, v46
    v_exp_f32 v47, v47
    v_cvt_pk_bf16_f32 v70, v44, v45
    v_cvt_pk_bf16_f32 v71, v46, v47
    v_mfma_f32_32x32x16_bf16 v[32:47], a[64:67], v[104:107], 0
    v_exp_f32 v48, v48
    v_exp_f32 v49, v49
    v_exp_f32 v50, v50
    v_cvt_pk_bf16_f32 v64, v48, v49
    v_exp_f32 v51, v51
    v_mfma_f32_32x32x16_bf16 v[160:175], a[60:63], v[68:71], v[160:175]
    v_cvt_pk_bf16_f32 v65, v50, v51
    v_exp_f32 v52, v52
    v_exp_f32 v53, v53
    v_exp_f32 v54, v54
    v_cvt_pk_bf16_f32 v66, v52, v53
    v_exp_f32 v55, v55
    v_mfma_f32_32x32x16_bf16 v[32:47], a[68:71], v[108:111], v[32:47]
    v_cvt_pk_bf16_f32 v67, v54, v55
    v_exp_f32 v56, v56
    v_exp_f32 v57, v57
    v_exp_f32 v58, v58
    v_cvt_pk_bf16_f32 v68, v56, v57
    v_exp_f32 v59, v59
    v_mfma_f32_32x32x16_bf16 v[176:191], a[56:59], v[64:67], v[176:191]
    v_cvt_pk_bf16_f32 v69, v58, v59
    v_exp_f32 v60, v60
    v_exp_f32 v61, v61
    v_exp_f32 v62, v62
    v_exp_f32 v63, v63
    v_cvt_pk_bf16_f32 v70, v60, v61
    v_cvt_pk_bf16_f32 v71, v62, v63
    v_mfma_f32_32x32x16_bf16 v[48:63], a[64:67], a[180:183], 0
    v_exp_f32 v32, v32
    v_exp_f32 v33, v33
    v_exp_f32 v34, v34
    v_cvt_pk_bf16_f32 v64, v32, v33
    v_exp_f32 v35, v35
    v_mfma_f32_32x32x16_bf16 v[176:191], a[60:63], v[68:71], v[176:191]
    v_cvt_pk_bf16_f32 v65, v34, v35
    v_exp_f32 v36, v36
    v_exp_f32 v37, v37
    v_exp_f32 v38, v38
    v_cvt_pk_bf16_f32 v66, v36, v37
    v_exp_f32 v39, v39
    v_mfma_f32_32x32x16_bf16 v[48:63], a[68:71], a[184:187], v[48:63]
    s_waitcnt vmcnt(8)
    v_cvt_pk_bf16_f32 v67, v38, v39
    v_exp_f32 v40, v40
    v_exp_f32 v41, v41
    v_exp_f32 v42, v42
    v_cvt_pk_bf16_f32 v68, v40, v41
    v_exp_f32 v43, v43
    v_mfma_f32_32x32x16_bf16 v[128:143], a[72:75], v[64:67], v[128:143]
    v_cvt_pk_bf16_f32 v69, v42, v43
    v_exp_f32 v44, v44
    v_exp_f32 v45, v45
    v_exp_f32 v46, v46
    v_exp_f32 v47, v47
    v_cvt_pk_bf16_f32 v70, v44, v45
    v_cvt_pk_bf16_f32 v71, v46, v47
    v_mfma_f32_32x32x16_bf16 v[32:47], a[64:67], a[188:191], 0
    v_exp_f32 v48, v48
    v_exp_f32 v49, v49
    v_exp_f32 v50, v50
    v_cvt_pk_bf16_f32 v64, v48, v49
    v_exp_f32 v51, v51
    v_mfma_f32_32x32x16_bf16 v[128:143], a[76:79], v[68:71], v[128:143]
    v_cvt_pk_bf16_f32 v65, v50, v51
    v_exp_f32 v52, v52
    v_exp_f32 v53, v53
    v_exp_f32 v54, v54
    v_cvt_pk_bf16_f32 v66, v52, v53
    v_exp_f32 v55, v55
    v_mfma_f32_32x32x16_bf16 v[32:47], a[68:71], a[192:195], v[32:47]
    v_cvt_pk_bf16_f32 v67, v54, v55
    v_exp_f32 v56, v56
    v_exp_f32 v57, v57
    v_exp_f32 v58, v58
    v_cvt_pk_bf16_f32 v68, v56, v57
    v_exp_f32 v59, v59
    v_mfma_f32_32x32x16_bf16 v[144:159], a[72:75], v[64:67], v[144:159]
    v_cvt_pk_bf16_f32 v69, v58, v59
    v_exp_f32 v60, v60
    v_exp_f32 v61, v61
    v_exp_f32 v62, v62
    v_exp_f32 v63, v63
    v_cvt_pk_bf16_f32 v70, v60, v61
    v_cvt_pk_bf16_f32 v71, v62, v63
    v_mfma_f32_32x32x16_bf16 v[48:63], a[64:67], a[196:199], 0
    v_exp_f32 v32, v32
    v_exp_f32 v33, v33
    v_exp_f32 v34, v34
    v_cvt_pk_bf16_f32 v64, v32, v33
    v_exp_f32 v35, v35
    v_mfma_f32_32x32x16_bf16 v[144:159], a[76:79], v[68:71], v[144:159]
    v_cvt_pk_bf16_f32 v65, v34, v35
    v_exp_f32 v36, v36
    v_exp_f32 v37, v37
    v_exp_f32 v38, v38
    v_cvt_pk_bf16_f32 v66, v36, v37
    v_exp_f32 v39, v39
    v_mfma_f32_32x32x16_bf16 v[48:63], a[68:71], a[200:203], v[48:63]
    v_cvt_pk_bf16_f32 v67, v38, v39
    v_exp_f32 v40, v40
    v_exp_f32 v41, v41
    v_exp_f32 v42, v42
    v_cvt_pk_bf16_f32 v68, v40, v41
    v_exp_f32 v43, v43
    v_mfma_f32_32x32x16_bf16 v[160:175], a[72:75], v[64:67], v[160:175]
    s_waitcnt vmcnt(6)
    v_cvt_pk_bf16_f32 v69, v42, v43
    v_exp_f32 v44, v44
    v_exp_f32 v45, v45
    v_exp_f32 v46, v46
    v_exp_f32 v47, v47
    v_cvt_pk_bf16_f32 v70, v44, v45
    v_cvt_pk_bf16_f32 v71, v46, v47
    v_mfma_f32_32x32x16_bf16 v[32:47], a[80:83], a[180:183], 0
    v_exp_f32 v48, v48
    v_exp_f32 v49, v49
    v_exp_f32 v50, v50
    v_cvt_pk_bf16_f32 v64, v48, v49
    v_exp_f32 v51, v51
    v_mfma_f32_32x32x16_bf16 v[160:175], a[76:79], v[68:71], v[160:175]
    v_cvt_pk_bf16_f32 v65, v50, v51
    v_exp_f32 v52, v52
    v_exp_f32 v53, v53
    v_exp_f32 v54, v54
    v_cvt_pk_bf16_f32 v66, v52, v53
    v_exp_f32 v55, v55
    v_mfma_f32_32x32x16_bf16 v[32:47], a[84:87], a[184:187], v[32:47]
    v_cvt_pk_bf16_f32 v67, v54, v55
    v_exp_f32 v56, v56
    v_exp_f32 v57, v57
    v_exp_f32 v58, v58
    v_cvt_pk_bf16_f32 v68, v56, v57
    v_exp_f32 v59, v59
    v_mfma_f32_32x32x16_bf16 v[176:191], a[72:75], v[64:67], v[176:191]
    v_cvt_pk_bf16_f32 v69, v58, v59
    v_exp_f32 v60, v60
    v_exp_f32 v61, v61
    v_exp_f32 v62, v62
    v_exp_f32 v63, v63
    v_cvt_pk_bf16_f32 v70, v60, v61
    v_cvt_pk_bf16_f32 v71, v62, v63
    v_mfma_f32_32x32x16_bf16 v[48:63], a[80:83], a[188:191], 0
    v_exp_f32 v32, v32
    v_exp_f32 v33, v33
    v_exp_f32 v34, v34
    v_cvt_pk_bf16_f32 v64, v32, v33
    v_exp_f32 v35, v35
    v_mfma_f32_32x32x16_bf16 v[176:191], a[76:79], v[68:71], v[176:191]
    v_cvt_pk_bf16_f32 v65, v34, v35
    v_exp_f32 v36, v36
    v_exp_f32 v37, v37
    v_exp_f32 v38, v38
    v_cvt_pk_bf16_f32 v66, v36, v37
    v_exp_f32 v39, v39
    v_mfma_f32_32x32x16_bf16 v[48:63], a[84:87], a[192:195], v[48:63]
    s_waitcnt vmcnt(4)
    v_cvt_pk_bf16_f32 v67, v38, v39
    v_exp_f32 v40, v40
    v_exp_f32 v41, v41
    v_exp_f32 v42, v42
    v_cvt_pk_bf16_f32 v68, v40, v41
    v_exp_f32 v43, v43
    v_mfma_f32_32x32x16_bf16 v[144:159], a[88:91], v[64:67], v[144:159]
    v_cvt_pk_bf16_f32 v69, v42, v43
    v_exp_f32 v44, v44
    v_exp_f32 v45, v45
    v_exp_f32 v46, v46
    v_exp_f32 v47, v47
    v_cvt_pk_bf16_f32 v70, v44, v45
    v_cvt_pk_bf16_f32 v71, v46, v47
    v_mfma_f32_32x32x16_bf16 v[32:47], a[80:83], a[196:199], 0
    v_exp_f32 v48, v48
    v_exp_f32 v49, v49
    v_exp_f32 v50, v50
    v_cvt_pk_bf16_f32 v64, v48, v49
    v_exp_f32 v51, v51
    v_mfma_f32_32x32x16_bf16 v[144:159], a[92:95], v[68:71], v[144:159]
    v_cvt_pk_bf16_f32 v65, v50, v51
    v_exp_f32 v52, v52
    v_exp_f32 v53, v53
    v_exp_f32 v54, v54
    v_cvt_pk_bf16_f32 v66, v52, v53
    v_exp_f32 v55, v55
    v_mfma_f32_32x32x16_bf16 v[32:47], a[84:87], a[200:203], v[32:47]
    v_cvt_pk_bf16_f32 v67, v54, v55
    v_exp_f32 v56, v56
    v_exp_f32 v57, v57
    v_exp_f32 v58, v58
    v_cvt_pk_bf16_f32 v68, v56, v57
    v_exp_f32 v59, v59
    v_mfma_f32_32x32x16_bf16 v[160:175], a[88:91], v[64:67], v[160:175]
    s_waitcnt vmcnt(2)
    v_cvt_pk_bf16_f32 v69, v58, v59
    v_exp_f32 v60, v60
    v_exp_f32 v61, v61
    v_exp_f32 v62, v62
    v_exp_f32 v63, v63
    v_cvt_pk_bf16_f32 v70, v60, v61
    v_cvt_pk_bf16_f32 v71, v62, v63
    v_mfma_f32_32x32x16_bf16 v[48:63], a[96:99], a[180:183], 0
    v_exp_f32 v32, v32
    v_exp_f32 v33, v33
    v_exp_f32 v34, v34
    v_cvt_pk_bf16_f32 v64, v32, v33
    v_exp_f32 v35, v35
    v_mfma_f32_32x32x16_bf16 v[160:175], a[92:95], v[68:71], v[160:175]
    v_cvt_pk_bf16_f32 v65, v34, v35
    v_exp_f32 v36, v36
    v_exp_f32 v37, v37
    v_exp_f32 v38, v38
    v_cvt_pk_bf16_f32 v66, v36, v37
    v_exp_f32 v39, v39
    v_mfma_f32_32x32x16_bf16 v[48:63], a[100:103], a[184:187], v[48:63]
    v_cvt_pk_bf16_f32 v67, v38, v39
    v_exp_f32 v40, v40
    v_exp_f32 v41, v41
    v_exp_f32 v42, v42
    v_cvt_pk_bf16_f32 v68, v40, v41
    v_exp_f32 v43, v43
    v_mfma_f32_32x32x16_bf16 v[176:191], a[88:91], v[64:67], v[176:191]
    v_cvt_pk_bf16_f32 v69, v42, v43
    v_exp_f32 v44, v44
    v_exp_f32 v45, v45
    v_exp_f32 v46, v46
    v_exp_f32 v47, v47
    v_cvt_pk_bf16_f32 v70, v44, v45
    v_cvt_pk_bf16_f32 v71, v46, v47
    v_mfma_f32_32x32x16_bf16 v[32:47], a[96:99], a[188:191], 0
    v_exp_f32 v48, v48
    v_exp_f32 v49, v49
    v_exp_f32 v50, v50
    v_cvt_pk_bf16_f32 v64, v48, v49
    v_exp_f32 v51, v51
    v_mfma_f32_32x32x16_bf16 v[176:191], a[92:95], v[68:71], v[176:191]
    v_cvt_pk_bf16_f32 v65, v50, v51
    v_exp_f32 v52, v52
    v_exp_f32 v53, v53
    v_exp_f32 v54, v54
    v_cvt_pk_bf16_f32 v66, v52, v53
    v_exp_f32 v55, v55
    v_mfma_f32_32x32x16_bf16 v[32:47], a[100:103], a[192:195], v[32:47]
    s_waitcnt vmcnt(0)
    v_cvt_pk_bf16_f32 v67, v54, v55
    v_exp_f32 v56, v56
    v_exp_f32 v57, v57
    v_exp_f32 v58, v58
    v_cvt_pk_bf16_f32 v68, v56, v57
    v_exp_f32 v59, v59
    v_mfma_f32_32x32x16_bf16 v[144:159], a[104:107], v[64:67], v[144:159]
    v_cvt_pk_bf16_f32 v69, v58, v59
    v_exp_f32 v60, v60
    v_exp_f32 v61, v61
    v_exp_f32 v62, v62
    v_exp_f32 v63, v63
    v_cvt_pk_bf16_f32 v70, v60, v61
    v_cvt_pk_bf16_f32 v71, v62, v63
    v_mfma_f32_32x32x16_bf16 v[48:63], a[96:99], a[196:199], 0
    v_exp_f32 v32, v32
    v_exp_f32 v33, v33
    v_exp_f32 v34, v34
    v_cvt_pk_bf16_f32 v64, v32, v33
    v_exp_f32 v35, v35
    v_mfma_f32_32x32x16_bf16 v[144:159], a[108:111], v[68:71], v[144:159]
    v_cvt_pk_bf16_f32 v65, v34, v35
    v_exp_f32 v36, v36
    v_exp_f32 v37, v37
    v_exp_f32 v38, v38
    v_cvt_pk_bf16_f32 v66, v36, v37
    v_exp_f32 v39, v39
    v_mfma_f32_32x32x16_bf16 v[48:63], a[100:103], a[200:203], v[48:63]
    v_cvt_pk_bf16_f32 v67, v38, v39
    v_exp_f32 v40, v40
    v_exp_f32 v41, v41
    v_exp_f32 v42, v42
    v_cvt_pk_bf16_f32 v68, v40, v41
    v_exp_f32 v43, v43
    v_mfma_f32_32x32x16_bf16 v[160:175], a[104:107], v[64:67], v[160:175]
    ds_write_b128 v117, v[144:147] offset:0
    ds_write_b128 v117, v[148:151] offset:1024
    v_cvt_pk_bf16_f32 v69, v42, v43
    v_exp_f32 v44, v44
    v_exp_f32 v45, v45
    v_exp_f32 v46, v46
    v_exp_f32 v47, v47
    v_cvt_pk_bf16_f32 v70, v44, v45
    v_cvt_pk_bf16_f32 v71, v46, v47
    v_mfma_f32_32x32x16_bf16 v[32:47], a[80:83], v[104:107], 0
    ds_write_b128 v117, v[152:155] offset:2048
    ds_write_b128 v117, v[156:159] offset:3072
    v_exp_f32 v48, v48
    v_exp_f32 v49, v49
    v_exp_f32 v50, v50
    v_cvt_pk_bf16_f32 v64, v48, v49
    v_exp_f32 v51, v51
    v_mfma_f32_32x32x16_bf16 v[160:175], a[108:111], v[68:71], v[160:175]
    v_cvt_pk_bf16_f32 v65, v50, v51
    v_exp_f32 v52, v52
    v_exp_f32 v53, v53
    v_exp_f32 v54, v54
    v_cvt_pk_bf16_f32 v66, v52, v53
    v_exp_f32 v55, v55
    v_mfma_f32_32x32x16_bf16 v[32:47], a[84:87], v[108:111], v[32:47]
    v_cvt_pk_bf16_f32 v67, v54, v55
    v_exp_f32 v56, v56
    v_exp_f32 v57, v57
    v_exp_f32 v58, v58
    v_cvt_pk_bf16_f32 v68, v56, v57
    v_exp_f32 v59, v59
    v_mfma_f32_32x32x16_bf16 v[176:191], a[104:107], v[64:67], v[176:191]
    ds_write_b128 v118, v[160:163] offset:4096
    ds_write_b128 v118, v[164:167] offset:5120
    v_cvt_pk_bf16_f32 v69, v58, v59
    v_exp_f32 v60, v60
    v_exp_f32 v61, v61
    v_exp_f32 v62, v62
    v_exp_f32 v63, v63
    v_cvt_pk_bf16_f32 v70, v60, v61
    v_cvt_pk_bf16_f32 v71, v62, v63
    v_mfma_f32_32x32x16_bf16 v[48:63], a[96:99], v[104:107], 0
    ds_write_b128 v118, v[168:171] offset:6144
    ds_write_b128 v118, v[172:175] offset:7168
    v_exp_f32 v32, v32
    v_exp_f32 v33, v33
    v_exp_f32 v34, v34
    v_cvt_pk_bf16_f32 v64, v32, v33
    v_exp_f32 v35, v35
    v_mfma_f32_32x32x16_bf16 v[176:191], a[108:111], v[68:71], v[176:191]
    v_cvt_pk_bf16_f32 v65, v34, v35
    v_exp_f32 v36, v36
    v_exp_f32 v37, v37
    v_exp_f32 v38, v38
    v_cvt_pk_bf16_f32 v66, v36, v37
    v_exp_f32 v39, v39
    v_mfma_f32_32x32x16_bf16 v[48:63], a[100:103], v[108:111], v[48:63]
    v_cvt_pk_bf16_f32 v67, v38, v39
    v_exp_f32 v40, v40
    v_exp_f32 v41, v41
    v_exp_f32 v42, v42
    v_cvt_pk_bf16_f32 v68, v40, v41
    v_exp_f32 v43, v43
    v_mfma_f32_32x32x16_bf16 v[128:143], a[88:91], v[64:67], v[128:143]
    ds_write_b128 v119, v[176:179] offset:8192
    ds_write_b128 v119, v[180:183] offset:9216
    ds_write_b128 v119, v[184:187] offset:10240
    ds_write_b128 v119, v[188:191] offset:11264
    v_cvt_pk_bf16_f32 v69, v42, v43
    v_exp_f32 v44, v44
    v_exp_f32 v45, v45
    v_exp_f32 v46, v46
    v_exp_f32 v47, v47
    v_cvt_pk_bf16_f32 v70, v44, v45
    v_cvt_pk_bf16_f32 v71, v46, v47
    s_waitcnt lgkmcnt(0)
    s_barrier
    ds_read_b128 v[204:207], v116 offset:3072
    ds_read_b128 v[220:223], v116 offset:7168
    ds_read_b128 v[236:239], v116 offset:11264
    v_exp_f32 v48, v48
    v_exp_f32 v49, v49
    v_exp_f32 v50, v50
    v_cvt_pk_bf16_f32 v64, v48, v49
    v_exp_f32 v51, v51
    v_mfma_f32_32x32x16_bf16 v[128:143], a[92:95], v[68:71], v[128:143]
    ds_read_b128 v[192:195], v116 offset:0
    ds_read_b128 v[208:211], v116 offset:4096
    ds_read_b128 v[224:227], v116 offset:8192
    ds_read_b128 v[196:199], v116 offset:1024
    ds_read_b128 v[212:215], v116 offset:5120
    ds_read_b128 v[228:231], v116 offset:9216
    v_cvt_pk_bf16_f32 v65, v50, v51
    v_exp_f32 v52, v52
    v_exp_f32 v53, v53
    v_exp_f32 v54, v54
    v_cvt_pk_bf16_f32 v66, v52, v53
    v_exp_f32 v55, v55
    s_nop 0
    v_cvt_pk_bf16_f32 v67, v54, v55
    v_exp_f32 v56, v56
L_page_6:
    s_cbranch_vccnz L_page_10
    v_exp_f32 v57, v57
    v_exp_f32 v58, v58
    v_cvt_pk_bf16_f32 v68, v56, v57
    v_exp_f32 v59, v59
    v_mfma_f32_32x32x16_bf16 v[128:143], a[104:107], v[64:67], v[128:143]
    ds_read_b128 v[200:203], v116 offset:2048
    ds_read_b128 v[216:219], v116 offset:6144
    ds_read_b128 v[232:235], v116 offset:10240
    v_cvt_pk_bf16_f32 v69, v58, v59
    v_exp_f32 v60, v60
    v_exp_f32 v61, v61
    v_exp_f32 v62, v62
    v_exp_f32 v63, v63
    v_cvt_pk_bf16_f32 v70, v60, v61
    v_cvt_pk_bf16_f32 v71, v62, v63
    s_nop 1
    v_mfma_f32_32x32x16_bf16 v[128:143], a[108:111], v[68:71], v[128:143]
    s_waitcnt lgkmcnt(10)
    v_add_f32 v204, v204, v220
    v_add_f32 v205, v205, v221
    v_add_f32 v206, v206, v222
    v_add_f32 v207, v207, v223
    s_waitcnt lgkmcnt(7)
    v_add_f32 v192, v192, v208
    v_add_f32 v193, v193, v209
    v_add_f32 v194, v194, v210
    v_add_f32 v195, v195, v211
    s_waitcnt lgkmcnt(4)
    v_add_f32 v196, v196, v212
    v_add_f32 v197, v197, v213
    v_add_f32 v198, v198, v214
    v_add_f32 v199, v199, v215
    s_waitcnt lgkmcnt(1)
    v_pk_add_f32 v[200:201], v[200:201], v[216:217]
    v_pk_add_f32 v[202:203], v[202:203], v[218:219]
    v_pk_add_f32 v[140:141], v[140:141], v[236:237]
    v_pk_add_f32 v[142:143], v[142:143], v[238:239]
    v_pk_add_f32 v[140:141], v[140:141], v[204:205]
    v_pk_add_f32 v[142:143], v[142:143], v[206:207]
    v_pk_add_f32 v[128:129], v[128:129], v[224:225]
    v_mov_b32 v74, v140
    v_pk_add_f32 v[130:131], v[130:131], v[226:227]
    v_pk_add_f32 v[128:129], v[128:129], v[192:193]
    v_mov_b32 v75, v140
    v_pk_add_f32 v[130:131], v[130:131], v[194:195]
    v_pk_add_f32 v[132:133], v[132:133], v[228:229]
    s_add_u32 s90, s69, 5242880
    v_pk_add_f32 v[134:135], v[134:135], v[230:231]
    v_pk_add_f32 v[132:133], v[132:133], v[196:197]
    s_sub_u32 s91, s90, 4096
    v_pk_add_f32 v[134:135], v[134:135], v[198:199]
    s_waitcnt lgkmcnt(0)
    v_pk_add_f32 v[136:137], v[136:137], v[232:233]
    v_permlane32_swap_b32 v74, v75
    v_pk_add_f32 v[138:139], v[138:139], v[234:235]
    v_pk_add_f32 v[136:137], v[136:137], v[200:201]
    v_rcp_f32 v74, v75
    v_pk_add_f32 v[138:139], v[138:139], v[202:203]
    v_pk_mul_f32 v[128:129], v[128:129], v[74:75] op_sel:[0,0] op_sel_hi:[1,0]
    v_pk_mul_f32 v[130:131], v[130:131], v[74:75] op_sel:[0,0] op_sel_hi:[1,0]
    v_pk_mul_f32 v[132:133], v[132:133], v[74:75] op_sel:[0,0] op_sel_hi:[1,0]
    v_pk_mul_f32 v[134:135], v[134:135], v[74:75] op_sel:[0,0] op_sel_hi:[1,0]
    v_cvt_pk_bf16_f32 v192, v128, v129
    v_cvt_pk_bf16_f32 v193, v130, v131
    v_cvt_pk_bf16_f32 v194, v132, v133
    v_cvt_pk_bf16_f32 v195, v134, v135
    buffer_store_dwordx4 v[192:195], v1, s[52:55], s90 offen sc1
    v_pk_mul_f32 v[136:137], v[136:137], v[74:75] op_sel:[0,0] op_sel_hi:[1,0]
    v_pk_mul_f32 v[138:139], v[138:139], v[74:75] op_sel:[0,0] op_sel_hi:[1,0]
    v_pk_mul_f32 v[140:141], v[140:141], v[74:75] op_sel:[0,0] op_sel_hi:[1,0]
    v_pk_mul_f32 v[142:143], v[142:143], v[74:75] op_sel:[0,0] op_sel_hi:[1,0]
    v_cvt_pk_bf16_f32 v196, v136, v137
    v_cvt_pk_bf16_f32 v197, v138, v139
    v_cvt_pk_bf16_f32 v198, v140, v141
    v_cvt_pk_bf16_f32 v199, v142, v143
    s_mov_b64 exec, s[82:83]
    buffer_store_dwordx4 v[196:199], v1, s[52:55], s90 offen offset:1024 sc1
    s_mov_b64 exec, s[80:81]
    buffer_store_dwordx2 v[196:197], v5, s[52:55], s91 offen offset:1536 sc1
    s_mov_b64 exec, -1
    v_pk_mul_f32 v[72:73], v[128:129], 0
    v_pk_fma_f32 v[72:73], v[130:131], 0, v[72:73]
    v_pk_fma_f32 v[72:73], v[132:133], 0, v[72:73]
    v_pk_fma_f32 v[72:73], v[134:135], 0, v[72:73]
    v_pk_fma_f32 v[72:73], v[136:137], 0, v[72:73]
    v_pk_fma_f32 v[72:73], v[138:139], 0, v[72:73]
    v_pk_fma_f32 v[72:73], v[140:141], 0, v[72:73]
    v_pk_fma_f32 v[72:73], v[142:143], 0, v[72:73]
    v_add_f32 v72, v72, v73
    v_add_f32 v72, v72, v75
    s_mov_b32 s90, 0x5d800000
    v_cmp_nle_f32 s[98:99], v72, s90
    s_mov_b32 s90, 0x21800000
    v_cmp_nge_f32 s[96:97], v72, s90
    s_nop 1
    s_or_b64 s[98:99], s[98:99], s[96:97]
    s_or_b32 s90, s98, s99
    v_mov_b32 v72, s90
    ds_write_b32 v120, v72
    s_waitcnt lgkmcnt(0)
    s_barrier
    ds_read_b128 v[72:75], v121
    s_waitcnt lgkmcnt(0)
    v_or_b32 v72, v72, v73
    v_or3_b32 v72, v72, v74, v75
    s_nop 0
    v_readfirstlane_b32 s90, v72
    s_nop 1
    s_andn2_b32 s90, s90, s95
    s_cmp_lg_u32 s90, 0
    s_cbranch_scc1 L_slow_12
    s_waitcnt vmcnt(0)
    s_mov_b32 s101, s56
    s_atomic_add s101, s[64:65], 0 glc
    s_add_u32 m0, s100, 0
    s_add_u32 s90, s3, 0
    buffer_load_dwordx4 v1, s[52:55], s90 offen offset:0 sc1 lds
    buffer_load_dwordx4 v1, s[52:55], s90 offen offset:1024 sc1 lds
    buffer_load_dwordx4 v1, s[52:55], s90 offen offset:2048 sc1 lds
    buffer_load_dwordx4 v1, s[52:55], s90 offen offset:3072 sc1 lds
    s_add_u32 m0, s100, 4096
    s_add_u32 s90, s3, 4096
    buffer_load_dwordx4 v1, s[52:55], s90 offen offset:0 sc1 lds
    buffer_load_dwordx4 v1, s[52:55], s90 offen offset:1024 sc1 lds
    buffer_load_dwordx4 v1, s[52:55], s90 offen offset:2048 sc1 lds
    s_add_u32 m0, s100, 28672
    s_add_u32 s90, s3, 28672
    buffer_load_dwordx4 v1, s[52:55], s90 offen offset:0 sc1 lds
    buffer_load_dwordx4 v1, s[52:55], s90 offen offset:1024 sc1 lds
    buffer_load_dwordx4 v1, s[52:55], s90 offen offset:2048 sc1 lds
    buffer_load_dwordx4 v1, s[52:55], s90 offen offset:3072 sc1 lds
    s_add_u32 m0, s100, 32768
    s_add_u32 s90, s3, 32768
    buffer_load_dwordx4 v1, s[52:55], s90 offen offset:0 sc1 lds
    buffer_load_dwordx4 v1, s[52:55], s90 offen offset:1024 sc1 lds
    buffer_load_dwordx4 v1, s[52:55], s90 offen offset:2048 sc1 lds
    s_add_u32 s72, s68, 5242880
    s_xor_b32 s73, s72, 4096
    s_xor_b32 s74, s72, 8192
    s_xor_b32 s75, s72, 12288
    s_xor_b32 s76, s72, 16384
    s_xor_b32 s77, s72, 20480
    s_xor_b32 s78, s72, 24576
    s_xor_b32 s79, s72, 28672
    ds_read_b128 a[128:131], v2 offset:28672
    ds_read_b128 a[132:135], v2 offset:29696
    ds_read_b128 a[136:139], v2 offset:30720
    ds_read_b128 a[140:143], v2 offset:31744
    ds_read_b128 a[144:147], v2 offset:32768
    s_waitcnt lgkmcnt(0)
    s_add_u32 s101, s101, s56
    s_waitcnt lgkmcnt(0)
    s_add_u32 s89, s101, 0x74747474
    s_and_b32 s89, s89, 0x80808080
    s_cmp_eq_u32 s89, 0x80808080
    s_cbranch_scc1 L_go_14
L_poll_13:
    s_mov_b32 s101, 0
    s_atomic_add s101, s[64:65], 0 glc
    s_sub_u32 s63, s63, 1
    s_cbranch_scc1 L_go_14_to
    s_waitcnt lgkmcnt(0)
    s_add_u32 s89, s101, 0x74747474
    s_and_b32 s89, s89, 0x80808080
    s_cmp_eq_u32 s89, 0x80808080
    s_cbranch_scc0 L_poll_13
    s_branch L_go_14
L_go_14_to:
    s_mov_b32 s63, 0
    s_waitcnt lgkmcnt(0)
L_go_14:
    buffer_load_dwordx4 v[128:131], v1, s[52:55], s72 offen offset:0 sc1
    buffer_load_dwordx4 v[132:135], v1, s[52:55], s72 offen offset:2048 sc1
    buffer_load_dwordx4 v[136:139], v1, s[52:55], s73 offen offset:0 sc1
    buffer_load_dwordx4 v[140:143], v1, s[52:55], s73 offen offset:2048 sc1
    buffer_load_dwordx4 v[144:147], v10, s[52:55], s72 offen offset:1024 sc1
    buffer_load_dwordx4 v[148:151], v10, s[52:55], s73 offen offset:1024 sc1
    buffer_load_dwordx2 v[154:155], v5, s[52:55], s72 offen offset:1536 sc1
    buffer_load_dwordx2 v[156:157], v5, s[52:55], s72 offen offset:3584 sc1
    buffer_load_dwordx2 v[186:187], v5, s[52:55], s74 offen offset:1536 sc1
    buffer_load_dwordx2 v[188:189], v5, s[52:55], s74 offen offset:3584 sc1
    buffer_load_dwordx2 v[218:219], v5, s[52:55], s76 offen offset:1536 sc1
    buffer_load_dwordx2 v[220:221], v5, s[52:55], s76 offen offset:3584 sc1
    buffer_load_dwordx2 v[250:251], v5, s[52:55], s78 offen offset:1536 sc1
    buffer_load_dwordx2 v[252:253], v5, s[52:55], s78 offen offset:3584 sc1
    s_waitcnt vmcnt(13)
    v_mfma_f32_32x32x16_bf16 v[16:31], a[128:131], v[128:131], v[16:31]
    ds_read_b128 a[148:151], v2 offset:33792
    buffer_load_dwordx4 v[160:163], v1, s[52:55], s74 offen offset:0 sc1
    buffer_load_dwordx4 v[164:167], v1, s[52:55], s74 offen offset:2048 sc1
    s_waitcnt vmcnt(14)
    v_mfma_f32_32x32x16_bf16 v[16:31], a[132:135], v[132:135], v[16:31]
    ds_read_b128 a[152:155], v2 offset:34816
    buffer_load_dwordx4 v[168:171], v1, s[52:55], s75 offen offset:0 sc1
    buffer_load_dwordx4 v[172:175], v1, s[52:55], s75 offen offset:2048 sc1
    s_waitcnt vmcnt(15)
    v_mfma_f32_32x32x16_bf16 v[16:31], a[136:139], v[136:139], v[16:31]
    ds_read_b128 a[156:159], v2 offset:41984
    buffer_load_dwordx4 v[176:179], v10, s[52:55], s74 offen offset:1024 sc1
    s_waitcnt vmcnt(15)
    v_mfma_f32_32x32x16_bf16 v[16:31], a[140:143], v[140:143], v[16:31]
    ds_read_b128 a[128:131], v2 offset:49152
    buffer_load_dwordx4 v[180:183], v10, s[52:55], s75 offen offset:1024 sc1
    s_waitcnt vmcnt(15)
    v_mfma_f32_32x32x16_bf16 v[16:31], a[144:147], v[144:147], v[16:31]
    ds_read_b128 a[132:135], v2 offset:56320
    buffer_load_dwordx4 v[192:195], v1, s[52:55], s76 offen offset:0 sc1
    s_waitcnt vmcnt(15) lgkmcnt(4)
    v_mfma_f32_32x32x16_bf16 v[16:31], a[148:151], v[148:151], v[16:31]
    ds_read_b128 a[136:139], v2 offset:35840
    buffer_load_dwordx4 v[196:199], v1, s[52:55], s76 offen offset:2048 sc1
    s_waitcnt vmcnt(14) lgkmcnt(4)
    v_mfma_f32_32x32x16_bf16 v[16:31], a[152:155], v[154:157], v[16:31]
    ds_read_b128 a[140:143], v2 offset:36864
    buffer_load_dwordx4 v[200:203], v1, s[52:55], s77 offen offset:0 sc1
    s_waitcnt vmcnt(13) lgkmcnt(4)
    v_mfma_f32_32x32x16_bf16 v[16:31], a[156:159], v[186:189], v[16:31]
    ds_read_b128 a[144:147], v2 offset:37888
    buffer_load_dwordx4 v[204:207], v1, s[52:55], s77 offen offset:2048 sc1
    s_waitcnt vmcnt(12) lgkmcnt(4)
    v_mfma_f32_32x32x16_bf16 v[16:31], a[128:131], v[218:221], v[16:31]
    ds_read_b128 a[148:151], v2 offset:38912
    buffer_load_dwordx4 v[208:211], v10, s[52:55], s76 offen offset:1024 sc1
    s_waitcnt vmcnt(11) lgkmcnt(4)
    v_mfma_f32_32x32x16_bf16 v[16:31], a[132:135], v[250:253], v[16:31]
    ds_read_b128 a[152:155], v2 offset:39936
    buffer_load_dwordx4 v[212:215], v10, s[52:55], s77 offen offset:1024 sc1
    s_waitcnt vmcnt(11) lgkmcnt(4)
    v_mfma_f32_32x32x16_bf16 v[16:31], a[136:139], v[160:163], v[16:31]
    ds_read_b128 a[156:159], v2 offset:40960
    buffer_load_dwordx4 v[224:227], v1, s[52:55], s78 offen offset:0 sc1
    s_waitcnt vmcnt(11) lgkmcnt(4)
    v_mfma_f32_32x32x16_bf16 v[16:31], a[140:143], v[164:167], v[16:31]
    ds_read_b128 a[128:131], v2 offset:43008
    buffer_load_dwordx4 v[228:231], v1, s[52:55], s78 offen offset:2048 sc1
    s_waitcnt vmcnt(11) lgkmcnt(4)
    v_mfma_f32_32x32x16_bf16 v[16:31], a[144:147], v[168:171], v[16:31]
    ds_read_b128 a[132:135], v2 offset:44032
    buffer_load_dwordx4 v[232:235], v1, s[52:55], s79 offen offset:0 sc1
    s_waitcnt vmcnt(11) lgkmcnt(4)
    v_mfma_f32_32x32x16_bf16 v[16:31], a[148:151], v[172:175], v[16:31]
    ds_read_b128 a[136:139], v2 offset:45056
    buffer_load_dwordx4 v[236:239], v1, s[52:55], s79 offen offset:2048 sc1
    s_waitcnt vmcnt(11) lgkmcnt(4)
    v_mfma_f32_32x32x16_bf16 v[16:31], a[152:155], v[176:179], v[16:31]
    ds_read_b128 a[140:143], v2 offset:46080
    buffer_load_dwordx4 v[240:243], v10, s[52:55], s78 offen offset:1024 sc1
    s_waitcnt vmcnt(11) lgkmcnt(4)
    v_mfma_f32_32x32x16_bf16 v[16:31], a[156:159], v[180:183], v[16:31]
    ds_read_b128 a[144:147], v2 offset:47104
    buffer_load_dwordx4 v[244:247], v10, s[52:55], s79 offen offset:1024 sc1
    s_waitcnt vmcnt(11) lgkmcnt(4)
    v_mfma_f32_32x32x16_bf16 v[16:31], a[128:131], v[192:195], v[16:31]
    ds_read_b128 a[148:151], v2 offset:48128
    s_waitcnt vmcnt(10) lgkmcnt(4)
    v_mfma_f32_32x32x16_bf16 v[16:31], a[132:135], v[196:199], v[16:31]
    ds_read_b128 a[152:155], v2 offset:50176
    s_waitcnt vmcnt(9) lgkmcnt(4)
    v_mfma_f32_32x32x16_bf16 v[16:31], a[136:139], v[200:203], v[16:31]
    ds_read_b128 a[156:159], v2 offset:51200
    s_waitcnt vmcnt(8) lgkmcnt(4)
    v_mfma_f32_32x32x16_bf16 v[16:31], a[140:143], v[204:207], v[16:31]
    ds_read_b128 a[128:131], v2 offset:52224
    s_waitcnt vmcnt(7) lgkmcnt(4)
    v_mfma_f32_32x32x16_bf16 v[16:31], a[144:147], v[208:211], v[16:31]
    ds_read_b128 a[132:135], v2 offset:53248
    s_waitcnt vmcnt(6) lgkmcnt(4)
    v_mfma_f32_32x32x16_bf16 v[16:31], a[148:151], v[212:215], v[16:31]
    ds_read_b128 a[136:139], v2 offset:54272
    s_waitcnt vmcnt(5) lgkmcnt(4)
    v_mfma_f32_32x32x16_bf16 v[16:31], a[152:155], v[224:227], v[16:31]
    ds_read_b128 a[140:143], v2 offset:55296
    s_waitcnt vmcnt(4) lgkmcnt(4)
    v_mfma_f32_32x32x16_bf16 v[16:31], a[156:159], v[228:231], v[16:31]
    s_waitcnt vmcnt(3) lgkmcnt(3)
    v_mfma_f32_32x32x16_bf16 v[16:31], a[128:131], v[232:235], v[16:31]
    s_waitcnt vmcnt(2) lgkmcnt(2)
    v_mfma_f32_32x32x16_bf16 v[16:31], a[132:135], v[236:239], v[16:31]
    s_waitcnt vmcnt(1) lgkmcnt(1)
    v_mfma_f32_32x32x16_bf16 v[16:31], a[136:139], v[240:243], v[16:31]
    s_waitcnt vmcnt(0) lgkmcnt(0)
    v_mfma_f32_32x32x16_bf16 v[16:31], a[140:143], v[244:247], v[16:31]
    s_add_u32 s90, s69, 7340032
    s_nop 10
    v_cvt_pk_bf16_f32 v88, v16, v17
    v_cvt_pk_bf16_f32 v89, v18, v19
    v_cvt_pk_bf16_f32 v90, v20, v21
    v_cvt_pk_bf16_f32 v91, v22, v23
    buffer_store_dwordx4 v[88:91], v1, s[52:55], s90 offen sc1
    v_pk_add_f32 v[104:105], v[16:17], v[18:19]
    v_pk_mul_f32 v[106:107], v[16:17], v[16:17]
    v_pk_fma_f32 v[106:107], v[18:19], v[18:19], v[106:107]
    v_pk_add_f32 v[104:105], v[104:105], v[20:21]
    v_pk_fma_f32 v[106:107], v[20:21], v[20:21], v[106:107]
    v_pk_add_f32 v[104:105], v[104:105], v[22:23]
    v_pk_fma_f32 v[106:107], v[22:23], v[22:23], v[106:107]
    v_pk_add_f32 v[104:105], v[104:105], v[24:25]
    v_pk_fma_f32 v[106:107], v[24:25], v[24:25], v[106:107]
    v_pk_add_f32 v[104:105], v[104:105], v[26:27]
    v_pk_fma_f32 v[106:107], v[26:27], v[26:27], v[106:107]
    s_mov_b64 exec, s[82:83]
    v_pk_add_f32 v[104:105], v[104:105], v[28:29]
    v_pk_fma_f32 v[106:107], v[28:29], v[28:29], v[106:107]
    v_pk_add_f32 v[104:105], v[104:105], v[30:31]
    v_pk_fma_f32 v[106:107], v[30:31], v[30:31], v[106:107]
    s_mov_b64 exec, -1
    v_add_f32 v104, v104, v105
    v_add_f32 v106, v106, v107
    v_cvt_pk_bf16_f32 v92, v24, v25
    v_cvt_pk_bf16_f32 v93, v26, v27
    v_cvt_pk_bf16_f32 v94, v28, v29
    v_cvt_pk_bf16_f32 v95, v30, v31
    v_permlane32_swap_b32 v105, v104
    v_permlane32_swap_b32 v107, v106
    s_mov_b64 exec, s[80:81]
    v_add_f32 v94, v104, v105
    v_add_f32 v95, v106, v107
    s_mov_b64 exec, s[86:87]
    v_swap_b32 v92, v94
    v_swap_b32 v93, v95
    s_mov_b64 exec, -1
    buffer_store_dwordx4 v[92:95], v1, s[52:55], s90 offen offset:1024 sc1
    s_waitcnt vmcnt(0)
    s_mov_b32 s101, s56
    s_atomic_add s101, s[64:65], 0 glc
    s_add_u32 m0, s100, 57344
    s_add_u32 s90, s3, 57344
    buffer_load_dwordx4 v1, s[52:55], s90 offen offset:0 sc1 lds
    buffer_load_dwordx4 v1, s[52:55], s90 offen offset:1024 sc1 lds
    buffer_load_dwordx4 v1, s[52:55], s90 offen offset:2048 sc1 lds
    buffer_load_dwordx4 v1, s[52:55], s90 offen offset:3072 sc1 lds
    s_add_u32 m0, s100, 61440
    s_add_u32 s90, s3, 61440
    buffer_load_dwordx4 v1, s[52:55], s90 offen offset:0 sc1 lds
    buffer_load_dwordx4 v1, s[52:55], s90 offen offset:1024 sc1 lds
    buffer_load_dwordx4 v1, s[52:55], s90 offen offset:2048 sc1 lds
    s_barrier
    s_add_u32 s72, s68, 7340032
    s_xor_b32 s73, s72, 4096
    s_xor_b32 s74, s72, 8192
    s_xor_b32 s75, s72, 12288
    s_xor_b32 s76, s72, 16384
    s_xor_b32 s77, s72, 20480
    s_xor_b32 s78, s72, 24576
    s_xor_b32 s79, s72, 28672
    ds_read_b128 a[128:131], v1 offset:0
    ds_read_b128 a[132:135], v1 offset:28672
    ds_read_b128 a[136:139], v1 offset:1024
    ds_read_b128 a[140:143], v1 offset:29696
    ds_read_b128 a[144:147], v1 offset:2048
    ds_read_b128 a[148:151], v1 offset:30720
    s_waitcnt lgkmcnt(0)
    s_add_u32 s101, s101, s56
    s_waitcnt lgkmcnt(0)
    s_add_u32 s89, s101, 0x70707070
    s_and_b32 s89, s89, 0x80808080
    s_cmp_eq_u32 s89, 0x80808080
    s_cbranch_scc1 L_go_16
L_poll_15:
    s_mov_b32 s101, 0
    s_atomic_add s101, s[64:65], 0 glc
    s_sub_u32 s63, s63, 1
    s_cbranch_scc1 L_go_16_to
    s_waitcnt lgkmcnt(0)
    s_add_u32 s89, s101, 0x70707070
    s_and_b32 s89, s89, 0x80808080
    s_cmp_eq_u32 s89, 0x80808080
    s_cbranch_scc0 L_poll_15
    s_branch L_go_16
L_go_16_to:
    s_mov_b32 s63, 0
    s_waitcnt lgkmcnt(0)
L_go_16:
    buffer_load_dwordx4 v[128:131], v1, s[52:55], s72 offen offset:0 sc1
    buffer_load_dwordx4 v[132:135], v1, s[52:55], s72 offen offset:2048 sc1
    buffer_load_dwordx4 v[136:139], v1, s[52:55], s73 offen offset:0 sc1
    buffer_load_dwordx4 v[140:143], v1, s[52:55], s73 offen offset:2048 sc1
    buffer_load_dwordx4 v[144:147], v10, s[52:55], s72 offen offset:1024 sc1
    buffer_load_dwordx4 v[148:151], v10, s[52:55], s73 offen offset:1024 sc1
    buffer_load_dwordx4 v[152:155], v11, s[52:55], s72 offen offset:1536 sc1
    buffer_load_dwordx4 v[156:159], v11, s[52:55], s72 offen offset:3584 sc1
    buffer_load_dwordx4 v[184:187], v11, s[52:55], s74 offen offset:1536 sc1
    buffer_load_dwordx4 v[188:191], v11, s[52:55], s74 offen offset:3584 sc1
    s_waitcnt vmcnt(9)
    v_mfma_f32_32x32x16_bf16 v[32:47], a[128:131], v[128:131], 0
    ds_read_b128 a[152:155], v1 offset:3072
    ds_read_b128 a[156:159], v1 offset:31744
    buffer_load_dwordx4 v[216:219], v11, s[52:55], s76 offen offset:1536 sc1
    buffer_load_dwordx4 v[220:223], v11, s[52:55], s76 offen offset:3584 sc1
    v_mfma_f32_32x32x16_bf16 v[48:63], a[132:135], v[128:131], 0
    s_waitcnt vmcnt(10)
    v_mfma_f32_32x32x16_bf16 v[32:47], a[136:139], v[132:135], v[32:47]
    ds_read_b128 a[128:131], v1 offset:4096
    ds_read_b128 a[132:135], v1 offset:32768
    buffer_load_dwordx4 v[248:251], v11, s[52:55], s78 offen offset:1536 sc1
    buffer_load_dwordx4 v[252:255], v11, s[52:55], s78 offen offset:3584 sc1
    v_mfma_f32_32x32x16_bf16 v[48:63], a[140:143], v[132:135], v[48:63]
    s_waitcnt vmcnt(11)
    v_mfma_f32_32x32x16_bf16 v[32:47], a[144:147], v[136:139], v[32:47]
    ds_read_b128 a[136:139], v1 offset:5120
    ds_read_b128 a[140:143], v1 offset:33792
    buffer_load_dwordx4 v[160:163], v1, s[52:55], s74 offen offset:0 sc1
    buffer_load_dwordx4 v[164:167], v1, s[52:55], s74 offen offset:2048 sc1
    v_mfma_f32_32x32x16_bf16 v[48:63], a[148:151], v[136:139], v[48:63]
    s_waitcnt vmcnt(12) lgkmcnt(4)
    v_mfma_f32_32x32x16_bf16 v[32:47], a[152:155], v[140:143], v[32:47]
    ds_read_b128 a[144:147], v1 offset:6144
    ds_read_b128 a[148:151], v1 offset:34816
    buffer_load_dwordx4 v[168:171], v1, s[52:55], s75 offen offset:0 sc1
    buffer_load_dwordx4 v[172:175], v1, s[52:55], s75 offen offset:2048 sc1
    v_mfma_f32_32x32x16_bf16 v[48:63], a[156:159], v[140:143], v[48:63]
    s_waitcnt vmcnt(13) lgkmcnt(4)
    v_mfma_f32_32x32x16_bf16 v[32:47], a[128:131], v[144:147], v[32:47]
    ds_read_b128 a[152:155], v1 offset:13312
    ds_read_b128 a[156:159], v1 offset:41984
    buffer_load_dwordx4 v[176:179], v10, s[52:55], s74 offen offset:1024 sc1
    v_mfma_f32_32x32x16_bf16 v[48:63], a[132:135], v[144:147], v[48:63]
    s_waitcnt vmcnt(13) lgkmcnt(4)
    v_mfma_f32_32x32x16_bf16 v[32:47], a[136:139], v[148:151], v[32:47]
    ds_read_b128 a[128:131], v1 offset:20480
    ds_read_b128 a[132:135], v1 offset:49152
    buffer_load_dwordx4 v[180:183], v10, s[52:55], s75 offen offset:1024 sc1
    v_mfma_f32_32x32x16_bf16 v[48:63], a[140:143], v[148:151], v[48:63]
    s_waitcnt vmcnt(12) lgkmcnt(4)
    v_mfma_f32_32x32x16_bf16 v[32:47], a[144:147], v[154:157], v[32:47]
    ds_read_b128 a[136:139], v1 offset:27648
    ds_read_b128 a[140:143], v1 offset:56320
    buffer_load_dwordx4 v[192:195], v1, s[52:55], s76 offen offset:0 sc1
    v_mfma_f32_32x32x16_bf16 v[48:63], a[148:151], v[154:157], v[48:63]
    s_waitcnt vmcnt(11) lgkmcnt(4)
    v_mfma_f32_32x32x16_bf16 v[32:47], a[152:155], v[186:189], v[32:47]
    ds_read_b128 a[144:147], v1 offset:7168
    ds_read_b128 a[148:151], v1 offset:35840
    buffer_load_dwordx4 v[196:199], v1, s[52:55], s76 offen offset:2048 sc1
    v_mfma_f32_32x32x16_bf16 v[48:63], a[156:159], v[186:189], v[48:63]
    s_waitcnt vmcnt(10) lgkmcnt(4)
    v_mfma_f32_32x32x16_bf16 v[32:47], a[128:131], v[218:221], v[32:47]
    ds_read_b128 a[152:155], v1 offset:8192
    ds_read_b128 a[156:159], v1 offset:36864
    buffer_load_dwordx4 v[200:203], v1, s[52:55], s77 offen offset:0 sc1
    v_mfma_f32_32x32x16_bf16 v[48:63], a[132:135], v[218:221], v[48:63]
    s_waitcnt vmcnt(9) lgkmcnt(4)
    v_mfma_f32_32x32x16_bf16 v[32:47], a[136:139], v[250:253], v[32:47]
    ds_read_b128 a[128:131], v1 offset:9216
    ds_read_b128 a[132:135], v1 offset:37888
    buffer_load_dwordx4 v[204:207], v1, s[52:55], s77 offen offset:2048 sc1
    v_mfma_f32_32x32x16_bf16 v[48:63], a[140:143], v[250:253], v[48:63]
    s_waitcnt vmcnt(9) lgkmcnt(4)
    v_mfma_f32_32x32x16_bf16 v[32:47], a[144:147], v[160:163], v[32:47]
    ds_read_b128 a[136:139], v1 offset:10240
    ds_read_b128 a[140:143], v1 offset:38912
    buffer_load_dwordx4 v[208:211], v10, s[52:55], s76 offen offset:1024 sc1
    v_add_f32 v120, v152, v158
    v_add_f32 v121, v153, v159
    v_mfma_f32_32x32x16_bf16 v[48:63], a[148:151], v[160:163], v[48:63]
    v_add_f32 v120, v120, v184
    v_add_f32 v121, v121, v185
    s_waitcnt vmcnt(9) lgkmcnt(4)
    v_mfma_f32_32x32x16_bf16 v[32:47], a[152:155], v[164:167], v[32:47]
    ds_read_b128 a[144:147], v1 offset:11264
    ds_read_b128 a[148:151], v1 offset:39936
    buffer_load_dwordx4 v[212:215], v10, s[52:55], s77 offen offset:1024 sc1
    v_add_f32 v120, v120, v190
    v_add_f32 v121, v121, v191
    v_mfma_f32_32x32x16_bf16 v[48:63], a[156:159], v[164:167], v[48:63]
    v_add_f32 v120, v120, v216
    v_add_f32 v121, v121, v217
    s_waitcnt vmcnt(9) lgkmcnt(4)
    v_mfma_f32_32x32x16_bf16 v[32:47], a[128:131], v[168:171], v[32:47]
    ds_read_b128 a[152:155], v1 offset:12288
    ds_read_b128 a[156:159], v1 offset:40960
    buffer_load_dwordx4 v[224:227], v1, s[52:55], s78 offen offset:0 sc1
    v_add_f32 v120, v120, v222
    v_add_f32 v121, v121, v223
    v_mfma_f32_32x32x16_bf16 v[48:63], a[132:135], v[168:171], v[48:63]
    v_add_f32 v120, v120, v248
    v_add_f32 v121, v121, v249
    s_waitcnt vmcnt(9) lgkmcnt(4)
    v_mfma_f32_32x32x16_bf16 v[32:47], a[136:139], v[172:175], v[32:47]
    ds_read_b128 a[128:131], v1 offset:14336
    ds_read_b128 a[132:135], v1 offset:43008
    buffer_load_dwordx4 v[228:231], v1, s[52:55], s78 offen offset:2048 sc1
    v_add_f32 v120, v120, v254
    v_add_f32 v121, v121, v255
    v_mfma_f32_32x32x16_bf16 v[48:63], a[140:143], v[172:175], v[48:63]
    v_mov_b32 v122, v120
    s_nop 1
    v_permlane32_swap_b32 v122, v120
    s_waitcnt vmcnt(9) lgkmcnt(4)
    v_mfma_f32_32x32x16_bf16 v[32:47], a[144:147], v[176:179], v[32:47]
    ds_read_b128 a[136:139], v1 offset:15360
    ds_read_b128 a[140:143], v1 offset:44032
    buffer_load_dwordx4 v[232:235], v1, s[52:55], s79 offen offset:0 sc1
    v_add_f32 v120, v120, v122
    v_mov_b32 v122, v121
    v_mfma_f32_32x32x16_bf16 v[48:63], a[148:151], v[176:179], v[48:63]
    s_nop 0
    v_permlane32_swap_b32 v122, v121
    v_add_f32 v121, v121, v122
    s_waitcnt vmcnt(9) lgkmcnt(4)
    v_mfma_f32_32x32x16_bf16 v[32:47], a[152:155], v[180:183], v[32:47]
    ds_read_b128 a[144:147], v1 offset:16384
    ds_read_b128 a[148:151], v1 offset:45056
    buffer_load_dwordx4 v[236:239], v1, s[52:55], s79 offen offset:2048 sc1
    v_mul_f32 v120, 0xbb124925, v120
    v_mul_f32 v121, 0x3b124925, v121
    v_mfma_f32_32x32x16_bf16 v[48:63], a[156:159], v[180:183], v[48:63]
    v_fma_f32 v121, -v120, v120, v121
    v_max_f32 v121, 0, v121
    s_waitcnt vmcnt(9) lgkmcnt(4)
    v_mfma_f32_32x32x16_bf16 v[32:47], a[128:131], v[192:195], v[32:47]
    ds_read_b128 a[152:155], v1 offset:17408
    ds_read_b128 a[156:159], v1 offset:46080
    buffer_load_dwordx4 v[240:243], v10, s[52:55], s78 offen offset:1024 sc1
    v_add_f32 v121, 0x3727c5ac, v121
    v_rsq_f32 v124, v121
    v_mfma_f32_32x32x16_bf16 v[48:63], a[132:135], v[192:195], v[48:63]
    v_cndmask_b32 v120, v120, 0, s[80:81]
    v_cvt_pk_bf16_f32 v127, v120, 0
    s_waitcnt vmcnt(9) lgkmcnt(4)
    v_mfma_f32_32x32x16_bf16 v[32:47], a[136:139], v[196:199], v[32:47]
    ds_read_b128 a[128:131], v1 offset:18432
    ds_read_b128 a[132:135], v1 offset:47104
    buffer_load_dwordx4 v[244:247], v10, s[52:55], s79 offen offset:1024 sc1
    v_lshlrev_b32 v122, 16, v127
    v_sub_f32 v122, v120, v122
    v_mfma_f32_32x32x16_bf16 v[48:63], a[140:143], v[196:199], v[48:63]
    v_cvt_pk_bf16_f32 v126, v120, v122
    s_nop 1
    v_mfma_f32_32x32x8_bf16 v[32:47], a[160:161], v[126:127], v[32:47]
    s_waitcnt vmcnt(9) lgkmcnt(4)
    v_mfma_f32_32x32x16_bf16 v[32:47], a[144:147], v[200:203], v[32:47]
    ds_read_b128 a[136:139], v1 offset:19456
    ds_read_b128 a[140:143], v1 offset:48128
    v_mfma_f32_32x32x8_bf16 v[48:63], a[162:163], v[126:127], v[48:63]
    v_mfma_f32_32x32x16_bf16 v[48:63], a[148:151], v[200:203], v[48:63]
    s_waitcnt vmcnt(8) lgkmcnt(4)
    v_mfma_f32_32x32x16_bf16 v[32:47], a[152:155], v[204:207], v[32:47]
    ds_read_b128 a[144:147], v1 offset:21504
    ds_read_b128 a[148:151], v1 offset:50176
    v_mfma_f32_32x32x16_bf16 v[48:63], a[156:159], v[204:207], v[48:63]
    s_waitcnt vmcnt(7) lgkmcnt(4)
    v_mfma_f32_32x32x16_bf16 v[32:47], a[128:131], v[208:211], v[32:47]
    ds_read_b128 a[152:155], v1 offset:22528
    ds_read_b128 a[156:159], v1 offset:51200
    v_mfma_f32_32x32x16_bf16 v[48:63], a[132:135], v[208:211], v[48:63]
    s_waitcnt vmcnt(6) lgkmcnt(4)
    v_mfma_f32_32x32x16_bf16 v[32:47], a[136:139], v[212:215], v[32:47]
    ds_read_b128 a[128:131], v1 offset:23552
    ds_read_b128 a[132:135], v1 offset:52224
    v_mfma_f32_32x32x16_bf16 v[48:63], a[140:143], v[212:215], v[48:63]
    s_waitcnt vmcnt(5) lgkmcnt(4)
    v_mfma_f32_32x32x16_bf16 v[32:47], a[144:147], v[224:227], v[32:47]
    ds_read_b128 a[136:139], v1 offset:24576
    ds_read_b128 a[140:143], v1 offset:53248
    v_mfma_f32_32x32x16_bf16 v[48:63], a[148:151], v[224:227], v[48:63]
    s_waitcnt vmcnt(4) lgkmcnt(4)
    v_mfma_f32_32x32x16_bf16 v[32:47], a[152:155], v[228:231], v[32:47]
    ds_read_b128 a[144:147], v1 offset:25600
    ds_read_b128 a[148:151], v1 offset:54272
    v_mfma_f32_32x32x16_bf16 v[48:63], a[156:159], v[228:231], v[48:63]
    v_mul_f32 v122, 0x3fb8aa3b, v124
    s_waitcnt vmcnt(3) lgkmcnt(5)
    v_mfma_f32_32x32x16_bf16 v[32:47], a[128:131], v[232:235], v[32:47]
    ds_read_b128 a[152:155], v1 offset:26624
    ds_read_b128 a[156:159], v1 offset:55296
    s_waitcnt vmcnt(2) lgkmcnt(5)
    v_mfma_f32_32x32x16_bf16 v[32:47], a[136:139], v[236:239], v[32:47]
    s_waitcnt vmcnt(1) lgkmcnt(3)
    v_mfma_f32_32x32x16_bf16 v[32:47], a[144:147], v[240:243], v[32:47]
    s_waitcnt vmcnt(0) lgkmcnt(1)
    v_mfma_f32_32x32x16_bf16 v[32:47], a[152:155], v[244:247], v[32:47]
    v_mfma_f32_32x32x16_bf16 v[48:63], a[132:135], v[232:235], v[48:63]
    v_mfma_f32_32x32x16_bf16 v[48:63], a[140:143], v[236:239], v[48:63]
    s_nop 7
    v_mfma_f32_32x32x16_bf16 v[48:63], a[148:151], v[240:243], v[48:63]
    s_nop 0
    v_mul_f32 v32, v32, v122
    v_mul_f32 v33, v33, v122
    v_cvt_pk_bf16_f32 v80, v32, v33
    v_mul_f32 v34, v34, v122
    v_mul_f32 v35, v35, v122
    v_cvt_pk_bf16_f32 v81, v34, v35
    s_waitcnt lgkmcnt(0)
    v_mfma_f32_32x32x16_bf16 v[48:63], a[156:159], v[244:247], v[48:63]
    v_mul_f32 v36, v36, v122
    v_mul_f32 v37, v37, v122
    v_cvt_pk_bf16_f32 v82, v36, v37
    v_mul_f32 v38, v38, v122
    v_mul_f32 v39, v39, v122
    v_cvt_pk_bf16_f32 v83, v38, v39
    v_mul_f32 v40, v40, v122
    v_mul_f32 v41, v41, v122
    v_cvt_pk_bf16_f32 v84, v40, v41
    v_mul_f32 v42, v42, v122
    v_mul_f32 v43, v43, v122
    v_cvt_pk_bf16_f32 v85, v42, v43
    v_mul_f32 v44, v44, v122
    v_mul_f32 v45, v45, v122
    v_cvt_pk_bf16_f32 v86, v44, v45
    v_mul_f32 v46, v46, v122
    v_mul_f32 v47, v47, v122
    v_cvt_pk_bf16_f32 v87, v46, v47
    v_mfma_f32_32x32x16_bf16 v[64:79], a[172:175], v[80:83], 0
    v_mul_f32 v48, v48, v124
    v_mul_f32 v49, v49, v124
    v_mul_f32 v50, v50, v124
    v_mul_f32 v51, v51, v124
    v_mul_f32 v52, v52, v124
    v_mul_f32 v53, v53, v124
    v_mfma_f32_32x32x16_bf16 v[64:79], a[176:179], v[84:87], v[64:79]
    v_mul_f32 v54, v54, v124
    v_mul_f32 v55, v55, v124
    v_mul_f32 v56, v56, v124
    v_mul_f32 v57, v57, v124
    v_mul_f32 v58, v58, v124
    v_mul_f32 v59, v59, v124
    v_mul_f32 v60, v60, v124
    v_mul_f32 v61, v61, v124
    v_mul_f32 v62, v62, v124
    v_mul_f32 v63, v63, v124
    v_cvt_pk_bf16_f32 v104, v48, v49
    v_cvt_pk_bf16_f32 v105, v50, v51
L_page_7:
    s_cbranch_vccnz L_page_11
    v_cvt_pk_bf16_f32 v106, v52, v53
    v_cvt_pk_bf16_f32 v107, v54, v55
    v_cvt_pk_bf16_f32 v108, v56, v57
    v_cvt_pk_bf16_f32 v109, v58, v59
    v_cvt_pk_bf16_f32 v110, v60, v61
    v_cvt_pk_bf16_f32 v111, v62, v63
    s_mov_b64 exec, s[80:81]
    v_mov_b32 v110, 0x00003f80
    v_mov_b32 v111, 0
    s_mov_b64 exec, -1
    v_xor_b32 v32, 128, v8
    ds_write_b64 v32, v[104:105]
    v_xor_b32 v33, 144, v8
    ds_write_b64 v33, v[106:107]
    v_xor_b32 v32, 160, v8
    ds_write_b64 v32, v[108:109]
    v_xor_b32 v33, 176, v8
    ds_write_b64 v33, v[110:111]
    v_max3_f32 v120, v64, v65, v66
    v_max3_f32 v121, -v64, -v65, -v66
    v_max3_f32 v120, v120, v67, v68
    v_max3_f32 v121, v121, -v67, -v68
    v_max3_f32 v120, v120, v69, v70
    v_max3_f32 v121, v121, -v69, -v70
    v_max3_f32 v120, v120, v71, v72
    v_max3_f32 v121, v121, -v71, -v72
    v_max3_f32 v120, v120, v73, v74
    v_max3_f32 v121, v121, -v73, -v74
    v_max3_f32 v120, v120, v75, v76
    v_max3_f32 v121, v121, -v75, -v76
    v_max_f32 v120, v120, v77
    v_max_f32_e64 v121, v121, -v77
    s_nop 1
    v_permlane32_swap_b32 v120, v121
    v_max_f32 v121, v120, v121
    v_mov_b32 v120, v121
    s_nop 1
    v_permlane32_swap_b32 v120, v121
    v_pk_add_f32 v[88:89], v[64:65], v[120:121] op_sel:[0,0] op_sel_hi:[1,0] neg_lo:[0,1] neg_hi:[0,1]
    v_pk_add_f32 v[64:65], v[64:65], v[120:121] op_sel:[0,1] op_sel_hi:[1,1] neg_lo:[1,1] neg_hi:[1,1]
    v_pk_add_f32 v[90:91], v[66:67], v[120:121] op_sel:[0,0] op_sel_hi:[1,0] neg_lo:[0,1] neg_hi:[0,1]
    v_pk_add_f32 v[66:67], v[66:67], v[120:121] op_sel:[0,1] op_sel_hi:[1,1] neg_lo:[1,1] neg_hi:[1,1]
    v_pk_add_f32 v[92:93], v[68:69], v[120:121] op_sel:[0,0] op_sel_hi:[1,0] neg_lo:[0,1] neg_hi:[0,1]
    v_pk_add_f32 v[68:69], v[68:69], v[120:121] op_sel:[0,1] op_sel_hi:[1,1] neg_lo:[1,1] neg_hi:[1,1]
    v_pk_add_f32 v[94:95], v[70:71], v[120:121] op_sel:[0,0] op_sel_hi:[1,0] neg_lo:[0,1] neg_hi:[0,1]
    v_pk_add_f32 v[70:71], v[70:71], v[120:121] op_sel:[0,1] op_sel_hi:[1,1] neg_lo:[1,1] neg_hi:[1,1]
    v_pk_add_f32 v[96:97], v[72:73], v[120:121] op_sel:[0,0] op_sel_hi:[1,0] neg_lo:[0,1] neg_hi:[0,1]
    v_pk_add_f32 v[72:73], v[72:73], v[120:121] op_sel:[0,1] op_sel_hi:[1,1] neg_lo:[1,1] neg_hi:[1,1]
    v_pk_add_f32 v[98:99], v[74:75], v[120:121] op_sel:[0,0] op_sel_hi:[1,0] neg_lo:[0,1] neg_hi:[0,1]
    v_pk_add_f32 v[74:75], v[74:75], v[120:121] op_sel:[0,1] op_sel_hi:[1,1] neg_lo:[1,1] neg_hi:[1,1]
    v_pk_add_f32 v[100:101], v[76:77], v[120:121] op_sel:[0,0] op_sel_hi:[1,0] neg_lo:[0,1] neg_hi:[0,1]
    v_pk_add_f32 v[76:77], v[76:77], v[120:121] op_sel:[0,1] op_sel_hi:[1,1] neg_lo:[1,1] neg_hi:[1,1]
    v_exp_f32 v88, v88
    v_exp_f32 v64, v64
    v_exp_f32 v89, v89
    v_exp_f32 v65, v65
    v_exp_f32 v90, v90
    v_exp_f32 v66, v66
    v_exp_f32 v91, v91
    v_exp_f32 v67, v67
    v_exp_f32 v92, v92
    v_exp_f32 v68, v68
    v_exp_f32 v93, v93
    v_exp_f32 v69, v69
    v_exp_f32 v94, v94
    v_exp_f32 v70, v70
    v_exp_f32 v95, v95
    v_exp_f32 v71, v71
    v_exp_f32 v96, v96
    v_exp_f32 v72, v72
    v_exp_f32 v97, v97
    v_exp_f32 v73, v73
    v_exp_f32 v98, v98
    v_exp_f32 v74, v74
    v_exp_f32 v99, v99
    v_exp_f32 v75, v75
    v_exp_f32 v100, v100
    v_exp_f32 v76, v76
    v_exp_f32 v101, v101
    v_exp_f32 v77, v77
    v_pk_add_f32 v[120:121], v[88:89], v[90:91]
    v_pk_add_f32 v[122:123], v[64:65], v[66:67]
    v_pk_add_f32 v[120:121], v[120:121], v[92:93]
    v_pk_add_f32 v[122:123], v[122:123], v[68:69]
    v_pk_add_f32 v[120:121], v[120:121], v[94:95]
    v_pk_add_f32 v[122:123], v[122:123], v[70:71]
    v_pk_add_f32 v[120:121], v[120:121], v[96:97]
    v_pk_add_f32 v[122:123], v[122:123], v[72:73]
    v_pk_add_f32 v[120:121], v[120:121], v[98:99]
    v_pk_add_f32 v[122:123], v[122:123], v[74:75]
    v_pk_add_f32 v[120:121], v[120:121], v[100:101]
    v_pk_add_f32 v[122:123], v[122:123], v[76:77]
    v_add_f32 v120, v120, v121
    v_add_f32 v121, v122, v123
    v_mov_b32 v111, 0
    s_nop 0
    v_permlane32_swap_b32 v120, v121
    v_add_f32 v121, v120, v121
    v_rcp_f32 v121, v121
    v_mov_b32 v119, 0
    v_mov_b32 v120, v121
    s_nop 1
    v_permlane32_swap_b32 v120, v121
    v_pk_mul_f32 v[88:89], v[88:89], v[120:121] op_sel:[0,0] op_sel_hi:[1,0]
    v_pk_mul_f32 v[90:91], v[90:91], v[120:121] op_sel:[0,0] op_sel_hi:[1,0]
    v_pk_mul_f32 v[92:93], v[92:93], v[120:121] op_sel:[0,0] op_sel_hi:[1,0]
    v_pk_mul_f32 v[94:95], v[94:95], v[120:121] op_sel:[0,0] op_sel_hi:[1,0]
    v_pk_mul_f32 v[96:97], v[96:97], v[120:121] op_sel:[0,0] op_sel_hi:[1,0]
    v_pk_mul_f32 v[98:99], v[98:99], v[120:121] op_sel:[0,0] op_sel_hi:[1,0]
    v_pk_mul_f32 v[100:101], v[100:101], v[120:121] op_sel:[0,0] op_sel_hi:[1,0]
    v_cvt_pk_bf16_f32 v104, v88, v89
    v_cvt_pk_bf16_f32 v105, v90, v91
    v_cvt_pk_bf16_f32 v106, v92, v93
    v_cvt_pk_bf16_f32 v107, v94, v95
    v_cvt_pk_bf16_f32 v108, v96, v97
    v_cvt_pk_bf16_f32 v109, v98, v99
    v_cvt_pk_bf16_f32 v110, v100, v101
    ds_write_b64 v8, v[104:105]
    v_xor_b32 v33, 16, v8
    ds_write_b64 v33, v[106:107]
    v_xor_b32 v32, 32, v8
    ds_write_b64 v32, v[108:109]
    v_xor_b32 v33, 48, v8
    ds_write_b64 v33, v[110:111]
    v_pk_mul_f32 v[64:65], v[64:65], v[120:121] op_sel:[0,1] op_sel_hi:[1,1]
    v_pk_mul_f32 v[66:67], v[66:67], v[120:121] op_sel:[0,1] op_sel_hi:[1,1]
    v_pk_mul_f32 v[68:69], v[68:69], v[120:121] op_sel:[0,1] op_sel_hi:[1,1]
    v_pk_mul_f32 v[70:71], v[70:71], v[120:121] op_sel:[0,1] op_sel_hi:[1,1]
    v_pk_mul_f32 v[72:73], v[72:73], v[120:121] op_sel:[0,1] op_sel_hi:[1,1]
    v_pk_mul_f32 v[74:75], v[74:75], v[120:121] op_sel:[0,1] op_sel_hi:[1,1]
    v_pk_mul_f32 v[76:77], v[76:77], v[120:121] op_sel:[0,1] op_sel_hi:[1,1]
    v_cvt_pk_bf16_f32 v112, v64, v65
    v_cvt_pk_bf16_f32 v113, v66, v67
    v_cvt_pk_bf16_f32 v114, v68, v69
    v_cvt_pk_bf16_f32 v115, v70, v71
    v_cvt_pk_bf16_f32 v116, v72, v73
    v_cvt_pk_bf16_f32 v117, v74, v75
    v_cvt_pk_bf16_f32 v118, v76, v77
    v_xor_b32 v32, 64, v8
    ds_write_b64 v32, v[112:113]
    v_xor_b32 v33, 80, v8
    ds_write_b64 v33, v[114:115]
    v_xor_b32 v32, 96, v8
    ds_write_b64 v32, v[116:117]
    v_xor_b32 v33, 112, v8
    ds_write_b64 v33, v[118:119]
    s_lshl_b32 s90, s60, 10
    s_add_u32 s90, s90, s71
    s_add_u32 s90, s90, 25165824
    s_waitcnt lgkmcnt(0)
    s_barrier
    ds_read_b64_tr_b16 a[0:1], v9 offset:0
    ds_read_b64_tr_b16 a[2:3], v9 offset:4096
    ds_read_b64_tr_b16 a[4:5], v13 offset:0
    ds_read_b64_tr_b16 a[6:7], v13 offset:4096
    ds_read_b64_tr_b16 a[8:9], v7 offset:0
    ds_read_b64_tr_b16 a[10:11], v7 offset:4096
    ds_read_b64_tr_b16 a[12:13], v9 offset:8192
    ds_read_b64_tr_b16 a[14:15], v9 offset:12288
    ds_read_b64_tr_b16 a[16:17], v13 offset:8192
    ds_read_b64_tr_b16 a[18:19], v13 offset:12288
    ds_read_b64_tr_b16 a[20:21], v7 offset:8192
    ds_read_b64_tr_b16 a[22:23], v7 offset:12288
    s_waitcnt lgkmcnt(8)
    v_mfma_f32_16x16x32_bf16 v[36:39], a[0:3], a[4:7], 0
    ds_read_b64_tr_b16 a[24:25], v9 offset:16384
    ds_read_b64_tr_b16 a[26:27], v9 offset:20480
    ds_read_b64_tr_b16 a[28:29], v13 offset:16384
    ds_read_b64_tr_b16 a[30:31], v13 offset:20480
    ds_read_b64_tr_b16 a[32:33], v7 offset:16384
    ds_read_b64_tr_b16 a[34:35], v7 offset:20480
    s_waitcnt lgkmcnt(12)
    v_mfma_f32_16x16x32_bf16 v[40:43], a[0:3], a[8:11], 0
    s_waitcnt lgkmcnt(8)
    v_mfma_f32_16x16x32_bf16 v[36:39], a[12:15], a[16:19], v[36:39]
    ds_read_b64_tr_b16 a[36:37], v9 offset:24576
    ds_read_b64_tr_b16 a[38:39], v9 offset:28672
    ds_read_b64_tr_b16 a[40:41], v13 offset:24576
    ds_read_b64_tr_b16 a[42:43], v13 offset:28672
    ds_read_b64_tr_b16 a[44:45], v7 offset:24576
    ds_read_b64_tr_b16 a[46:47], v7 offset:28672
    s_waitcnt lgkmcnt(12)
    v_mfma_f32_16x16x32_bf16 v[40:43], a[12:15], a[20:23], v[40:43]
    s_waitcnt lgkmcnt(8)
    v_mfma_f32_16x16x32_bf16 v[36:39], a[24:27], a[28:31], v[36:39]
    s_waitcnt lgkmcnt(6)
    v_mfma_f32_16x16x32_bf16 v[40:43], a[24:27], a[32:35], v[40:43]
    s_waitcnt lgkmcnt(2)
    v_mfma_f32_16x16x32_bf16 v[36:39], a[36:39], a[40:43], v[36:39]
    s_waitcnt lgkmcnt(0)
    v_mfma_f32_16x16x32_bf16 v[40:43], a[36:39], a[44:47], v[40:43]
    s_nop 5
    v_cvt_pk_bf16_f32 v44, v36, v37
    v_cvt_pk_bf16_f32 v45, v38, v39
    v_cvt_pk_bf16_f32 v46, v40, v41
    v_cvt_pk_bf16_f32 v47, v42, v43
    buffer_store_dwordx4 v[44:47], v1, s[52:55], s90 offen sc1
    ds_read_b128 a[128:131], v2 offset:0
    ds_read_b128 a[132:135], v2 offset:1024
    ds_read_b128 a[136:139], v2 offset:2048
    ds_read_b128 a[140:143], v2 offset:3072
    ds_read_b128 a[144:147], v2 offset:4096
    s_waitcnt lgkmcnt(4)
    v_mfma_f32_32x32x16_bf16 v[64:79], a[128:131], v[128:131], 0
    ds_read_b128 a[148:151], v2 offset:5120
    s_waitcnt lgkmcnt(4)
    v_mfma_f32_32x32x16_bf16 v[64:79], a[132:135], v[132:135], v[64:79]
    ds_read_b128 a[152:155], v2 offset:6144
    s_waitcnt lgkmcnt(4)
    v_mfma_f32_32x32x16_bf16 v[64:79], a[136:139], v[136:139], v[64:79]
    ds_read_b128 a[156:159], v2 offset:13312
    s_waitcnt lgkmcnt(4)
    v_mfma_f32_32x32x16_bf16 v[64:79], a[140:143], v[140:143], v[64:79]
    ds_read_b128 a[128:131], v2 offset:20480
    s_waitcnt lgkmcnt(4)
    v_mfma_f32_32x32x16_bf16 v[64:79], a[144:147], v[144:147], v[64:79]
    ds_read_b128 a[132:135], v2 offset:27648
    s_waitcnt lgkmcnt(4)
    v_mfma_f32_32x32x16_bf16 v[64:79], a[148:151], v[148:151], v[64:79]
    ds_read_b128 a[136:139], v2 offset:7168
    s_waitcnt lgkmcnt(4)
    v_mfma_f32_32x32x16_bf16 v[64:79], a[152:155], v[154:157], v[64:79]
    ds_read_b128 a[140:143], v2 offset:8192
    s_waitcnt lgkmcnt(4)
    v_mfma_f32_32x32x16_bf16 v[64:79], a[156:159], v[186:189], v[64:79]
    ds_read_b128 a[144:147], v2 offset:9216
    s_waitcnt lgkmcnt(4)
    v_mfma_f32_32x32x16_bf16 v[64:79], a[128:131], v[218:221], v[64:79]
    ds_read_b128 a[148:151], v2 offset:10240
    s_waitcnt lgkmcnt(4)
    v_mfma_f32_32x32x16_bf16 v[64:79], a[132:135], v[250:253], v[64:79]
    ds_read_b128 a[152:155], v2 offset:11264
    s_waitcnt lgkmcnt(4)
    v_mfma_f32_32x32x16_bf16 v[64:79], a[136:139], v[160:163], v[64:79]
    ds_read_b128 a[156:159], v2 offset:12288
    s_waitcnt lgkmcnt(4)
    v_mfma_f32_32x32x16_bf16 v[64:79], a[140:143], v[164:167], v[64:79]
    ds_read_b128 a[128:131], v2 offset:14336
    s_waitcnt lgkmcnt(4)
    v_mfma_f32_32x32x16_bf16 v[64:79], a[144:147], v[168:171], v[64:79]
    ds_read_b128 a[132:135], v2 offset:15360
    s_waitcnt lgkmcnt(4)
    v_mfma_f32_32x32x16_bf16 v[64:79], a[148:151], v[172:175], v[64:79]
    ds_read_b128 a[136:139], v2 offset:16384
    s_waitcnt lgkmcnt(4)
    v_mfma_f32_32x32x16_bf16 v[64:79], a[152:155], v[176:179], v[64:79]
    ds_read_b128 a[140:143], v2 offset:17408
    s_waitcnt vmcnt(0)
    s_atomic_add s57, s[66:67], 0
    s_add_u32 m0, s100, 86016
    s_add_u32 s90, s3, 86016
    buffer_load_dwordx4 v1, s[52:55], s90 offen offset:0 sc1 lds
    s_waitcnt lgkmcnt(4)
    v_mfma_f32_32x32x16_bf16 v[64:79], a[156:159], v[180:183], v[64:79]
    ds_read_b128 a[144:147], v2 offset:18432
    s_waitcnt lgkmcnt(4)
    v_mfma_f32_32x32x16_bf16 v[64:79], a[128:131], v[192:195], v[64:79]
    ds_read_b128 a[148:151], v2 offset:19456
    buffer_load_dwordx4 v1, s[52:55], s90 offen offset:1024 sc1 lds
    s_waitcnt lgkmcnt(4)
    v_mfma_f32_32x32x16_bf16 v[64:79], a[132:135], v[196:199], v[64:79]
    ds_read_b128 a[152:155], v2 offset:21504
    s_waitcnt lgkmcnt(4)
    v_mfma_f32_32x32x16_bf16 v[64:79], a[136:139], v[200:203], v[64:79]
    ds_read_b128 a[156:159], v2 offset:22528
    buffer_load_dwordx4 v1, s[52:55], s90 offen offset:2048 sc1 lds
    s_waitcnt lgkmcnt(4)
    v_mfma_f32_32x32x16_bf16 v[64:79], a[140:143], v[204:207], v[64:79]
    ds_read_b128 a[128:131], v2 offset:23552
    s_waitcnt lgkmcnt(4)
    v_mfma_f32_32x32x16_bf16 v[64:79], a[144:147], v[208:211], v[64:79]
    ds_read_b128 a[132:135], v2 offset:24576
    buffer_load_dwordx4 v1, s[52:55], s90 offen offset:3072 sc1 lds
    s_waitcnt lgkmcnt(4)
    v_mfma_f32_32x32x16_bf16 v[64:79], a[148:151], v[212:215], v[64:79]
    ds_read_b128 a[136:139], v2 offset:25600
    s_waitcnt lgkmcnt(4)
    v_mfma_f32_32x32x16_bf16 v[64:79], a[152:155], v[224:227], v[64:79]
    ds_read_b128 a[140:143], v2 offset:26624
    s_add_u32 m0, s100, 90112
    s_add_u32 s90, s3, 90112
    buffer_load_dwordx4 v1, s[52:55], s90 offen offset:0 sc1 lds
    s_waitcnt lgkmcnt(4)
    v_mfma_f32_32x32x16_bf16 v[64:79], a[156:159], v[228:231], v[64:79]
    s_waitcnt lgkmcnt(3)
    v_mfma_f32_32x32x16_bf16 v[64:79], a[128:131], v[232:235], v[64:79]
    buffer_load_dwordx4 v1, s[52:55], s90 offen offset:1024 sc1 lds
    s_waitcnt lgkmcnt(2)
    v_mfma_f32_32x32x16_bf16 v[64:79], a[132:135], v[236:239], v[64:79]
    s_waitcnt lgkmcnt(1)
    v_mfma_f32_32x32x16_bf16 v[64:79], a[136:139], v[240:243], v[64:79]
    buffer_load_dwordx4 v1, s[52:55], s90 offen offset:2048 sc1 lds
    s_waitcnt lgkmcnt(0)
    v_mfma_f32_32x32x16_bf16 v[64:79], a[140:143], v[244:247], v[64:79]
    v_mfma_f32_32x32x8_bf16 v[64:79], a[164:165], v[126:127], v[64:79]
    s_mov_b32 s101, 0
    s_atomic_add s101, s[66:67], 0 glc
    v_mul_f32 v122, 0x3fb8aa3b, v124
    s_and_b32 s90, s60, 3
    s_lshl_b32 s90, s90, 12
    s_add_u32 s90, s90, s71
    s_add_u32 s72, s90, 25165824
    s_xor_b32 s73, s72, 4096
    s_xor_b32 s74, s72, 8192
    s_xor_b32 s75, s72, 12288
    s_nop 1
    v_pk_mul_f32 v[64:65], v[64:65], v[122:123] op_sel:[0,0] op_sel_hi:[1,0]
    v_pk_mul_f32 v[66:67], v[66:67], v[122:123] op_sel:[0,0] op_sel_hi:[1,0]
    v_pk_mul_f32 v[68:69], v[68:69], v[122:123] op_sel:[0,0] op_sel_hi:[1,0]
    v_pk_mul_f32 v[70:71], v[70:71], v[122:123] op_sel:[0,0] op_sel_hi:[1,0]
    v_pk_mul_f32 v[72:73], v[72:73], v[122:123] op_sel:[0,0] op_sel_hi:[1,0]
    v_pk_mul_f32 v[74:75], v[74:75], v[122:123] op_sel:[0,0] op_sel_hi:[1,0]
    v_pk_mul_f32 v[76:77], v[76:77], v[122:123] op_sel:[0,0] op_sel_hi:[1,0]
    v_pk_mul_f32 v[78:79], v[78:79], v[122:123] op_sel:[0,0] op_sel_hi:[1,0]
    v_cvt_pk_bf16_f32 v80, v64, v65
    v_cvt_pk_bf16_f32 v81, v66, v67
    v_cvt_pk_bf16_f32 v82, v68, v69
    v_cvt_pk_bf16_f32 v83, v70, v71
    v_cvt_pk_bf16_f32 v84, v72, v73
    v_cvt_pk_bf16_f32 v85, v74, v75
    v_cvt_pk_bf16_f32 v86, v76, v77
    v_cvt_pk_bf16_f32 v87, v78, v79
    v_mfma_f32_32x32x16_bf16 v[64:79], a[172:175], v[80:83], 0
    s_nop 0
    v_mfma_f32_32x32x16_bf16 v[64:79], a[176:179], v[84:87], v[64:79]
    s_nop 11
    v_max3_f32 v120, v64, v65, v66
    v_max3_f32 v121, -v64, -v65, -v66
    v_max3_f32 v120, v120, v67, v68
    v_max3_f32 v121, v121, -v67, -v68
    v_max3_f32 v120, v120, v69, v70
    v_max3_f32 v121, v121, -v69, -v70
    v_max3_f32 v120, v120, v71, v72
    v_max3_f32 v121, v121, -v71, -v72
    v_max3_f32 v120, v120, v73, v74
    v_max3_f32 v121, v121, -v73, -v74
    v_max3_f32 v120, v120, v75, v76
    v_max3_f32 v121, v121, -v75, -v76
    v_max_f32 v120, v120, v77
    v_max_f32_e64 v121, v121, -v77
    s_nop 1
    v_permlane32_swap_b32 v120, v121
    v_max_f32 v121, v120, v121
    v_mov_b32 v120, v121
    s_nop 1
    v_permlane32_swap_b32 v120, v121
    v_pk_add_f32 v[88:89], v[64:65], v[120:121] op_sel:[0,0] op_sel_hi:[1,0] neg_lo:[0,1] neg_hi:[0,1]
    v_pk_add_f32 v[64:65], v[64:65], v[120:121] op_sel:[0,1] op_sel_hi:[1,1] neg_lo:[1,1] neg_hi:[1,1]
    v_pk_add_f32 v[90:91], v[66:67], v[120:121] op_sel:[0,0] op_sel_hi:[1,0] neg_lo:[0,1] neg_hi:[0,1]
    v_pk_add_f32 v[66:67], v[66:67], v[120:121] op_sel:[0,1] op_sel_hi:[1,1] neg_lo:[1,1] neg_hi:[1,1]
    v_pk_add_f32 v[92:93], v[68:69], v[120:121] op_sel:[0,0] op_sel_hi:[1,0] neg_lo:[0,1] neg_hi:[0,1]
    v_pk_add_f32 v[68:69], v[68:69], v[120:121] op_sel:[0,1] op_sel_hi:[1,1] neg_lo:[1,1] neg_hi:[1,1]
    v_pk_add_f32 v[94:95], v[70:71], v[120:121] op_sel:[0,0] op_sel_hi:[1,0] neg_lo:[0,1] neg_hi:[0,1]
    v_pk_add_f32 v[70:71], v[70:71], v[120:121] op_sel:[0,1] op_sel_hi:[1,1] neg_lo:[1,1] neg_hi:[1,1]
    v_pk_add_f32 v[96:97], v[72:73], v[120:121] op_sel:[0,0] op_sel_hi:[1,0] neg_lo:[0,1] neg_hi:[0,1]
    v_pk_add_f32 v[72:73], v[72:73], v[120:121] op_sel:[0,1] op_sel_hi:[1,1] neg_lo:[1,1] neg_hi:[1,1]
    v_pk_add_f32 v[98:99], v[74:75], v[120:121] op_sel:[0,0] op_sel_hi:[1,0] neg_lo:[0,1] neg_hi:[0,1]
    v_pk_add_f32 v[74:75], v[74:75], v[120:121] op_sel:[0,1] op_sel_hi:[1,1] neg_lo:[1,1] neg_hi:[1,1]
    v_pk_add_f32 v[100:101], v[76:77], v[120:121] op_sel:[0,0] op_sel_hi:[1,0] neg_lo:[0,1] neg_hi:[0,1]
    v_pk_add_f32 v[76:77], v[76:77], v[120:121] op_sel:[0,1] op_sel_hi:[1,1] neg_lo:[1,1] neg_hi:[1,1]
    v_exp_f32 v88, v88
    v_exp_f32 v64, v64
    v_exp_f32 v89, v89
    v_exp_f32 v65, v65
    v_exp_f32 v90, v90
    v_exp_f32 v66, v66
    v_exp_f32 v91, v91
    v_exp_f32 v67, v67
    v_exp_f32 v92, v92
    v_exp_f32 v68, v68
    v_exp_f32 v93, v93
    v_exp_f32 v69, v69
    v_exp_f32 v94, v94
    v_exp_f32 v70, v70
    v_exp_f32 v95, v95
    v_exp_f32 v71, v71
    v_exp_f32 v96, v96
    v_exp_f32 v72, v72
    v_exp_f32 v97, v97
    v_exp_f32 v73, v73
    v_exp_f32 v98, v98
    v_exp_f32 v74, v74
    v_exp_f32 v99, v99
    v_exp_f32 v75, v75
    v_exp_f32 v100, v100
    v_exp_f32 v76, v76
    v_exp_f32 v101, v101
    v_exp_f32 v77, v77
    v_pk_add_f32 v[120:121], v[88:89], v[90:91]
    v_pk_add_f32 v[122:123], v[64:65], v[66:67]
    v_pk_add_f32 v[120:121], v[120:121], v[92:93]
    v_pk_add_f32 v[122:123], v[122:123], v[68:69]
    s_waitcnt lgkmcnt(0)
    s_add_u32 s89, s101, 0x74747474
    s_and_b32 s89, s89, 0x80808080
    s_cmp_eq_u32 s89, 0x80808080
    s_cbranch_scc1 L_go_18
L_poll_17:
    s_mov_b32 s101, 0
    s_atomic_add s101, s[66:67], 0 glc
    s_sub_u32 s63, s63, 1
    s_cbranch_scc1 L_go_18_to
    s_waitcnt lgkmcnt(0)
    s_add_u32 s89, s101, 0x74747474
    s_and_b32 s89, s89, 0x80808080
    s_cmp_eq_u32 s89, 0x80808080
    s_cbranch_scc0 L_poll_17
    s_branch L_go_18
L_go_18_to:
    s_mov_b32 s63, 0
    s_waitcnt lgkmcnt(0)
L_go_18:
    buffer_load_dwordx4 v[128:131], v1, s[52:55], s72 offen offset:0 sc1
    buffer_load_dwordx4 v[132:135], v1, s[52:55], s72 offen offset:1024 sc1
    buffer_load_dwordx4 v[136:139], v1, s[52:55], s72 offen offset:2048 sc1
    buffer_load_dwordx4 v[140:143], v1, s[52:55], s72 offen offset:3072 sc1
    v_pk_add_f32 v[120:121], v[120:121], v[94:95]
    buffer_load_dwordx4 v[144:147], v1, s[52:55], s73 offen offset:0 sc1
    v_pk_add_f32 v[122:123], v[122:123], v[70:71]
    v_pk_add_f32 v[120:121], v[120:121], v[96:97]
    v_pk_add_f32 v[122:123], v[122:123], v[72:73]
    v_pk_add_f32 v[120:121], v[120:121], v[98:99]
    buffer_load_dwordx4 v[148:151], v1, s[52:55], s73 offen offset:1024 sc1
    v_pk_add_f32 v[122:123], v[122:123], v[74:75]
    v_pk_add_f32 v[120:121], v[120:121], v[100:101]
    v_pk_add_f32 v[122:123], v[122:123], v[76:77]
    v_add_f32 v120, v120, v121
    buffer_load_dwordx4 v[152:155], v1, s[52:55], s73 offen offset:2048 sc1
    v_add_f32 v121, v122, v123
    v_mov_b32 v111, 0
    s_nop 0
    v_permlane32_swap_b32 v120, v121
    v_add_f32 v121, v120, v121
    buffer_load_dwordx4 v[156:159], v1, s[52:55], s73 offen offset:3072 sc1
    v_rcp_f32 v121, v121
    v_mov_b32 v119, 0
    v_mov_b32 v120, v121
    s_nop 1
    v_permlane32_swap_b32 v120, v121
    buffer_load_dwordx4 v[160:163], v1, s[52:55], s74 offen offset:0 sc1
    v_pk_mul_f32 v[88:89], v[88:89], v[120:121] op_sel:[0,0] op_sel_hi:[1,0]
    v_pk_mul_f32 v[90:91], v[90:91], v[120:121] op_sel:[0,0] op_sel_hi:[1,0]
    v_pk_mul_f32 v[92:93], v[92:93], v[120:121] op_sel:[0,0] op_sel_hi:[1,0]
    v_pk_mul_f32 v[94:95], v[94:95], v[120:121] op_sel:[0,0] op_sel_hi:[1,0]
    buffer_load_dwordx4 v[164:167], v1, s[52:55], s74 offen offset:1024 sc1
    v_pk_mul_f32 v[96:97], v[96:97], v[120:121] op_sel:[0,0] op_sel_hi:[1,0]
    v_pk_mul_f32 v[98:99], v[98:99], v[120:121] op_sel:[0,0] op_sel_hi:[1,0]
    v_pk_mul_f32 v[100:101], v[100:101], v[120:121] op_sel:[0,0] op_sel_hi:[1,0]
    v_cvt_pk_bf16_f32 v104, v88, v89
    buffer_load_dwordx4 v[168:171], v1, s[52:55], s74 offen offset:2048 sc1
    v_cvt_pk_bf16_f32 v105, v90, v91
    v_cvt_pk_bf16_f32 v106, v92, v93
    v_cvt_pk_bf16_f32 v107, v94, v95
    v_cvt_pk_bf16_f32 v108, v96, v97
    buffer_load_dwordx4 v[172:175], v1, s[52:55], s74 offen offset:3072 sc1
    v_cvt_pk_bf16_f32 v109, v98, v99
    v_cvt_pk_bf16_f32 v110, v100, v101
    v_pk_mul_f32 v[64:65], v[64:65], v[120:121] op_sel:[0,1] op_sel_hi:[1,1]
    v_pk_mul_f32 v[66:67], v[66:67], v[120:121] op_sel:[0,1] op_sel_hi:[1,1]
    buffer_load_dwordx4 v[176:179], v1, s[52:55], s75 offen offset:0 sc1
    v_pk_mul_f32 v[68:69], v[68:69], v[120:121] op_sel:[0,1] op_sel_hi:[1,1]
    v_pk_mul_f32 v[70:71], v[70:71], v[120:121] op_sel:[0,1] op_sel_hi:[1,1]
    v_pk_mul_f32 v[72:73], v[72:73], v[120:121] op_sel:[0,1] op_sel_hi:[1,1]
    v_pk_mul_f32 v[74:75], v[74:75], v[120:121] op_sel:[0,1] op_sel_hi:[1,1]
    buffer_load_dwordx4 v[180:183], v1, s[52:55], s75 offen offset:1024 sc1
    v_pk_mul_f32 v[76:77], v[76:77], v[120:121] op_sel:[0,1] op_sel_hi:[1,1]
    v_cvt_pk_bf16_f32 v112, v64, v65
    v_cvt_pk_bf16_f32 v113, v66, v67
    v_cvt_pk_bf16_f32 v114, v68, v69
    buffer_load_dwordx4 v[184:187], v1, s[52:55], s75 offen offset:2048 sc1
    v_cvt_pk_bf16_f32 v115, v70, v71
    v_cvt_pk_bf16_f32 v116, v72, v73
    v_cvt_pk_bf16_f32 v117, v74, v75
    v_cvt_pk_bf16_f32 v118, v76, v77
    buffer_load_dwordx4 v[188:191], v1, s[52:55], s75 offen offset:3072 sc1
    s_waitcnt vmcnt(15)
    v_dot2_f32_bf16 v80, v128, s93, 0
    v_dot2_f32_bf16 v81, v128, s94, 0
    v_dot2_f32_bf16 v82, v129, s93, 0
    v_dot2_f32_bf16 v83, v129, s94, 0
    v_dot2_f32_bf16 v84, v130, s93, 0
    v_dot2_f32_bf16 v85, v130, s94, 0
    v_dot2_f32_bf16 v86, v131, s93, 0
    v_dot2_f32_bf16 v87, v131, s94, 0
    s_waitcnt vmcnt(14)
    v_dot2_f32_bf16 v80, v132, s93, v80
    v_dot2_f32_bf16 v81, v132, s94, v81
    v_dot2_f32_bf16 v82, v133, s93, v82
    v_dot2_f32_bf16 v83, v133, s94, v83
    v_dot2_f32_bf16 v84, v134, s93, v84
    v_dot2_f32_bf16 v85, v134, s94, v85
    v_dot2_f32_bf16 v86, v135, s93, v86
    v_dot2_f32_bf16 v87, v135, s94, v87
    s_waitcnt vmcnt(13)
    v_dot2_f32_bf16 v80, v136, s93, v80
    v_dot2_f32_bf16 v81, v136, s94, v81
    v_dot2_f32_bf16 v82, v137, s93, v82
    v_dot2_f32_bf16 v83, v137, s94, v83
    v_dot2_f32_bf16 v84, v138, s93, v84
    v_dot2_f32_bf16 v85, v138, s94, v85
    v_dot2_f32_bf16 v86, v139, s93, v86
    v_dot2_f32_bf16 v87, v139, s94, v87
    s_waitcnt vmcnt(12)
    v_dot2_f32_bf16 v80, v140, s93, v80
    v_dot2_f32_bf16 v81, v140, s94, v81
    v_dot2_f32_bf16 v82, v141, s93, v82
    v_dot2_f32_bf16 v83, v141, s94, v83
    v_dot2_f32_bf16 v84, v142, s93, v84
    v_dot2_f32_bf16 v85, v142, s94, v85
    v_dot2_f32_bf16 v86, v143, s93, v86
    v_dot2_f32_bf16 v87, v143, s94, v87
    s_waitcnt vmcnt(11)
    v_dot2_f32_bf16 v80, v144, s93, v80
    v_dot2_f32_bf16 v81, v144, s94, v81
    v_dot2_f32_bf16 v82, v145, s93, v82
    v_dot2_f32_bf16 v83, v145, s94, v83
    v_dot2_f32_bf16 v84, v146, s93, v84
    v_dot2_f32_bf16 v85, v146, s94, v85
    v_dot2_f32_bf16 v86, v147, s93, v86
    v_dot2_f32_bf16 v87, v147, s94, v87
    s_waitcnt vmcnt(10)
    v_dot2_f32_bf16 v80, v148, s93, v80
    v_dot2_f32_bf16 v81, v148, s94, v81
    v_dot2_f32_bf16 v82, v149, s93, v82
    v_dot2_f32_bf16 v83, v149, s94, v83
    v_dot2_f32_bf16 v84, v150, s93, v84
    v_dot2_f32_bf16 v85, v150, s94, v85
    v_dot2_f32_bf16 v86, v151, s93, v86
    v_dot2_f32_bf16 v87, v151, s94, v87
    s_waitcnt vmcnt(9)
    v_dot2_f32_bf16 v80, v152, s93, v80
    v_dot2_f32_bf16 v81, v152, s94, v81
    v_dot2_f32_bf16 v82, v153, s93, v82
    v_dot2_f32_bf16 v83, v153, s94, v83
    v_dot2_f32_bf16 v84, v154, s93, v84
    v_dot2_f32_bf16 v85, v154, s94, v85
    v_dot2_f32_bf16 v86, v155, s93, v86
    v_dot2_f32_bf16 v87, v155, s94, v87
    s_waitcnt vmcnt(8)
    v_dot2_f32_bf16 v80, v156, s93, v80
    v_dot2_f32_bf16 v81, v156, s94, v81
    v_dot2_f32_bf16 v82, v157, s93, v82
    v_dot2_f32_bf16 v83, v157, s94, v83
    v_dot2_f32_bf16 v84, v158, s93, v84
    v_dot2_f32_bf16 v85, v158, s94, v85
    v_dot2_f32_bf16 v86, v159, s93, v86
    v_dot2_f32_bf16 v87, v159, s94, v87
    s_waitcnt vmcnt(7)
    v_dot2_f32_bf16 v80, v160, s93, v80
    v_dot2_f32_bf16 v81, v160, s94, v81
    v_dot2_f32_bf16 v82, v161, s93, v82
    v_dot2_f32_bf16 v83, v161, s94, v83
    v_dot2_f32_bf16 v84, v162, s93, v84
    v_dot2_f32_bf16 v85, v162, s94, v85
    v_dot2_f32_bf16 v86, v163, s93, v86
    v_dot2_f32_bf16 v87, v163, s94, v87
    s_waitcnt vmcnt(6)
    v_dot2_f32_bf16 v80, v164, s93, v80
    v_dot2_f32_bf16 v81, v164, s94, v81
    v_dot2_f32_bf16 v82, v165, s93, v82
    v_dot2_f32_bf16 v83, v165, s94, v83
    v_dot2_f32_bf16 v84, v166, s93, v84
    v_dot2_f32_bf16 v85, v166, s94, v85
    v_dot2_f32_bf16 v86, v167, s93, v86
    v_dot2_f32_bf16 v87, v167, s94, v87
    s_waitcnt vmcnt(5)
    v_dot2_f32_bf16 v80, v168, s93, v80
    v_dot2_f32_bf16 v81, v168, s94, v81
    v_dot2_f32_bf16 v82, v169, s93, v82
    v_dot2_f32_bf16 v83, v169, s94, v83
    v_dot2_f32_bf16 v84, v170, s93, v84
    v_dot2_f32_bf16 v85, v170, s94, v85
    v_dot2_f32_bf16 v86, v171, s93, v86
    v_dot2_f32_bf16 v87, v171, s94, v87
    s_waitcnt vmcnt(4)
    v_dot2_f32_bf16 v80, v172, s93, v80
    v_dot2_f32_bf16 v81, v172, s94, v81
    v_dot2_f32_bf16 v82, v173, s93, v82
    v_dot2_f32_bf16 v83, v173, s94, v83
    v_dot2_f32_bf16 v84, v174, s93, v84
    v_dot2_f32_bf16 v85, v174, s94, v85
    v_dot2_f32_bf16 v86, v175, s93, v86
    v_dot2_f32_bf16 v87, v175, s94, v87
    s_waitcnt vmcnt(3)
    v_dot2_f32_bf16 v80, v176, s93, v80
    v_dot2_f32_bf16 v81, v176, s94, v81
    v_dot2_f32_bf16 v82, v177, s93, v82
    v_dot2_f32_bf16 v83, v177, s94, v83
    v_dot2_f32_bf16 v84, v178, s93, v84
    v_dot2_f32_bf16 v85, v178, s94, v85
    v_dot2_f32_bf16 v86, v179, s93, v86
    v_dot2_f32_bf16 v87, v179, s94, v87
    s_waitcnt vmcnt(2)
    v_dot2_f32_bf16 v80, v180, s93, v80
    v_dot2_f32_bf16 v81, v180, s94, v81
    v_dot2_f32_bf16 v82, v181, s93, v82
    v_dot2_f32_bf16 v83, v181, s94, v83
    v_dot2_f32_bf16 v84, v182, s93, v84
    v_dot2_f32_bf16 v85, v182, s94, v85
    v_dot2_f32_bf16 v86, v183, s93, v86
    v_dot2_f32_bf16 v87, v183, s94, v87
L_page_8:
    s_cbranch_vccnz L_page_12
    s_waitcnt vmcnt(1)
    v_dot2_f32_bf16 v80, v184, s93, v80
    v_dot2_f32_bf16 v81, v184, s94, v81
    v_dot2_f32_bf16 v82, v185, s93, v82
    v_dot2_f32_bf16 v83, v185, s94, v83
    v_dot2_f32_bf16 v84, v186, s93, v84
    v_dot2_f32_bf16 v85, v186, s94, v85
    v_dot2_f32_bf16 v86, v187, s93, v86
    v_dot2_f32_bf16 v87, v187, s94, v87
    s_waitcnt vmcnt(0)
    v_dot2_f32_bf16 v80, v188, s93, v80
    v_dot2_f32_bf16 v81, v188, s94, v81
    v_dot2_f32_bf16 v82, v189, s93, v82
    v_dot2_f32_bf16 v83, v189, s94, v83
    v_dot2_f32_bf16 v84, v190, s93, v84
    v_dot2_f32_bf16 v85, v190, s94, v85
    v_dot2_f32_bf16 v86, v191, s93, v86
    v_dot2_f32_bf16 v87, v191, s94, v87
    v_cvt_pk_bf16_f32 v88, v80, v81
    v_cvt_pk_bf16_f32 v89, v82, v83
    v_cvt_pk_bf16_f32 v90, v84, v85
    v_cvt_pk_bf16_f32 v91, v86, v87
    ds_write_b64 v103, v[88:89] offset:0
    ds_write_b64 v103, v[90:91] offset:256
    s_waitcnt lgkmcnt(0)
    s_barrier
    ds_read_b128 a[128:131], v102 offset:32768
    ds_read_b128 a[132:135], v102 offset:33792
    ds_read_b128 a[136:139], v102 offset:34816
    ds_read_b128 a[140:143], v102 offset:35840
    s_waitcnt lgkmcnt(3)
    v_mfma_f32_32x32x16_bf16 v[32:47], a[128:131], v[104:107], 0
    s_waitcnt lgkmcnt(2)
    v_mfma_f32_32x32x16_bf16 v[32:47], a[132:135], v[108:111], v[32:47]
    s_waitcnt lgkmcnt(1)
    v_mfma_f32_32x32x16_bf16 v[32:47], a[136:139], v[112:115], v[32:47]
    s_waitcnt lgkmcnt(0)
    v_mfma_f32_32x32x16_bf16 v[32:47], a[140:143], v[116:119], v[32:47]
    s_nop 11
    v_mov_b32 v120, v44
    v_mov_b32 v121, v44
    s_add_u32 s90, s69, 9437184
    s_sub_u32 s91, s90, 4096
    v_permlane32_swap_b32 v120, v121
    v_add_f32 v121, 0x358637bd, v121
    v_rcp_f32 v120, v121
    s_nop 0
    v_pk_mul_f32 v[32:33], v[32:33], v[120:121] op_sel:[0,0] op_sel_hi:[1,0]
    v_pk_mul_f32 v[34:35], v[34:35], v[120:121] op_sel:[0,0] op_sel_hi:[1,0]
    v_pk_mul_f32 v[36:37], v[36:37], v[120:121] op_sel:[0,0] op_sel_hi:[1,0]
    v_pk_mul_f32 v[38:39], v[38:39], v[120:121] op_sel:[0,0] op_sel_hi:[1,0]
    v_cvt_pk_bf16_f32 v88, v32, v33
    v_cvt_pk_bf16_f32 v89, v34, v35
    v_cvt_pk_bf16_f32 v90, v36, v37
    v_cvt_pk_bf16_f32 v91, v38, v39
    buffer_store_dwordx4 v[88:91], v1, s[52:55], s90 offen sc1
    v_pk_mul_f32 v[40:41], v[40:41], v[120:121] op_sel:[0,0] op_sel_hi:[1,0]
    v_pk_mul_f32 v[42:43], v[42:43], v[120:121] op_sel:[0,0] op_sel_hi:[1,0]
    v_pk_mul_f32 v[44:45], v[44:45], v[120:121] op_sel:[0,0] op_sel_hi:[1,0]
    v_pk_mul_f32 v[46:47], v[46:47], v[120:121] op_sel:[0,0] op_sel_hi:[1,0]
    v_cvt_pk_bf16_f32 v92, v40, v41
    v_cvt_pk_bf16_f32 v93, v42, v43
    v_cvt_pk_bf16_f32 v94, v44, v45
    v_cvt_pk_bf16_f32 v95, v46, v47
    s_mov_b64 exec, s[82:83]
    buffer_store_dwordx4 v[92:95], v1, s[52:55], s90 offen offset:1024 sc1
    s_mov_b64 exec, s[80:81]
    buffer_store_dwordx2 v[92:93], v5, s[52:55], s91 offen offset:1536 sc1
    s_mov_b64 exec, -1
    s_waitcnt vmcnt(0)
    s_mov_b32 s101, s56
    s_atomic_add s101, s[64:65], 0 glc
    s_add_u32 m0, s100, 0
    s_add_u32 s90, s3, 1835008
    buffer_load_dwordx4 v1, s[52:55], s90 offen offset:0 sc1 lds
    buffer_load_dwordx4 v1, s[52:55], s90 offen offset:1024 sc1 lds
    buffer_load_dwordx4 v1, s[52:55], s90 offen offset:2048 sc1 lds
    buffer_load_dwordx4 v1, s[52:55], s90 offen offset:3072 sc1 lds
    s_add_u32 m0, s100, 4096
    s_add_u32 s90, s3, 1839104
    buffer_load_dwordx4 v1, s[52:55], s90 offen offset:0 sc1 lds
    buffer_load_dwordx4 v1, s[52:55], s90 offen offset:1024 sc1 lds
    buffer_load_dwordx4 v1, s[52:55], s90 offen offset:2048 sc1 lds
    s_add_u32 m0, s100, 28672
    s_add_u32 s90, s3, 1863680
    buffer_load_dwordx4 v1, s[52:55], s90 offen offset:0 sc1 lds
    buffer_load_dwordx4 v1, s[52:55], s90 offen offset:1024 sc1 lds
    buffer_load_dwordx4 v1, s[52:55], s90 offen offset:2048 sc1 lds
    buffer_load_dwordx4 v1, s[52:55], s90 offen offset:3072 sc1 lds
    s_add_u32 m0, s100, 32768
    s_add_u32 s90, s3, 1867776
    buffer_load_dwordx4 v1, s[52:55], s90 offen offset:0 sc1 lds
    buffer_load_dwordx4 v1, s[52:55], s90 offen offset:1024 sc1 lds
    buffer_load_dwordx4 v1, s[52:55], s90 offen offset:2048 sc1 lds
    s_add_u32 s72, s68, 9437184
    s_xor_b32 s73, s72, 4096
    s_xor_b32 s74, s72, 8192
    s_xor_b32 s75, s72, 12288
    s_xor_b32 s76, s72, 16384
    s_xor_b32 s77, s72, 20480
    s_xor_b32 s78, s72, 24576
    s_xor_b32 s79, s72, 28672
    ds_read_b128 a[128:131], v2 offset:28672
    ds_read_b128 a[132:135], v2 offset:29696
    ds_read_b128 a[136:139], v2 offset:30720
    ds_read_b128 a[140:143], v2 offset:31744
    ds_read_b128 a[144:147], v2 offset:32768
    s_waitcnt lgkmcnt(0)
    s_add_u32 s101, s101, s56
    s_waitcnt lgkmcnt(0)
    s_add_u32 s89, s101, 0x6c6c6c6c
    s_and_b32 s89, s89, 0x80808080
    s_cmp_eq_u32 s89, 0x80808080
    s_cbranch_scc1 L_go_20
L_poll_19:
    s_mov_b32 s101, 0
    s_atomic_add s101, s[64:65], 0 glc
    s_sub_u32 s63, s63, 1
    s_cbranch_scc1 L_go_20_to
    s_waitcnt lgkmcnt(0)
    s_add_u32 s89, s101, 0x6c6c6c6c
    s_and_b32 s89, s89, 0x80808080
    s_cmp_eq_u32 s89, 0x80808080
    s_cbranch_scc0 L_poll_19
    s_branch L_go_20
L_go_20_to:
    s_mov_b32 s63, 0
    s_waitcnt lgkmcnt(0)
L_go_20:
    buffer_load_dwordx4 v[128:131], v1, s[52:55], s72 offen offset:0 sc1
    buffer_load_dwordx4 v[132:135], v1, s[52:55], s72 offen offset:2048 sc1
    buffer_load_dwordx4 v[136:139], v1, s[52:55], s73 offen offset:0 sc1
    buffer_load_dwordx4 v[140:143], v1, s[52:55], s73 offen offset:2048 sc1
    buffer_load_dwordx4 v[144:147], v10, s[52:55], s72 offen offset:1024 sc1
    buffer_load_dwordx4 v[148:151], v10, s[52:55], s73 offen offset:1024 sc1
    buffer_load_dwordx2 v[154:155], v5, s[52:55], s72 offen offset:1536 sc1
    buffer_load_dwordx2 v[156:157], v5, s[52:55], s72 offen offset:3584 sc1
    buffer_load_dwordx2 v[186:187], v5, s[52:55], s74 offen offset:1536 sc1
    buffer_load_dwordx2 v[188:189], v5, s[52:55], s74 offen offset:3584 sc1
    buffer_load_dwordx2 v[218:219], v5, s[52:55], s76 offen offset:1536 sc1
    buffer_load_dwordx2 v[220:221], v5, s[52:55], s76 offen offset:3584 sc1
    buffer_load_dwordx2 v[250:251], v5, s[52:55], s78 offen offset:1536 sc1
    buffer_load_dwordx2 v[252:253], v5, s[52:55], s78 offen offset:3584 sc1
    s_waitcnt vmcnt(13)
    v_mfma_f32_32x32x16_bf16 v[16:31], a[128:131], v[128:131], v[16:31]
    ds_read_b128 a[148:151], v2 offset:33792
    buffer_load_dwordx4 v[160:163], v1, s[52:55], s74 offen offset:0 sc1
    buffer_load_dwordx4 v[164:167], v1, s[52:55], s74 offen offset:2048 sc1
    s_waitcnt vmcnt(14)
    v_mfma_f32_32x32x16_bf16 v[16:31], a[132:135], v[132:135], v[16:31]
    ds_read_b128 a[152:155], v2 offset:34816
    buffer_load_dwordx4 v[168:171], v1, s[52:55], s75 offen offset:0 sc1
    buffer_load_dwordx4 v[172:175], v1, s[52:55], s75 offen offset:2048 sc1
    s_waitcnt vmcnt(15)
    v_mfma_f32_32x32x16_bf16 v[16:31], a[136:139], v[136:139], v[16:31]
    ds_read_b128 a[156:159], v2 offset:41984
    buffer_load_dwordx4 v[176:179], v10, s[52:55], s74 offen offset:1024 sc1
    s_waitcnt vmcnt(15)
    v_mfma_f32_32x32x16_bf16 v[16:31], a[140:143], v[140:143], v[16:31]
    ds_read_b128 a[128:131], v2 offset:49152
    buffer_load_dwordx4 v[180:183], v10, s[52:55], s75 offen offset:1024 sc1
    s_waitcnt vmcnt(15)
    v_mfma_f32_32x32x16_bf16 v[16:31], a[144:147], v[144:147], v[16:31]
    ds_read_b128 a[132:135], v2 offset:56320
    buffer_load_dwordx4 v[192:195], v1, s[52:55], s76 offen offset:0 sc1
    s_waitcnt vmcnt(15) lgkmcnt(4)
    v_mfma_f32_32x32x16_bf16 v[16:31], a[148:151], v[148:151], v[16:31]
    ds_read_b128 a[136:139], v2 offset:35840
    buffer_load_dwordx4 v[196:199], v1, s[52:55], s76 offen offset:2048 sc1
    s_waitcnt vmcnt(14) lgkmcnt(4)
    v_mfma_f32_32x32x16_bf16 v[16:31], a[152:155], v[154:157], v[16:31]
    ds_read_b128 a[140:143], v2 offset:36864
    buffer_load_dwordx4 v[200:203], v1, s[52:55], s77 offen offset:0 sc1
    s_waitcnt vmcnt(13) lgkmcnt(4)
    v_mfma_f32_32x32x16_bf16 v[16:31], a[156:159], v[186:189], v[16:31]
    ds_read_b128 a[144:147], v2 offset:37888
    buffer_load_dwordx4 v[204:207], v1, s[52:55], s77 offen offset:2048 sc1
    s_waitcnt vmcnt(12) lgkmcnt(4)
    v_mfma_f32_32x32x16_bf16 v[16:31], a[128:131], v[218:221], v[16:31]
    ds_read_b128 a[148:151], v2 offset:38912
    buffer_load_dwordx4 v[208:211], v10, s[52:55], s76 offen offset:1024 sc1
    s_waitcnt vmcnt(11) lgkmcnt(4)
    v_mfma_f32_32x32x16_bf16 v[16:31], a[132:135], v[250:253], v[16:31]
    ds_read_b128 a[152:155], v2 offset:39936
    buffer_load_dwordx4 v[212:215], v10, s[52:55], s77 offen offset:1024 sc1
    s_waitcnt vmcnt(11) lgkmcnt(4)
    v_mfma_f32_32x32x16_bf16 v[16:31], a[136:139], v[160:163], v[16:31]
    ds_read_b128 a[156:159], v2 offset:40960
    buffer_load_dwordx4 v[224:227], v1, s[52:55], s78 offen offset:0 sc1
    s_waitcnt vmcnt(11) lgkmcnt(4)
    v_mfma_f32_32x32x16_bf16 v[16:31], a[140:143], v[164:167], v[16:31]
    ds_read_b128 a[128:131], v2 offset:43008
    buffer_load_dwordx4 v[228:231], v1, s[52:55], s78 offen offset:2048 sc1
    s_waitcnt vmcnt(11) lgkmcnt(4)
    v_mfma_f32_32x32x16_bf16 v[16:31], a[144:147], v[168:171], v[16:31]
    ds_read_b128 a[132:135], v2 offset:44032
    buffer_load_dwordx4 v[232:235], v1, s[52:55], s79 offen offset:0 sc1
    s_waitcnt vmcnt(11) lgkmcnt(4)
    v_mfma_f32_32x32x16_bf16 v[16:31], a[148:151], v[172:175], v[16:31]
    ds_read_b128 a[136:139], v2 offset:45056
    buffer_load_dwordx4 v[236:239], v1, s[52:55], s79 offen offset:2048 sc1
    s_waitcnt vmcnt(11) lgkmcnt(4)
    v_mfma_f32_32x32x16_bf16 v[16:31], a[152:155], v[176:179], v[16:31]
    ds_read_b128 a[140:143], v2 offset:46080
    buffer_load_dwordx4 v[240:243], v10, s[52:55], s78 offen offset:1024 sc1
    s_waitcnt vmcnt(11) lgkmcnt(4)
    v_mfma_f32_32x32x16_bf16 v[16:31], a[156:159], v[180:183], v[16:31]
    ds_read_b128 a[144:147], v2 offset:47104
    buffer_load_dwordx4 v[244:247], v10, s[52:55], s79 offen offset:1024 sc1
    s_waitcnt vmcnt(11) lgkmcnt(4)
    v_mfma_f32_32x32x16_bf16 v[16:31], a[128:131], v[192:195], v[16:31]
    ds_read_b128 a[148:151], v2 offset:48128
    s_waitcnt vmcnt(10) lgkmcnt(4)
    v_mfma_f32_32x32x16_bf16 v[16:31], a[132:135], v[196:199], v[16:31]
    ds_read_b128 a[152:155], v2 offset:50176
    s_waitcnt vmcnt(9) lgkmcnt(4)
    v_mfma_f32_32x32x16_bf16 v[16:31], a[136:139], v[200:203], v[16:31]
    ds_read_b128 a[156:159], v2 offset:51200
    s_waitcnt vmcnt(8) lgkmcnt(4)
    v_mfma_f32_32x32x16_bf16 v[16:31], a[140:143], v[204:207], v[16:31]
    ds_read_b128 a[128:131], v2 offset:52224
    s_waitcnt vmcnt(7) lgkmcnt(4)
    v_mfma_f32_32x32x16_bf16 v[16:31], a[144:147], v[208:211], v[16:31]
    ds_read_b128 a[132:135], v2 offset:53248
    s_waitcnt vmcnt(6) lgkmcnt(4)
    v_mfma_f32_32x32x16_bf16 v[16:31], a[148:151], v[212:215], v[16:31]
    ds_read_b128 a[136:139], v2 offset:54272
    s_waitcnt vmcnt(5) lgkmcnt(4)
    v_mfma_f32_32x32x16_bf16 v[16:31], a[152:155], v[224:227], v[16:31]
    ds_read_b128 a[140:143], v2 offset:55296
    s_waitcnt vmcnt(4) lgkmcnt(4)
    v_mfma_f32_32x32x16_bf16 v[16:31], a[156:159], v[228:231], v[16:31]
    s_waitcnt vmcnt(3) lgkmcnt(3)
    v_mfma_f32_32x32x16_bf16 v[16:31], a[128:131], v[232:235], v[16:31]
    s_waitcnt vmcnt(2) lgkmcnt(2)
    v_mfma_f32_32x32x16_bf16 v[16:31], a[132:135], v[236:239], v[16:31]
    s_waitcnt vmcnt(1) lgkmcnt(1)
    v_mfma_f32_32x32x16_bf16 v[16:31], a[136:139], v[240:243], v[16:31]
    s_waitcnt vmcnt(0) lgkmcnt(0)
    v_mfma_f32_32x32x16_bf16 v[16:31], a[140:143], v[244:247], v[16:31]
    s_add_u32 s90, s69, 11534336
    s_nop 10
    v_cvt_pk_bf16_f32 v88, v16, v17
    v_cvt_pk_bf16_f32 v89, v18, v19
    v_cvt_pk_bf16_f32 v90, v20, v21
    v_cvt_pk_bf16_f32 v91, v22, v23
    buffer_store_dwordx4 v[88:91], v1, s[52:55], s90 offen sc1
    v_pk_add_f32 v[104:105], v[16:17], v[18:19]
    v_pk_mul_f32 v[106:107], v[16:17], v[16:17]
    v_pk_fma_f32 v[106:107], v[18:19], v[18:19], v[106:107]
    v_pk_add_f32 v[104:105], v[104:105], v[20:21]
    v_pk_fma_f32 v[106:107], v[20:21], v[20:21], v[106:107]
    v_pk_add_f32 v[104:105], v[104:105], v[22:23]
    v_pk_fma_f32 v[106:107], v[22:23], v[22:23], v[106:107]
    v_pk_add_f32 v[104:105], v[104:105], v[24:25]
    v_pk_fma_f32 v[106:107], v[24:25], v[24:25], v[106:107]
    v_pk_add_f32 v[104:105], v[104:105], v[26:27]
    v_pk_fma_f32 v[106:107], v[26:27], v[26:27], v[106:107]
    s_mov_b64 exec, s[82:83]
    v_pk_add_f32 v[104:105], v[104:105], v[28:29]
    v_pk_fma_f32 v[106:107], v[28:29], v[28:29], v[106:107]
    v_pk_add_f32 v[104:105], v[104:105], v[30:31]
    v_pk_fma_f32 v[106:107], v[30:31], v[30:31], v[106:107]
    s_mov_b64 exec, -1
    v_add_f32 v104, v104, v105
    v_add_f32 v106, v106, v107
    v_cvt_pk_bf16_f32 v92, v24, v25
    v_cvt_pk_bf16_f32 v93, v26, v27
    v_cvt_pk_bf16_f32 v94, v28, v29
    v_cvt_pk_bf16_f32 v95, v30, v31
    v_permlane32_swap_b32 v105, v104
    v_permlane32_swap_b32 v107, v106
    s_mov_b64 exec, s[80:81]
    v_add_f32 v94, v104, v105
    v_add_f32 v95, v106, v107
    s_mov_b64 exec, s[86:87]
    v_swap_b32 v92, v94
    v_swap_b32 v93, v95
    s_mov_b64 exec, -1
    buffer_store_dwordx4 v[92:95], v1, s[52:55], s90 offen offset:1024 sc1
    s_waitcnt vmcnt(0)
    s_mov_b32 s101, s56
    s_atomic_add s101, s[64:65], 0 glc
    s_add_u32 m0, s100, 57344
    s_add_u32 s90, s3, 1892352
    buffer_load_dwordx4 v1, s[52:55], s90 offen offset:0 sc1 lds
    buffer_load_dwordx4 v1, s[52:55], s90 offen offset:1024 sc1 lds
    buffer_load_dwordx4 v1, s[52:55], s90 offen offset:2048 sc1 lds
    buffer_load_dwordx4 v1, s[52:55], s90 offen offset:3072 sc1 lds
    s_add_u32 m0, s100, 61440
    s_add_u32 s90, s3, 1896448
    buffer_load_dwordx4 v1, s[52:55], s90 offen offset:0 sc1 lds
    buffer_load_dwordx4 v1, s[52:55], s90 offen offset:1024 sc1 lds
    buffer_load_dwordx4 v1, s[52:55], s90 offen offset:2048 sc1 lds
    s_barrier
    s_add_u32 m0, s100, 86016
    s_add_u32 s90, s3, 1921024
    buffer_load_dwordx4 v1, s[52:55], s90 offen offset:0 sc1 lds
    buffer_load_dwordx4 v1, s[52:55], s90 offen offset:1024 sc1 lds
    buffer_load_dwordx4 v1, s[52:55], s90 offen offset:2048 sc1 lds
    buffer_load_dwordx4 v1, s[52:55], s90 offen offset:3072 sc1 lds
    s_add_u32 m0, s100, 90112
    s_add_u32 s90, s3, 1925120
    buffer_load_dwordx4 v1, s[52:55], s90 offen offset:0 sc1 lds
    buffer_load_dwordx4 v1, s[52:55], s90 offen offset:1024 sc1 lds
    buffer_load_dwordx4 v1, s[52:55], s90 offen offset:2048 sc1 lds
    s_add_u32 s72, s68, 11534336
    s_xor_b32 s73, s72, 4096
    s_xor_b32 s74, s72, 8192
    s_xor_b32 s75, s72, 12288
    s_xor_b32 s76, s72, 16384
    s_xor_b32 s77, s72, 20480
    s_xor_b32 s78, s72, 24576
    s_xor_b32 s79, s72, 28672
    ds_read_b128 a[128:131], v1 offset:0
    ds_read_b128 a[132:135], v1 offset:28672
    ds_read_b128 a[136:139], v1 offset:1024
    ds_read_b128 a[140:143], v1 offset:29696
    ds_read_b128 a[144:147], v1 offset:2048
    ds_read_b128 a[148:151], v1 offset:30720
    s_waitcnt lgkmcnt(0)
    s_add_u32 s101, s101, s56
    s_waitcnt lgkmcnt(0)
    s_add_u32 s89, s101, 0x68686868
    s_and_b32 s89, s89, 0x80808080
    s_cmp_eq_u32 s89, 0x80808080
    s_cbranch_scc1 L_go_22
L_poll_21:
    s_mov_b32 s101, 0
    s_atomic_add s101, s[64:65], 0 glc
    s_sub_u32 s63, s63, 1
    s_cbranch_scc1 L_go_22_to
    s_waitcnt lgkmcnt(0)
    s_add_u32 s89, s101, 0x68686868
    s_and_b32 s89, s89, 0x80808080
    s_cmp_eq_u32 s89, 0x80808080
    s_cbranch_scc0 L_poll_21
    s_branch L_go_22
L_go_22_to:
    s_mov_b32 s63, 0
    s_waitcnt lgkmcnt(0)
L_go_22:
    buffer_load_dwordx4 v[128:131], v1, s[52:55], s72 offen offset:0 sc1
    buffer_load_dwordx4 v[132:135], v1, s[52:55], s72 offen offset:2048 sc1
    buffer_load_dwordx4 v[136:139], v1, s[52:55], s73 offen offset:0 sc1
    buffer_load_dwordx4 v[140:143], v1, s[52:55], s73 offen offset:2048 sc1
    buffer_load_dwordx4 v[144:147], v10, s[52:55], s72 offen offset:1024 sc1
    buffer_load_dwordx4 v[148:151], v10, s[52:55], s73 offen offset:1024 sc1
    buffer_load_dwordx4 v[152:155], v11, s[52:55], s72 offen offset:1536 sc1
    buffer_load_dwordx4 v[156:159], v11, s[52:55], s72 offen offset:3584 sc1
    buffer_load_dwordx4 v[184:187], v11, s[52:55], s74 offen offset:1536 sc1
    buffer_load_dwordx4 v[188:191], v11, s[52:55], s74 offen offset:3584 sc1
    s_waitcnt vmcnt(9)
    v_mfma_f32_32x32x16_bf16 v[32:47], a[128:131], v[128:131], 0
    ds_read_b128 a[152:155], v1 offset:3072
    ds_read_b128 a[156:159], v1 offset:31744
    buffer_load_dwordx4 v[216:219], v11, s[52:55], s76 offen offset:1536 sc1
    buffer_load_dwordx4 v[220:223], v11, s[52:55], s76 offen offset:3584 sc1
    v_mfma_f32_32x32x16_bf16 v[48:63], v[128:131], a[132:135], 0
    s_waitcnt vmcnt(10)
    v_mfma_f32_32x32x16_bf16 v[32:47], a[136:139], v[132:135], v[32:47]
    ds_read_b128 a[128:131], v1 offset:4096
    ds_read_b128 a[132:135], v1 offset:32768
    buffer_load_dwordx4 v[248:251], v11, s[52:55], s78 offen offset:1536 sc1
    buffer_load_dwordx4 v[252:255], v11, s[52:55], s78 offen offset:3584 sc1
    v_mfma_f32_32x32x16_bf16 v[48:63], v[132:135], a[140:143], v[48:63]
    s_waitcnt vmcnt(11)
    v_mfma_f32_32x32x16_bf16 v[32:47], a[144:147], v[136:139], v[32:47]
    ds_read_b128 a[136:139], v1 offset:5120
    ds_read_b128 a[140:143], v1 offset:33792
    buffer_load_dwordx4 v[160:163], v1, s[52:55], s74 offen offset:0 sc1
    buffer_load_dwordx4 v[164:167], v1, s[52:55], s74 offen offset:2048 sc1
    v_mfma_f32_32x32x16_bf16 v[48:63], v[136:139], a[148:151], v[48:63]
    s_waitcnt vmcnt(12) lgkmcnt(4)
    v_mfma_f32_32x32x16_bf16 v[32:47], a[152:155], v[140:143], v[32:47]
    ds_read_b128 a[144:147], v1 offset:6144
    ds_read_b128 a[148:151], v1 offset:34816
    buffer_load_dwordx4 v[168:171], v1, s[52:55], s75 offen offset:0 sc1
    buffer_load_dwordx4 v[172:175], v1, s[52:55], s75 offen offset:2048 sc1
    v_mfma_f32_32x32x16_bf16 v[48:63], v[140:143], a[156:159], v[48:63]
    s_waitcnt vmcnt(13) lgkmcnt(4)
    v_mfma_f32_32x32x16_bf16 v[32:47], a[128:131], v[144:147], v[32:47]
    ds_read_b128 a[152:155], v1 offset:13312
    ds_read_b128 a[156:159], v1 offset:41984
    buffer_load_dwordx4 v[176:179], v10, s[52:55], s74 offen offset:1024 sc1
    v_mfma_f32_32x32x16_bf16 v[48:63], v[144:147], a[132:135], v[48:63]
    s_waitcnt vmcnt(13) lgkmcnt(4)
    v_mfma_f32_32x32x16_bf16 v[32:47], a[136:139], v[148:151], v[32:47]
    ds_read_b128 a[128:131], v1 offset:20480
    ds_read_b128 a[132:135], v1 offset:49152
    buffer_load_dwordx4 v[180:183], v10, s[52:55], s75 offen offset:1024 sc1
    v_mfma_f32_32x32x16_bf16 v[48:63], v[148:151], a[140:143], v[48:63]
    s_waitcnt vmcnt(12) lgkmcnt(4)
    v_mfma_f32_32x32x16_bf16 v[32:47], a[144:147], v[154:157], v[32:47]
    ds_read_b128 a[136:139], v1 offset:27648
    ds_read_b128 a[140:143], v1 offset:56320
    buffer_load_dwordx4 v[192:195], v1, s[52:55], s76 offen offset:0 sc1
    v_mfma_f32_32x32x16_bf16 v[48:63], v[154:157], a[148:151], v[48:63]
    s_waitcnt vmcnt(11) lgkmcnt(4)
    v_mfma_f32_32x32x16_bf16 v[32:47], a[152:155], v[186:189], v[32:47]
    ds_read_b128 a[144:147], v1 offset:7168
    ds_read_b128 a[148:151], v1 offset:35840
    buffer_load_dwordx4 v[196:199], v1, s[52:55], s76 offen offset:2048 sc1
    v_mfma_f32_32x32x16_bf16 v[48:63], v[186:189], a[156:159], v[48:63]
    s_waitcnt vmcnt(10) lgkmcnt(4)
    v_mfma_f32_32x32x16_bf16 v[32:47], a[128:131], v[218:221], v[32:47]
    ds_read_b128 a[152:155], v1 offset:8192
    ds_read_b128 a[156:159], v1 offset:36864
    buffer_load_dwordx4 v[200:203], v1, s[52:55], s77 offen offset:0 sc1
    v_mfma_f32_32x32x16_bf16 v[48:63], v[218:221], a[132:135], v[48:63]
    s_waitcnt vmcnt(9) lgkmcnt(4)
    v_mfma_f32_32x32x16_bf16 v[32:47], a[136:139], v[250:253], v[32:47]
    ds_read_b128 a[128:131], v1 offset:9216
    ds_read_b128 a[132:135], v1 offset:37888
    buffer_load_dwordx4 v[204:207], v1, s[52:55], s77 offen offset:2048 sc1
    v_mfma_f32_32x32x16_bf16 v[48:63], v[250:253], a[140:143], v[48:63]
    s_waitcnt vmcnt(9) lgkmcnt(4)
    v_mfma_f32_32x32x16_bf16 v[32:47], a[144:147], v[160:163], v[32:47]
    ds_read_b128 a[136:139], v1 offset:10240
    ds_read_b128 a[140:143], v1 offset:38912
    buffer_load_dwordx4 v[208:211], v10, s[52:55], s76 offen offset:1024 sc1
    v_add_f32 v120, v152, v158
    v_add_f32 v121, v153, v159
    v_mfma_f32_32x32x16_bf16 v[48:63], v[160:163], a[148:151], v[48:63]
    v_add_f32 v120, v120, v184
    v_add_f32 v121, v121, v185
    s_waitcnt vmcnt(9) lgkmcnt(4)
    v_mfma_f32_32x32x16_bf16 v[32:47], a[152:155], v[164:167], v[32:47]
    ds_read_b128 a[144:147], v1 offset:11264
    ds_read_b128 a[148:151], v1 offset:39936
    buffer_load_dwordx4 v[212:215], v10, s[52:55], s77 offen offset:1024 sc1
    v_add_f32 v120, v120, v190
    v_add_f32 v121, v121, v191
    v_mfma_f32_32x32x16_bf16 v[48:63], v[164:167], a[156:159], v[48:63]
    v_add_f32 v120, v120, v216
    v_add_f32 v121, v121, v217
    s_waitcnt vmcnt(9) lgkmcnt(4)
    v_mfma_f32_32x32x16_bf16 v[32:47], a[128:131], v[168:171], v[32:47]
    ds_read_b128 a[152:155], v1 offset:12288
    ds_read_b128 a[156:159], v1 offset:40960
    buffer_load_dwordx4 v[224:227], v1, s[52:55], s78 offen offset:0 sc1
    v_add_f32 v120, v120, v222
    v_add_f32 v121, v121, v223
    v_mfma_f32_32x32x16_bf16 v[48:63], v[168:171], a[132:135], v[48:63]
    v_add_f32 v120, v120, v248
    v_add_f32 v121, v121, v249
    s_waitcnt vmcnt(9) lgkmcnt(4)
    v_mfma_f32_32x32x16_bf16 v[32:47], a[136:139], v[172:175], v[32:47]
    ds_read_b128 a[128:131], v1 offset:14336
    ds_read_b128 a[132:135], v1 offset:43008
    buffer_load_dwordx4 v[228:231], v1, s[52:55], s78 offen offset:2048 sc1
    v_add_f32 v120, v120, v254
    v_add_f32 v121, v121, v255
    v_mfma_f32_32x32x16_bf16 v[48:63], v[172:175], a[140:143], v[48:63]
    v_mov_b32 v122, v120
    s_nop 1
    v_permlane32_swap_b32 v122, v120
    s_waitcnt vmcnt(9) lgkmcnt(4)
    v_mfma_f32_32x32x16_bf16 v[32:47], a[144:147], v[176:179], v[32:47]
    ds_read_b128 a[136:139], v1 offset:15360
    ds_read_b128 a[140:143], v1 offset:44032
    buffer_load_dwordx4 v[232:235], v1, s[52:55], s79 offen offset:0 sc1
    v_add_f32 v120, v120, v122
    v_mov_b32 v122, v121
    v_mfma_f32_32x32x16_bf16 v[48:63], v[176:179], a[148:151], v[48:63]
    s_nop 0
    v_permlane32_swap_b32 v122, v121
    v_add_f32 v121, v121, v122
    s_waitcnt vmcnt(9) lgkmcnt(4)
    v_mfma_f32_32x32x16_bf16 v[32:47], a[152:155], v[180:183], v[32:47]
    ds_read_b128 a[144:147], v1 offset:16384
    ds_read_b128 a[148:151], v1 offset:45056
    buffer_load_dwordx4 v[236:239], v1, s[52:55], s79 offen offset:2048 sc1
    v_mul_f32 v120, 0xbb124925, v120
    v_mul_f32 v121, 0x3b124925, v121
    v_mfma_f32_32x32x16_bf16 v[48:63], v[180:183], a[156:159], v[48:63]
    v_fma_f32 v121, -v120, v120, v121
    v_max_f32 v121, 0, v121
    s_waitcnt vmcnt(9) lgkmcnt(4)
    v_mfma_f32_32x32x16_bf16 v[32:47], a[128:131], v[192:195], v[32:47]
    ds_read_b128 a[152:155], v1 offset:17408
    ds_read_b128 a[156:159], v1 offset:46080
    buffer_load_dwordx4 v[240:243], v10, s[52:55], s78 offen offset:1024 sc1
    v_add_f32 v121, 0x3727c5ac, v121
    v_rsq_f32 v124, v121
    v_mfma_f32_32x32x16_bf16 v[48:63], v[192:195], a[132:135], v[48:63]
    v_cndmask_b32 v120, v120, 0, s[80:81]
    v_cvt_pk_bf16_f32 v127, v120, 0
    s_waitcnt vmcnt(9) lgkmcnt(4)
    v_mfma_f32_32x32x16_bf16 v[32:47], a[136:139], v[196:199], v[32:47]
    ds_read_b128 a[128:131], v1 offset:18432
    ds_read_b128 a[132:135], v1 offset:47104
    buffer_load_dwordx4 v[244:247], v10, s[52:55], s79 offen offset:1024 sc1
    v_lshlrev_b32 v122, 16, v127
    v_sub_f32 v122, v120, v122
    v_mfma_f32_32x32x16_bf16 v[48:63], v[196:199], a[140:143], v[48:63]
    v_cvt_pk_bf16_f32 v126, v120, v122
    s_nop 1
    v_mfma_f32_32x32x8_bf16 v[32:47], a[166:167], v[126:127], v[32:47]
    s_waitcnt vmcnt(9) lgkmcnt(4)
    v_mfma_f32_32x32x16_bf16 v[32:47], a[144:147], v[200:203], v[32:47]
    ds_read_b128 a[136:139], v1 offset:19456
    ds_read_b128 a[140:143], v1 offset:48128
    v_mfma_f32_32x32x8_bf16 v[48:63], v[126:127], a[168:169], v[48:63]
    v_and_b32 v122, 31, v0
    v_mfma_f32_32x32x16_bf16 v[48:63], v[200:203], a[148:151], v[48:63]
    s_lshl_b32 s90, s62, 7
    s_add_u32 s90, s90, 161280
    v_lshl_add_u32 v122, v122, 2, s90
    s_waitcnt vmcnt(8) lgkmcnt(4)
    v_mfma_f32_32x32x16_bf16 v[32:47], a[152:155], v[204:207], v[32:47]
    ds_read_b128 a[144:147], v1 offset:21504
    ds_read_b128 a[148:151], v1 offset:50176
    ds_write_b32 v122, v124
    v_lshrrev_b32 v122, 5, v0
    v_mfma_f32_32x32x16_bf16 v[48:63], v[204:207], a[156:159], v[48:63]
    v_lshl_add_u32 v122, v122, 4, s90
    ds_read_b128 v[104:107], v122 offset:0
    s_waitcnt vmcnt(7) lgkmcnt(6)
    v_mfma_f32_32x32x16_bf16 v[32:47], a[128:131], v[208:211], v[32:47]
    ds_read_b128 a[152:155], v1 offset:22528
    ds_read_b128 a[156:159], v1 offset:51200
    ds_read_b128 v[108:111], v122 offset:32
    ds_read_b128 v[112:115], v122 offset:64
    v_mfma_f32_32x32x16_bf16 v[48:63], v[208:211], a[132:135], v[48:63]
    ds_read_b128 v[116:119], v122 offset:96
    v_and_b32 v123, 31, v0
    s_waitcnt vmcnt(6) lgkmcnt(9)
    v_mfma_f32_32x32x16_bf16 v[32:47], a[136:139], v[212:215], v[32:47]
    ds_read_b128 a[128:131], v1 offset:23552
    ds_read_b128 a[132:135], v1 offset:52224
    v_cmp_eq_u32 s[98:99], 28, v123
    v_mov_b32 v123, 0x3f803f80
    v_mfma_f32_32x32x16_bf16 v[48:63], v[212:215], a[140:143], v[48:63]
    v_cndmask_b32 v123, 0, v123, s[98:99]
    s_waitcnt vmcnt(5) lgkmcnt(9)
    v_mfma_f32_32x32x16_bf16 v[32:47], a[144:147], v[224:227], v[32:47]
    ds_read_b128 a[136:139], v1 offset:24576
    ds_read_b128 a[140:143], v1 offset:53248
    v_mfma_f32_32x32x16_bf16 v[48:63], v[224:227], a[148:151], v[48:63]
    s_waitcnt vmcnt(4) lgkmcnt(7)
    v_mfma_f32_32x32x16_bf16 v[32:47], a[152:155], v[228:231], v[32:47]
    ds_read_b128 a[144:147], v1 offset:25600
    ds_read_b128 a[148:151], v1 offset:54272
    v_mfma_f32_32x32x16_bf16 v[48:63], v[228:231], a[156:159], v[48:63]
    s_waitcnt vmcnt(3) lgkmcnt(5)
    v_mfma_f32_32x32x16_bf16 v[32:47], a[128:131], v[232:235], v[32:47]
    ds_read_b128 a[152:155], v1 offset:26624
    ds_read_b128 a[156:159], v1 offset:55296
    s_waitcnt vmcnt(2) lgkmcnt(5)
    v_mfma_f32_32x32x16_bf16 v[32:47], a[136:139], v[236:239], v[32:47]
    s_waitcnt vmcnt(1) lgkmcnt(3)
    v_mfma_f32_32x32x16_bf16 v[32:47], a[144:147], v[240:243], v[32:47]
    s_waitcnt vmcnt(0) lgkmcnt(1)
    v_mfma_f32_32x32x16_bf16 v[32:47], a[152:155], v[244:247], v[32:47]
    v_mfma_f32_32x32x16_bf16 v[48:63], v[232:235], a[132:135], v[48:63]
    v_mfma_f32_32x32x16_bf16 v[48:63], v[236:239], a[140:143], v[48:63]
    s_nop 7
    v_mfma_f32_32x32x16_bf16 v[48:63], v[240:243], a[148:151], v[48:63]
    s_nop 0
    v_mul_f32 v32, v32, v124
    v_mul_f32 v33, v33, v124
    v_cvt_pk_bf16_f32 v80, v32, v33
    v_mul_f32 v34, v34, v124
    v_mul_f32 v35, v35, v124
    v_cvt_pk_bf16_f32 v81, v34, v35
    s_waitcnt lgkmcnt(0)
    v_mfma_f32_32x32x16_bf16 v[48:63], v[244:247], a[156:159], v[48:63]
    v_mul_f32 v36, v36, v124
    v_mul_f32 v37, v37, v124
    v_cvt_pk_bf16_f32 v82, v36, v37
    v_mul_f32 v38, v38, v124
    v_mul_f32 v39, v39, v124
    v_cvt_pk_bf16_f32 v83, v38, v39
    v_mul_f32 v40, v40, v124
    v_mul_f32 v41, v41, v124
    v_cvt_pk_bf16_f32 v84, v40, v41
    v_mul_f32 v42, v42, v124
    v_mul_f32 v43, v43, v124
    v_cvt_pk_bf16_f32 v85, v42, v43
    v_mul_f32 v44, v44, v124
    v_mul_f32 v45, v45, v124
    v_cvt_pk_bf16_f32 v86, v44, v45
    v_mul_f32 v46, v46, v124
    v_mul_f32 v47, v47, v124
    v_cvt_pk_bf16_f32 v87, v46, v47
    s_mov_b64 exec, s[80:81]
    v_mov_b32 v86, 0x3f803f80
    v_mov_b32 v87, 0x00003f80
    s_mov_b64 exec, -1
    s_lshl_b32 s90, s60, 12
    s_add_u32 s90, s90, s70
    s_add_u32 s90, s90, 19922944
    s_mov_b32 s73, s90
    buffer_store_dwordx4 v[80:83], v1, s[52:55], s90 offen sc1
    buffer_store_dwordx4 v[84:87], v1, s[52:55], s90 offen offset:1024 sc1
    v_pk_mul_f32 v[48:49], v[48:49], v[104:105]
    v_pk_mul_f32 v[50:51], v[50:51], v[106:107]
    v_pk_mul_f32 v[52:53], v[52:53], v[108:109]
    v_pk_mul_f32 v[54:55], v[54:55], v[110:111]
    v_pk_mul_f32 v[56:57], v[56:57], v[112:113]
    v_pk_mul_f32 v[58:59], v[58:59], v[114:115]
    v_pk_mul_f32 v[60:61], v[60:61], v[116:117]
L_page_9:
    s_cbranch_vccnz L_page_ret1
    v_pk_mul_f32 v[62:63], v[62:63], v[118:119]
    v_cvt_pk_bf16_f32 v88, v48, v49
    v_cvt_pk_bf16_f32 v89, v50, v51
    v_cvt_pk_bf16_f32 v90, v52, v53
    v_cvt_pk_bf16_f32 v91, v54, v55
    v_cvt_pk_bf16_f32 v92, v56, v57
    v_cvt_pk_bf16_f32 v93, v58, v59
    v_cvt_pk_bf16_f32 v94, v60, v61
    v_cvt_pk_bf16_f32 v95, v62, v63
    s_mov_b64 exec, s[84:85]
    v_mov_b32 v88, v123
    v_mov_b32 v89, v123
    v_mov_b32 v90, v123
    v_mov_b32 v91, v123
    v_mov_b32 v92, v123
    v_mov_b32 v93, v123
    v_mov_b32 v94, v123
    v_mov_b32 v95, v123
    s_mov_b64 exec, -1
    buffer_store_dwordx4 v[88:91], v1, s[52:55], s90 offen offset:2048 sc1
    buffer_store_dwordx4 v[92:95], v1, s[52:55], s90 offen offset:3072 sc1
    s_barrier
    ds_read_b128 a[128:131], v2 offset:0
    ds_read_b128 a[132:135], v2 offset:1024
    ds_read_b128 a[136:139], v2 offset:2048
    ds_read_b128 a[140:143], v2 offset:3072
    ds_read_b128 a[144:147], v2 offset:4096
    s_waitcnt lgkmcnt(4)
    v_mfma_f32_32x32x16_bf16 v[64:79], a[128:131], v[128:131], 0
    ds_read_b128 a[148:151], v2 offset:5120
    s_lshl_b32 s90, s62, 11
    v_add_u32 v112, s90, v102
    s_waitcnt lgkmcnt(4)
    v_mfma_f32_32x32x16_bf16 v[64:79], a[132:135], v[132:135], v[64:79]
    ds_read_b128 a[152:155], v2 offset:6144
    s_add_u32 s90, s62, 1
    s_and_b32 s90, s90, 3
    s_waitcnt lgkmcnt(4)
    v_mfma_f32_32x32x16_bf16 v[64:79], a[136:139], v[136:139], v[64:79]
    ds_read_b128 a[156:159], v2 offset:13312
    s_lshl_b32 s91, s90, 11
    v_add_u32 v113, s91, v102
    s_waitcnt lgkmcnt(4)
    v_mfma_f32_32x32x16_bf16 v[64:79], a[140:143], v[140:143], v[64:79]
    ds_read_b128 a[128:131], v2 offset:20480
    s_mul_i32 s91, s90, 12288
    v_add_u32 v117, s91, v1
    s_waitcnt lgkmcnt(4)
    v_mfma_f32_32x32x16_bf16 v[64:79], a[144:147], v[144:147], v[64:79]
    ds_read_b128 a[132:135], v2 offset:27648
    s_add_u32 s90, s62, 2
    s_and_b32 s90, s90, 3
    s_waitcnt lgkmcnt(4)
    v_mfma_f32_32x32x16_bf16 v[64:79], a[148:151], v[148:151], v[64:79]
    ds_read_b128 a[136:139], v2 offset:7168
    s_lshl_b32 s91, s90, 11
    v_add_u32 v114, s91, v102
    s_waitcnt lgkmcnt(4)
    v_mfma_f32_32x32x16_bf16 v[64:79], a[152:155], v[154:157], v[64:79]
    ds_read_b128 a[140:143], v2 offset:8192
    s_mul_i32 s91, s90, 12288
    v_add_u32 v118, s91, v1
    s_waitcnt lgkmcnt(4)
    v_mfma_f32_32x32x16_bf16 v[64:79], a[156:159], v[186:189], v[64:79]
    ds_read_b128 a[144:147], v2 offset:9216
    s_add_u32 s90, s62, 3
    s_and_b32 s90, s90, 3
    s_waitcnt lgkmcnt(4)
    v_mfma_f32_32x32x16_bf16 v[64:79], a[128:131], v[218:221], v[64:79]
    ds_read_b128 a[148:151], v2 offset:10240
    s_lshl_b32 s91, s90, 11
    v_add_u32 v115, s91, v102
    s_waitcnt lgkmcnt(4)
    v_mfma_f32_32x32x16_bf16 v[64:79], a[132:135], v[250:253], v[64:79]
    ds_read_b128 a[152:155], v2 offset:11264
    s_mul_i32 s91, s90, 12288
    v_add_u32 v119, s91, v1
    s_waitcnt lgkmcnt(4)
    v_mfma_f32_32x32x16_bf16 v[64:79], a[136:139], v[160:163], v[64:79]
    ds_read_b128 a[156:159], v2 offset:12288
    s_mul_i32 s91, s62, 12288
    v_add_u32 v116, s91, v1
    s_waitcnt lgkmcnt(4)
    v_mfma_f32_32x32x16_bf16 v[64:79], a[140:143], v[164:167], v[64:79]
    ds_read_b128 a[128:131], v2 offset:14336
    s_lshl_b32 s91, s62, 2
    s_add_u32 s91, s91, 161792
    s_waitcnt lgkmcnt(4)
    v_mfma_f32_32x32x16_bf16 v[64:79], a[144:147], v[168:171], v[64:79]
    ds_read_b128 a[132:135], v2 offset:15360
    v_mov_b32 v120, s91
    v_mov_b32 v121, 161792
    s_waitcnt lgkmcnt(4)
    v_mfma_f32_32x32x16_bf16 v[64:79], a[148:151], v[172:175], v[64:79]
    ds_read_b128 a[136:139], v2 offset:16384
    s_add_u32 s92, s70, 19922944
    v_add_u32 v123, s92, v1
    s_waitcnt vmcnt(0)
    s_atomic_add s57, s[66:67], 0
    s_waitcnt lgkmcnt(4)
    v_mfma_f32_32x32x16_bf16 v[64:79], a[152:155], v[176:179], v[64:79]
    ds_read_b128 a[140:143], v2 offset:17408
    s_waitcnt lgkmcnt(4)
    v_mfma_f32_32x32x16_bf16 v[64:79], a[156:159], v[180:183], v[64:79]
    ds_read_b128 a[144:147], v2 offset:18432
    s_waitcnt lgkmcnt(4)
    v_mfma_f32_32x32x16_bf16 v[64:79], a[128:131], v[192:195], v[64:79]
    ds_read_b128 a[148:151], v2 offset:19456
    v_mfma_f32_32x32x8_bf16 v[64:79], a[170:171], v[126:127], v[64:79]
    s_waitcnt lgkmcnt(4)
    v_mfma_f32_32x32x16_bf16 v[64:79], a[132:135], v[196:199], v[64:79]
    ds_read_b128 a[152:155], v2 offset:21504
    s_waitcnt lgkmcnt(4)
    v_mfma_f32_32x32x16_bf16 v[64:79], a[136:139], v[200:203], v[64:79]
    ds_read_b128 a[156:159], v2 offset:22528
    s_waitcnt lgkmcnt(4)
    v_mfma_f32_32x32x16_bf16 v[64:79], a[140:143], v[204:207], v[64:79]
    ds_read_b128 a[128:131], v2 offset:23552
    s_waitcnt lgkmcnt(4)
    v_mfma_f32_32x32x16_bf16 v[64:79], a[144:147], v[208:211], v[64:79]
    ds_read_b128 a[132:135], v2 offset:24576
    s_waitcnt lgkmcnt(4)
    v_mfma_f32_32x32x16_bf16 v[64:79], a[148:151], v[212:215], v[64:79]
    ds_read_b128 a[136:139], v2 offset:25600
    s_waitcnt lgkmcnt(4)
    v_mfma_f32_32x32x16_bf16 v[64:79], a[152:155], v[224:227], v[64:79]
    ds_read_b128 a[140:143], v2 offset:26624
    s_waitcnt lgkmcnt(4)
    v_mfma_f32_32x32x16_bf16 v[64:79], a[156:159], v[228:231], v[64:79]
    s_waitcnt lgkmcnt(3)
    v_mfma_f32_32x32x16_bf16 v[64:79], a[128:131], v[232:235], v[64:79]
    s_waitcnt lgkmcnt(2)
    v_mfma_f32_32x32x16_bf16 v[64:79], a[132:135], v[236:239], v[64:79]
    s_waitcnt lgkmcnt(1)
    v_mfma_f32_32x32x16_bf16 v[64:79], a[136:139], v[240:243], v[64:79]
    s_waitcnt lgkmcnt(0)
    v_mfma_f32_32x32x16_bf16 v[64:79], a[140:143], v[244:247], v[64:79]
    s_mov_b32 s101, 0
    s_atomic_add s101, s[66:67], 0 glc
    v_mul_f32 v122, 0x3e8b97f6, v124
    s_nop 8
    v_pk_mul_f32 v[64:65], v[64:65], v[122:123] op_sel:[0,0] op_sel_hi:[1,0]
    v_pk_mul_f32 v[66:67], v[66:67], v[122:123] op_sel:[0,0] op_sel_hi:[1,0]
    v_pk_mul_f32 v[68:69], v[68:69], v[122:123] op_sel:[0,0] op_sel_hi:[1,0]
    v_pk_mul_f32 v[70:71], v[70:71], v[122:123] op_sel:[0,0] op_sel_hi:[1,0]
    v_pk_mul_f32 v[72:73], v[72:73], v[122:123] op_sel:[0,0] op_sel_hi:[1,0]
    v_pk_mul_f32 v[74:75], v[74:75], v[122:123] op_sel:[0,0] op_sel_hi:[1,0]
    v_pk_mul_f32 v[76:77], v[76:77], v[122:123] op_sel:[0,0] op_sel_hi:[1,0]
    v_pk_mul_f32 v[78:79], v[78:79], v[122:123] op_sel:[0,0] op_sel_hi:[1,0]
    v_cvt_pk_bf16_f32 v104, v64, v65
    v_cvt_pk_bf16_f32 v105, v66, v67
    v_cvt_pk_bf16_f32 v106, v68, v69
    v_cvt_pk_bf16_f32 v107, v70, v71
    v_cvt_pk_bf16_f32 v108, v72, v73
    v_cvt_pk_bf16_f32 v109, v74, v75
    v_cvt_pk_bf16_f32 v110, v76, v77
    v_cvt_pk_bf16_f32 v111, v78, v79
    s_mov_b64 exec, s[80:81]
    v_mov_b32 v110, 0
    v_mov_b32 v111, 0
    s_mov_b64 exec, -1
    v_mfma_f32_32x32x16_bf16 v[32:47], v[80:83], v[104:107], 0
    v_mfma_f32_32x32x16_bf16 v[32:47], v[84:87], v[108:111], v[32:47]
    s_mov_b32 s95, 0
    s_nop 10
    v_max3_f32 v15, v32, v33, v34
    v_max3_f32 v15, v15, v35, v36
    v_max3_f32 v15, v15, v37, v38
    v_max3_f32 v15, v15, v39, v40
    v_max3_f32 v15, v15, v41, v42
    v_max3_f32 v15, v15, v43, v44
    v_max3_f32 v15, v15, v45, v46
    v_max_f32 v15, v15, v47
    v_mov_b32 v72, v15
    s_nop 1
    v_permlane32_swap_b32 v72, v15
    v_max_f32 v15, v15, v72
    s_nop 2
L_attn_23:
    v_cvt_pk_bf16_f32 v72, -v15, 0
    v_lshlrev_b32 v73, 16, v72
    v_sub_f32_e64 v73, -v15, v73
    v_cvt_pk_bf16_f32 v72, -v15, v73
    v_and_b32 v74, 0xffff0000, v72
    v_sub_f32 v73, v73, v74
    s_mov_b64 exec, s[80:81]
    v_mov_b32 v110, v72
    v_cvt_pk_bf16_f32 v111, v73, 0
    s_mov_b64 exec, -1
    ds_write_b128 v112, v[104:107] offset:36864
    ds_write_b128 v112, v[108:111] offset:37888
    s_lshl_b32 s72, s60, 12
    s_xor_b32 s91, s72, 4096
    s_waitcnt lgkmcnt(0)
    s_add_u32 s89, s101, 0x70707070
    s_and_b32 s89, s89, s59
    s_cmp_eq_u32 s89, s59
    s_cbranch_scc1 L_go_25
L_poll_24:
    s_mov_b32 s101, 0
    s_atomic_add s101, s[66:67], 0 glc
    s_sub_u32 s63, s63, 1
    s_cbranch_scc1 L_go_25_to
    s_waitcnt lgkmcnt(0)
    s_add_u32 s89, s101, 0x70707070
    s_and_b32 s89, s89, s59
    s_cmp_eq_u32 s89, s59
    s_cbranch_scc0 L_poll_24
    s_branch L_go_25
L_go_25_to:
    s_mov_b32 s63, 0
    s_waitcnt lgkmcnt(0)
L_go_25:
    buffer_load_dwordx4 a[0:3], v123, s[52:55], s91 offen offset:0 sc1
    buffer_load_dwordx4 a[4:7], v123, s[52:55], s91 offen offset:1024 sc1
    buffer_load_dwordx4 a[8:11], v123, s[52:55], s91 offen offset:2048 sc1
    buffer_load_dwordx4 a[12:15], v123, s[52:55], s91 offen offset:3072 sc1
    s_barrier
    ds_read_b128 a[180:183], v113 offset:36864
    ds_read_b128 a[184:187], v113 offset:37888
    ds_read_b128 a[188:191], v114 offset:36864
    ds_read_b128 a[192:195], v114 offset:37888
    ds_read_b128 a[196:199], v115 offset:36864
    ds_read_b128 a[200:203], v115 offset:37888
    v_mfma_f32_32x32x16_bf16 v[32:47], v[80:83], v[104:107], 0
    v_mfma_f32_32x32x16_bf16 v[32:47], v[84:87], v[108:111], v[32:47]
    s_waitcnt lgkmcnt(5)
    v_mfma_f32_32x32x16_bf16 v[48:63], v[80:83], a[180:183], 0
    s_xor_b32 s91, s72, 8192
    buffer_load_dwordx4 a[16:19], v123, s[52:55], s91 offen offset:0 sc1
    buffer_load_dwordx4 a[20:23], v123, s[52:55], s91 offen offset:1024 sc1
    buffer_load_dwordx4 a[24:27], v123, s[52:55], s91 offen offset:2048 sc1
    buffer_load_dwordx4 a[28:31], v123, s[52:55], s91 offen offset:3072 sc1
    s_nop 4
    v_exp_f32 v32, v32
    v_exp_f32 v33, v33
    v_exp_f32 v34, v34
    v_cvt_pk_bf16_f32 v64, v32, v33
    v_exp_f32 v35, v35
    s_nop 0
    v_cvt_pk_bf16_f32 v65, v34, v35
    v_exp_f32 v36, v36
    v_exp_f32 v37, v37
    v_exp_f32 v38, v38
    v_cvt_pk_bf16_f32 v66, v36, v37
    v_exp_f32 v39, v39
    s_waitcnt lgkmcnt(4)
    v_mfma_f32_32x32x16_bf16 v[48:63], v[84:87], a[184:187], v[48:63]
    s_xor_b32 s91, s72, 12288
    v_cvt_pk_bf16_f32 v67, v38, v39
    v_exp_f32 v40, v40
    v_exp_f32 v41, v41
    v_exp_f32 v42, v42
    v_cvt_pk_bf16_f32 v68, v40, v41
    v_exp_f32 v43, v43
    v_mfma_f32_32x32x16_bf16 v[128:143], v[88:91], v[64:67], 0
    v_cvt_pk_bf16_f32 v69, v42, v43
    v_exp_f32 v44, v44
    v_exp_f32 v45, v45
    v_exp_f32 v46, v46
    v_exp_f32 v47, v47
    v_cvt_pk_bf16_f32 v70, v44, v45
    v_cvt_pk_bf16_f32 v71, v46, v47
    s_waitcnt lgkmcnt(3)
    v_mfma_f32_32x32x16_bf16 v[32:47], v[80:83], a[188:191], 0
    v_exp_f32 v48, v48
    v_exp_f32 v49, v49
    v_exp_f32 v50, v50
    v_cvt_pk_bf16_f32 v64, v48, v49
    v_exp_f32 v51, v51
    v_mfma_f32_32x32x16_bf16 v[128:143], v[92:95], v[68:71], v[128:143]
    v_cvt_pk_bf16_f32 v65, v50, v51
    v_exp_f32 v52, v52
    v_exp_f32 v53, v53
    v_exp_f32 v54, v54
    v_cvt_pk_bf16_f32 v66, v52, v53
    v_exp_f32 v55, v55
    s_waitcnt lgkmcnt(2)
    v_mfma_f32_32x32x16_bf16 v[32:47], v[84:87], a[192:195], v[32:47]
    v_cvt_pk_bf16_f32 v67, v54, v55
    v_exp_f32 v56, v56
    v_exp_f32 v57, v57
    v_exp_f32 v58, v58
    v_cvt_pk_bf16_f32 v68, v56, v57
    v_exp_f32 v59, v59
    v_mfma_f32_32x32x16_bf16 v[144:159], v[88:91], v[64:67], 0
    v_cvt_pk_bf16_f32 v69, v58, v59
    v_exp_f32 v60, v60
    v_exp_f32 v61, v61
    v_exp_f32 v62, v62
    v_exp_f32 v63, v63
    v_cvt_pk_bf16_f32 v70, v60, v61
    v_cvt_pk_bf16_f32 v71, v62, v63
    s_waitcnt lgkmcnt(1)
    v_mfma_f32_32x32x16_bf16 v[48:63], v[80:83], a[196:199], 0
    buffer_load_dwordx4 a[32:35], v123, s[52:55], s91 offen offset:0 sc1
    buffer_load_dwordx4 a[36:39], v123, s[52:55], s91 offen offset:1024 sc1
    buffer_load_dwordx4 a[40:43], v123, s[52:55], s91 offen offset:2048 sc1
    buffer_load_dwordx4 a[44:47], v123, s[52:55], s91 offen offset:3072 sc1
    v_exp_f32 v32, v32
    v_exp_f32 v33, v33
    v_exp_f32 v34, v34
    v_cvt_pk_bf16_f32 v64, v32, v33
    v_exp_f32 v35, v35
    v_mfma_f32_32x32x16_bf16 v[144:159], v[92:95], v[68:71], v[144:159]
    v_cvt_pk_bf16_f32 v65, v34, v35
    v_exp_f32 v36, v36
    v_exp_f32 v37, v37
    v_exp_f32 v38, v38
    v_cvt_pk_bf16_f32 v66, v36, v37
    v_exp_f32 v39, v39
    s_waitcnt lgkmcnt(0)
    v_mfma_f32_32x32x16_bf16 v[48:63], v[84:87], a[200:203], v[48:63]
    s_xor_b32 s91, s72, 16384
    v_cvt_pk_bf16_f32 v67, v38, v39
    v_exp_f32 v40, v40
    v_exp_f32 v41, v41
    v_exp_f32 v42, v42
    v_cvt_pk_bf16_f32 v68, v40, v41
    v_exp_f32 v43, v43
    v_mfma_f32_32x32x16_bf16 v[160:175], v[88:91], v[64:67], 0
    s_waitcnt vmcnt(10)
    v_cvt_pk_bf16_f32 v69, v42, v43
    v_exp_f32 v44, v44
    v_exp_f32 v45, v45
    v_exp_f32 v46, v46
    v_exp_f32 v47, v47
    v_cvt_pk_bf16_f32 v70, v44, v45
    v_cvt_pk_bf16_f32 v71, v46, v47
    v_mfma_f32_32x32x16_bf16 v[32:47], a[0:3], v[104:107], 0
    v_exp_f32 v48, v48
    v_exp_f32 v49, v49
    v_exp_f32 v50, v50
    v_cvt_pk_bf16_f32 v64, v48, v49
    v_exp_f32 v51, v51
    v_mfma_f32_32x32x16_bf16 v[160:175], v[92:95], v[68:71], v[160:175]
    v_cvt_pk_bf16_f32 v65, v50, v51
    v_exp_f32 v52, v52
    v_exp_f32 v53, v53
    v_exp_f32 v54, v54
    v_cvt_pk_bf16_f32 v66, v52, v53
    v_exp_f32 v55, v55
    v_mfma_f32_32x32x16_bf16 v[32:47], a[4:7], v[108:111], v[32:47]
    v_cvt_pk_bf16_f32 v67, v54, v55
    v_exp_f32 v56, v56
    v_exp_f32 v57, v57
    v_exp_f32 v58, v58
    v_cvt_pk_bf16_f32 v68, v56, v57
    v_exp_f32 v59, v59
    v_mfma_f32_32x32x16_bf16 v[176:191], v[88:91], v[64:67], 0
    v_cvt_pk_bf16_f32 v69, v58, v59
    v_exp_f32 v60, v60
    v_exp_f32 v61, v61
    v_exp_f32 v62, v62
    v_exp_f32 v63, v63
    v_cvt_pk_bf16_f32 v70, v60, v61
    v_cvt_pk_bf16_f32 v71, v62, v63
    v_mfma_f32_32x32x16_bf16 v[48:63], a[0:3], a[180:183], 0
    v_exp_f32 v32, v32
    v_exp_f32 v33, v33
    v_exp_f32 v34, v34
    v_cvt_pk_bf16_f32 v64, v32, v33
    v_exp_f32 v35, v35
    v_mfma_f32_32x32x16_bf16 v[176:191], v[92:95], v[68:71], v[176:191]
    v_cvt_pk_bf16_f32 v65, v34, v35
    v_exp_f32 v36, v36
    v_exp_f32 v37, v37
    v_exp_f32 v38, v38
    v_cvt_pk_bf16_f32 v66, v36, v37
    v_exp_f32 v39, v39
    v_mfma_f32_32x32x16_bf16 v[48:63], a[4:7], a[184:187], v[48:63]
    s_waitcnt vmcnt(8)
    s_mov_b32 s101, 0
    v_cvt_pk_bf16_f32 v67, v38, v39
    v_exp_f32 v40, v40
    v_exp_f32 v41, v41
    v_exp_f32 v42, v42
    v_cvt_pk_bf16_f32 v68, v40, v41
    v_exp_f32 v43, v43
    v_mfma_f32_32x32x16_bf16 v[128:143], a[8:11], v[64:67], v[128:143]
    s_atomic_add s101, s[66:67], 0 glc
    v_cvt_pk_bf16_f32 v69, v42, v43
    v_exp_f32 v44, v44
    v_exp_f32 v45, v45
    v_exp_f32 v46, v46
    v_exp_f32 v47, v47
    v_cvt_pk_bf16_f32 v70, v44, v45
    v_cvt_pk_bf16_f32 v71, v46, v47
    v_mfma_f32_32x32x16_bf16 v[32:47], a[0:3], a[188:191], 0
    v_exp_f32 v48, v48
    v_exp_f32 v49, v49
    v_exp_f32 v50, v50
    v_cvt_pk_bf16_f32 v64, v48, v49
    v_exp_f32 v51, v51
    v_mfma_f32_32x32x16_bf16 v[128:143], a[12:15], v[68:71], v[128:143]
    v_cvt_pk_bf16_f32 v65, v50, v51
    v_exp_f32 v52, v52
    v_exp_f32 v53, v53
    v_exp_f32 v54, v54
    v_cvt_pk_bf16_f32 v66, v52, v53
    v_exp_f32 v55, v55
    v_mfma_f32_32x32x16_bf16 v[32:47], a[4:7], a[192:195], v[32:47]
    v_cvt_pk_bf16_f32 v67, v54, v55
    v_exp_f32 v56, v56
    v_exp_f32 v57, v57
    v_exp_f32 v58, v58
    v_cvt_pk_bf16_f32 v68, v56, v57
    v_exp_f32 v59, v59
    v_mfma_f32_32x32x16_bf16 v[144:159], a[8:11], v[64:67], v[144:159]
    v_cvt_pk_bf16_f32 v69, v58, v59
    v_exp_f32 v60, v60
    v_exp_f32 v61, v61
    v_exp_f32 v62, v62
    v_exp_f32 v63, v63
    v_cvt_pk_bf16_f32 v70, v60, v61
    v_cvt_pk_bf16_f32 v71, v62, v63
    v_mfma_f32_32x32x16_bf16 v[48:63], a[0:3], a[196:199], 0
    v_exp_f32 v32, v32
    v_exp_f32 v33, v33
    v_exp_f32 v34, v34
    v_cvt_pk_bf16_f32 v64, v32, v33
    v_exp_f32 v35, v35
    v_mfma_f32_32x32x16_bf16 v[144:159], a[12:15], v[68:71], v[144:159]
    v_cvt_pk_bf16_f32 v65, v34, v35
    v_exp_f32 v36, v36
    v_exp_f32 v37, v37
    v_exp_f32 v38, v38
    v_cvt_pk_bf16_f32 v66, v36, v37
    v_exp_f32 v39, v39
    v_mfma_f32_32x32x16_bf16 v[48:63], a[4:7], a[200:203], v[48:63]
    v_cvt_pk_bf16_f32 v67, v38, v39
    v_exp_f32 v40, v40
    v_exp_f32 v41, v41
    v_exp_f32 v42, v42
    v_cvt_pk_bf16_f32 v68, v40, v41
    v_exp_f32 v43, v43
    v_mfma_f32_32x32x16_bf16 v[160:175], a[8:11], v[64:67], v[160:175]
    s_waitcnt vmcnt(6)
    s_waitcnt lgkmcnt(0)
    v_cvt_pk_bf16_f32 v69, v42, v43
    v_exp_f32 v44, v44
    v_exp_f32 v45, v45
    v_exp_f32 v46, v46
    v_exp_f32 v47, v47
    v_cvt_pk_bf16_f32 v70, v44, v45
    v_cvt_pk_bf16_f32 v71, v46, v47
    v_mfma_f32_32x32x16_bf16 v[32:47], a[16:19], v[104:107], 0
    s_add_u32 s89, s101, 0x70707070
    v_exp_f32 v48, v48
    v_exp_f32 v49, v49
    v_exp_f32 v50, v50
    v_cvt_pk_bf16_f32 v64, v48, v49
    v_exp_f32 v51, v51
    v_mfma_f32_32x32x16_bf16 v[160:175], a[12:15], v[68:71], v[160:175]
    s_and_b32 s89, s89, 0x80808080
    v_cvt_pk_bf16_f32 v65, v50, v51
    v_exp_f32 v52, v52
    v_exp_f32 v53, v53
    v_exp_f32 v54, v54
    v_cvt_pk_bf16_f32 v66, v52, v53
    v_exp_f32 v55, v55
    v_mfma_f32_32x32x16_bf16 v[32:47], a[20:23], v[108:111], v[32:47]
    s_cmp_eq_u32 s89, 0x80808080
    s_cbranch_scc0 L_rest_26
L_rest_26_ok:
    v_cvt_pk_bf16_f32 v67, v54, v55
    v_exp_f32 v56, v56
    v_exp_f32 v57, v57
    v_exp_f32 v58, v58
    v_cvt_pk_bf16_f32 v68, v56, v57
    v_exp_f32 v59, v59
    v_mfma_f32_32x32x16_bf16 v[176:191], a[8:11], v[64:67], v[176:191]
    v_cvt_pk_bf16_f32 v69, v58, v59
    v_exp_f32 v60, v60
    v_exp_f32 v61, v61
    v_exp_f32 v62, v62
    v_exp_f32 v63, v63
    v_cvt_pk_bf16_f32 v70, v60, v61
    v_cvt_pk_bf16_f32 v71, v62, v63
    v_mfma_f32_32x32x16_bf16 v[48:63], a[16:19], a[180:183], 0
    buffer_load_dwordx4 a[48:51], v123, s[52:55], s91 offen offset:0 sc1
    buffer_load_dwordx4 a[52:55], v123, s[52:55], s91 offen offset:1024 sc1
    buffer_load_dwordx4 a[56:59], v123, s[52:55], s91 offen offset:2048 sc1
    buffer_load_dwordx4 a[60:63], v123, s[52:55], s91 offen offset:3072 sc1
    v_exp_f32 v32, v32
    v_exp_f32 v33, v33
    v_exp_f32 v34, v34
    v_cvt_pk_bf16_f32 v64, v32, v33
    v_exp_f32 v35, v35
    v_mfma_f32_32x32x16_bf16 v[176:191], a[12:15], v[68:71], v[176:191]
    v_cvt_pk_bf16_f32 v65, v34, v35
    v_exp_f32 v36, v36
    v_exp_f32 v37, v37
    v_exp_f32 v38, v38
    v_cvt_pk_bf16_f32 v66, v36, v37
    v_exp_f32 v39, v39
    v_mfma_f32_32x32x16_bf16 v[48:63], a[20:23], a[184:187], v[48:63]
    s_waitcnt vmcnt(8)
    v_cvt_pk_bf16_f32 v67, v38, v39
    v_exp_f32 v40, v40
    v_exp_f32 v41, v41
    v_exp_f32 v42, v42
    v_cvt_pk_bf16_f32 v68, v40, v41
    v_exp_f32 v43, v43
    v_mfma_f32_32x32x16_bf16 v[128:143], a[24:27], v[64:67], v[128:143]
    s_xor_b32 s91, s72, 20480
    v_cvt_pk_bf16_f32 v69, v42, v43
    v_exp_f32 v44, v44
    v_exp_f32 v45, v45
    v_exp_f32 v46, v46
    v_exp_f32 v47, v47
    v_cvt_pk_bf16_f32 v70, v44, v45
    v_cvt_pk_bf16_f32 v71, v46, v47
    v_mfma_f32_32x32x16_bf16 v[32:47], a[16:19], a[188:191], 0
    v_exp_f32 v48, v48
    v_exp_f32 v49, v49
    v_exp_f32 v50, v50
    v_cvt_pk_bf16_f32 v64, v48, v49
    v_exp_f32 v51, v51
    v_mfma_f32_32x32x16_bf16 v[128:143], a[28:31], v[68:71], v[128:143]
    v_cvt_pk_bf16_f32 v65, v50, v51
    v_exp_f32 v52, v52
    v_exp_f32 v53, v53
    v_exp_f32 v54, v54
    v_cvt_pk_bf16_f32 v66, v52, v53
    v_exp_f32 v55, v55
    v_mfma_f32_32x32x16_bf16 v[32:47], a[20:23], a[192:195], v[32:47]
    v_cvt_pk_bf16_f32 v67, v54, v55
    v_exp_f32 v56, v56
    v_exp_f32 v57, v57
    v_exp_f32 v58, v58
    v_cvt_pk_bf16_f32 v68, v56, v57
    v_exp_f32 v59, v59
    v_mfma_f32_32x32x16_bf16 v[144:159], a[24:27], v[64:67], v[144:159]
    v_cvt_pk_bf16_f32 v69, v58, v59
    v_exp_f32 v60, v60
    v_exp_f32 v61, v61
    v_exp_f32 v62, v62
    v_exp_f32 v63, v63
    v_cvt_pk_bf16_f32 v70, v60, v61
    v_cvt_pk_bf16_f32 v71, v62, v63
    v_mfma_f32_32x32x16_bf16 v[48:63], a[16:19], a[196:199], 0
    buffer_load_dwordx4 a[64:67], v123, s[52:55], s91 offen offset:0 sc1
    buffer_load_dwordx4 a[68:71], v123, s[52:55], s91 offen offset:1024 sc1
    buffer_load_dwordx4 a[72:75], v123, s[52:55], s91 offen offset:2048 sc1
    buffer_load_dwordx4 a[76:79], v123, s[52:55], s91 offen offset:3072 sc1
    v_exp_f32 v32, v32
    v_exp_f32 v33, v33
    v_exp_f32 v34, v34
    v_cvt_pk_bf16_f32 v64, v32, v33
    v_exp_f32 v35, v35
    v_mfma_f32_32x32x16_bf16 v[144:159], a[28:31], v[68:71], v[144:159]
    v_cvt_pk_bf16_f32 v65, v34, v35
    v_exp_f32 v36, v36
    v_exp_f32 v37, v37
    v_exp_f32 v38, v38
    v_cvt_pk_bf16_f32 v66, v36, v37
    v_exp_f32 v39, v39
    v_mfma_f32_32x32x16_bf16 v[48:63], a[20:23], a[200:203], v[48:63]
    s_xor_b32 s91, s72, 24576
    v_cvt_pk_bf16_f32 v67, v38, v39
    v_exp_f32 v40, v40
    v_exp_f32 v41, v41
    v_exp_f32 v42, v42
    v_cvt_pk_bf16_f32 v68, v40, v41
    v_exp_f32 v43, v43
    v_mfma_f32_32x32x16_bf16 v[160:175], a[24:27], v[64:67], v[160:175]
    s_waitcnt vmcnt(10)
    v_cvt_pk_bf16_f32 v69, v42, v43
    v_exp_f32 v44, v44
    v_exp_f32 v45, v45
    v_exp_f32 v46, v46
    v_exp_f32 v47, v47
    v_cvt_pk_bf16_f32 v70, v44, v45
    v_cvt_pk_bf16_f32 v71, v46, v47
    v_mfma_f32_32x32x16_bf16 v[32:47], a[32:35], v[104:107], 0
    v_exp_f32 v48, v48
    v_exp_f32 v49, v49
    v_exp_f32 v50, v50
    v_cvt_pk_bf16_f32 v64, v48, v49
    v_exp_f32 v51, v51
    v_mfma_f32_32x32x16_bf16 v[160:175], a[28:31], v[68:71], v[160:175]
    v_cvt_pk_bf16_f32 v65, v50, v51
    v_exp_f32 v52, v52
    v_exp_f32 v53, v53
    v_exp_f32 v54, v54
    v_cvt_pk_bf16_f32 v66, v52, v53
    v_exp_f32 v55, v55
    v_mfma_f32_32x32x16_bf16 v[32:47], a[36:39], v[108:111], v[32:47]
    v_cvt_pk_bf16_f32 v67, v54, v55
    v_exp_f32 v56, v56
    v_exp_f32 v57, v57
    v_exp_f32 v58, v58
    v_cvt_pk_bf16_f32 v68, v56, v57
    v_exp_f32 v59, v59
    v_mfma_f32_32x32x16_bf16 v[176:191], a[24:27], v[64:67], v[176:191]
    v_cvt_pk_bf16_f32 v69, v58, v59
    v_exp_f32 v60, v60
    v_exp_f32 v61, v61
    v_exp_f32 v62, v62
    v_exp_f32 v63, v63
    v_cvt_pk_bf16_f32 v70, v60, v61
    v_cvt_pk_bf16_f32 v71, v62, v63
    v_mfma_f32_32x32x16_bf16 v[48:63], a[32:35], a[180:183], 0
    buffer_load_dwordx4 a[80:83], v123, s[52:55], s91 offen offset:0 sc1
    buffer_load_dwordx4 a[84:87], v123, s[52:55], s91 offen offset:1024 sc1
    buffer_load_dwordx4 a[88:91], v123, s[52:55], s91 offen offset:2048 sc1
    buffer_load_dwordx4 a[92:95], v123, s[52:55], s91 offen offset:3072 sc1
    v_exp_f32 v32, v32
    v_exp_f32 v33, v33
    v_exp_f32 v34, v34
    v_cvt_pk_bf16_f32 v64, v32, v33
    v_exp_f32 v35, v35
    v_mfma_f32_32x32x16_bf16 v[176:191], a[28:31], v[68:71], v[176:191]
    v_cvt_pk_bf16_f32 v65, v34, v35
    v_exp_f32 v36, v36
    v_exp_f32 v37, v37
    v_exp_f32 v38, v38
    v_cvt_pk_bf16_f32 v66, v36, v37
    v_exp_f32 v39, v39
    v_mfma_f32_32x32x16_bf16 v[48:63], a[36:39], a[184:187], v[48:63]
    s_waitcnt vmcnt(12)
    v_cvt_pk_bf16_f32 v67, v38, v39
    v_exp_f32 v40, v40
    v_exp_f32 v41, v41
    v_exp_f32 v42, v42
    v_cvt_pk_bf16_f32 v68, v40, v41
    v_exp_f32 v43, v43
    v_mfma_f32_32x32x16_bf16 v[128:143], a[40:43], v[64:67], v[128:143]
    s_xor_b32 s91, s72, 28672
    v_cvt_pk_bf16_f32 v69, v42, v43
    v_exp_f32 v44, v44
    v_exp_f32 v45, v45
    v_exp_f32 v46, v46
    v_exp_f32 v47, v47
    v_cvt_pk_bf16_f32 v70, v44, v45
    v_cvt_pk_bf16_f32 v71, v46, v47
    v_mfma_f32_32x32x16_bf16 v[32:47], a[32:35], a[188:191], 0
    v_exp_f32 v48, v48
    v_exp_f32 v49, v49
    v_exp_f32 v50, v50
    v_cvt_pk_bf16_f32 v64, v48, v49
    v_exp_f32 v51, v51
    v_mfma_f32_32x32x16_bf16 v[128:143], a[44:47], v[68:71], v[128:143]
    v_cvt_pk_bf16_f32 v65, v50, v51
    v_exp_f32 v52, v52
    v_exp_f32 v53, v53
    v_exp_f32 v54, v54
    v_cvt_pk_bf16_f32 v66, v52, v53
    v_exp_f32 v55, v55
    v_mfma_f32_32x32x16_bf16 v[32:47], a[36:39], a[192:195], v[32:47]
    v_cvt_pk_bf16_f32 v67, v54, v55
    v_exp_f32 v56, v56
    v_exp_f32 v57, v57
    v_exp_f32 v58, v58
    v_cvt_pk_bf16_f32 v68, v56, v57
    v_exp_f32 v59, v59
    v_mfma_f32_32x32x16_bf16 v[144:159], a[40:43], v[64:67], v[144:159]
    v_cvt_pk_bf16_f32 v69, v58, v59
    v_exp_f32 v60, v60
    v_exp_f32 v61, v61
    v_exp_f32 v62, v62
    v_exp_f32 v63, v63
    v_cvt_pk_bf16_f32 v70, v60, v61
    v_cvt_pk_bf16_f32 v71, v62, v63
    v_mfma_f32_32x32x16_bf16 v[48:63], a[32:35], a[196:199], 0
    buffer_load_dwordx4 a[96:99], v123, s[52:55], s91 offen offset:0 sc1
    buffer_load_dwordx4 a[100:103], v123, s[52:55], s91 offen offset:1024 sc1
    buffer_load_dwordx4 a[104:107], v123, s[52:55], s91 offen offset:2048 sc1
    buffer_load_dwordx4 a[108:111], v123, s[52:55], s91 offen offset:3072 sc1
    v_exp_f32 v32, v32
    v_exp_f32 v33, v33
    v_exp_f32 v34, v34
    v_cvt_pk_bf16_f32 v64, v32, v33
    v_exp_f32 v35, v35
    v_mfma_f32_32x32x16_bf16 v[144:159], a[44:47], v[68:71], v[144:159]
    v_cvt_pk_bf16_f32 v65, v34, v35
    v_exp_f32 v36, v36
    v_exp_f32 v37, v37
    v_exp_f32 v38, v38
    v_cvt_pk_bf16_f32 v66, v36, v37
    v_exp_f32 v39, v39
    v_mfma_f32_32x32x16_bf16 v[48:63], a[36:39], a[200:203], v[48:63]
    s_xor_b32 s91, s72, 32768
    v_cvt_pk_bf16_f32 v67, v38, v39
    v_exp_f32 v40, v40
    v_exp_f32 v41, v41
    v_exp_f32 v42, v42
    v_cvt_pk_bf16_f32 v68, v40, v41
    v_exp_f32 v43, v43
    v_mfma_f32_32x32x16_bf16 v[160:175], a[40:43], v[64:67], v[160:175]
L_page_10:
    s_cbranch_vccnz L_page_ret1
    s_waitcnt vmcnt(14)
    v_cvt_pk_bf16_f32 v69, v42, v43
    v_exp_f32 v44, v44
    v_exp_f32 v45, v45
    v_exp_f32 v46, v46
    v_exp_f32 v47, v47
    v_cvt_pk_bf16_f32 v70, v44, v45
    v_cvt_pk_bf16_f32 v71, v46, v47
    v_mfma_f32_32x32x16_bf16 v[32:47], a[48:51], v[104:107], 0
    v_exp_f32 v48, v48
    v_exp_f32 v49, v49
    v_exp_f32 v50, v50
    v_cvt_pk_bf16_f32 v64, v48, v49
    v_exp_f32 v51, v51
    v_mfma_f32_32x32x16_bf16 v[160:175], a[44:47], v[68:71], v[160:175]
    v_cvt_pk_bf16_f32 v65, v50, v51
    v_exp_f32 v52, v52
    v_exp_f32 v53, v53
    v_exp_f32 v54, v54
    v_cvt_pk_bf16_f32 v66, v52, v53
    v_exp_f32 v55, v55
    v_mfma_f32_32x32x16_bf16 v[32:47], a[52:55], v[108:111], v[32:47]
    v_cvt_pk_bf16_f32 v67, v54, v55
    v_exp_f32 v56, v56
    v_exp_f32 v57, v57
    v_exp_f32 v58, v58
    v_cvt_pk_bf16_f32 v68, v56, v57
    v_exp_f32 v59, v59
    v_mfma_f32_32x32x16_bf16 v[176:191], a[40:43], v[64:67], v[176:191]
    v_cvt_pk_bf16_f32 v69, v58, v59
    v_exp_f32 v60, v60
    v_exp_f32 v61, v61
    v_exp_f32 v62, v62
    v_exp_f32 v63, v63
    v_cvt_pk_bf16_f32 v70, v60, v61
    v_cvt_pk_bf16_f32 v71, v62, v63
    v_mfma_f32_32x32x16_bf16 v[48:63], a[48:51], a[180:183], 0
    buffer_load_dwordx4 a[112:115], v123, s[52:55], s91 offen offset:0 sc1
    buffer_load_dwordx4 a[116:119], v123, s[52:55], s91 offen offset:1024 sc1
    buffer_load_dwordx4 a[120:123], v123, s[52:55], s91 offen offset:2048 sc1
    buffer_load_dwordx4 a[124:127], v123, s[52:55], s91 offen offset:3072 sc1
    v_exp_f32 v32, v32
    v_exp_f32 v33, v33
    v_exp_f32 v34, v34
    v_cvt_pk_bf16_f32 v64, v32, v33
    v_exp_f32 v35, v35
    v_mfma_f32_32x32x16_bf16 v[176:191], a[44:47], v[68:71], v[176:191]
    v_cvt_pk_bf16_f32 v65, v34, v35
    v_exp_f32 v36, v36
    v_exp_f32 v37, v37
    v_exp_f32 v38, v38
    v_cvt_pk_bf16_f32 v66, v36, v37
    v_exp_f32 v39, v39
    v_mfma_f32_32x32x16_bf16 v[48:63], a[52:55], a[184:187], v[48:63]
    s_waitcnt vmcnt(16)
    v_cvt_pk_bf16_f32 v67, v38, v39
    v_exp_f32 v40, v40
    v_exp_f32 v41, v41
    v_exp_f32 v42, v42
    v_cvt_pk_bf16_f32 v68, v40, v41
    v_exp_f32 v43, v43
    v_mfma_f32_32x32x16_bf16 v[128:143], a[56:59], v[64:67], v[128:143]
    s_xor_b32 s91, s72, 36864
    v_cvt_pk_bf16_f32 v69, v42, v43
    v_exp_f32 v44, v44
    v_exp_f32 v45, v45
    v_exp_f32 v46, v46
    v_exp_f32 v47, v47
    v_cvt_pk_bf16_f32 v70, v44, v45
    v_cvt_pk_bf16_f32 v71, v46, v47
    v_mfma_f32_32x32x16_bf16 v[32:47], a[48:51], a[188:191], 0
    v_exp_f32 v48, v48
    v_exp_f32 v49, v49
    v_exp_f32 v50, v50
    v_cvt_pk_bf16_f32 v64, v48, v49
    v_exp_f32 v51, v51
    v_mfma_f32_32x32x16_bf16 v[128:143], a[60:63], v[68:71], v[128:143]
    v_cvt_pk_bf16_f32 v65, v50, v51
    v_exp_f32 v52, v52
    v_exp_f32 v53, v53
    v_exp_f32 v54, v54
    v_cvt_pk_bf16_f32 v66, v52, v53
    v_exp_f32 v55, v55
    v_mfma_f32_32x32x16_bf16 v[32:47], a[52:55], a[192:195], v[32:47]
    v_cvt_pk_bf16_f32 v67, v54, v55
    v_exp_f32 v56, v56
    v_exp_f32 v57, v57
    v_exp_f32 v58, v58
    v_cvt_pk_bf16_f32 v68, v56, v57
    v_exp_f32 v59, v59
    v_mfma_f32_32x32x16_bf16 v[144:159], a[56:59], v[64:67], v[144:159]
    v_cvt_pk_bf16_f32 v69, v58, v59
    v_exp_f32 v60, v60
    v_exp_f32 v61, v61
    v_exp_f32 v62, v62
    v_exp_f32 v63, v63
    v_cvt_pk_bf16_f32 v70, v60, v61
    v_cvt_pk_bf16_f32 v71, v62, v63
    v_mfma_f32_32x32x16_bf16 v[48:63], a[48:51], a[196:199], 0
    buffer_load_dwordx4 a[0:3], v123, s[52:55], s91 offen offset:0 sc1
    buffer_load_dwordx4 a[4:7], v123, s[52:55], s91 offen offset:1024 sc1
    buffer_load_dwordx4 a[8:11], v123, s[52:55], s91 offen offset:2048 sc1
    buffer_load_dwordx4 a[12:15], v123, s[52:55], s91 offen offset:3072 sc1
    v_exp_f32 v32, v32
    v_exp_f32 v33, v33
    v_exp_f32 v34, v34
    v_cvt_pk_bf16_f32 v64, v32, v33
    v_exp_f32 v35, v35
    v_mfma_f32_32x32x16_bf16 v[144:159], a[60:63], v[68:71], v[144:159]
    v_cvt_pk_bf16_f32 v65, v34, v35
    v_exp_f32 v36, v36
    v_exp_f32 v37, v37
    v_exp_f32 v38, v38
    v_cvt_pk_bf16_f32 v66, v36, v37
    v_exp_f32 v39, v39
    v_mfma_f32_32x32x16_bf16 v[48:63], a[52:55], a[200:203], v[48:63]
    s_xor_b32 s91, s72, 40960
    v_cvt_pk_bf16_f32 v67, v38, v39
    v_exp_f32 v40, v40
    v_exp_f32 v41, v41
    v_exp_f32 v42, v42
    v_cvt_pk_bf16_f32 v68, v40, v41
    v_exp_f32 v43, v43
    v_mfma_f32_32x32x16_bf16 v[160:175], a[56:59], v[64:67], v[160:175]
    s_waitcnt vmcnt(18)
    v_cvt_pk_bf16_f32 v69, v42, v43
    v_exp_f32 v44, v44
    v_exp_f32 v45, v45
    v_exp_f32 v46, v46
    v_exp_f32 v47, v47
    v_cvt_pk_bf16_f32 v70, v44, v45
    v_cvt_pk_bf16_f32 v71, v46, v47
    v_mfma_f32_32x32x16_bf16 v[32:47], a[64:67], v[104:107], 0
    v_exp_f32 v48, v48
    v_exp_f32 v49, v49
    v_exp_f32 v50, v50
    v_cvt_pk_bf16_f32 v64, v48, v49
    v_exp_f32 v51, v51
    v_mfma_f32_32x32x16_bf16 v[160:175], a[60:63], v[68:71], v[160:175]
    v_cvt_pk_bf16_f32 v65, v50, v51
    v_exp_f32 v52, v52
    v_exp_f32 v53, v53
    v_exp_f32 v54, v54
    v_cvt_pk_bf16_f32 v66, v52, v53
    v_exp_f32 v55, v55
    v_mfma_f32_32x32x16_bf16 v[32:47], a[68:71], v[108:111], v[32:47]
    v_cvt_pk_bf16_f32 v67, v54, v55
    v_exp_f32 v56, v56
    v_exp_f32 v57, v57
    v_exp_f32 v58, v58
    v_cvt_pk_bf16_f32 v68, v56, v57
    v_exp_f32 v59, v59
    v_mfma_f32_32x32x16_bf16 v[176:191], a[56:59], v[64:67], v[176:191]
    v_cvt_pk_bf16_f32 v69, v58, v59
    v_exp_f32 v60, v60
    v_exp_f32 v61, v61
    v_exp_f32 v62, v62
    v_exp_f32 v63, v63
    v_cvt_pk_bf16_f32 v70, v60, v61
    v_cvt_pk_bf16_f32 v71, v62, v63
    v_mfma_f32_32x32x16_bf16 v[48:63], a[64:67], a[180:183], 0
    buffer_load_dwordx4 a[16:19], v123, s[52:55], s91 offen offset:0 sc1
    buffer_load_dwordx4 a[20:23], v123, s[52:55], s91 offen offset:1024 sc1
    buffer_load_dwordx4 a[24:27], v123, s[52:55], s91 offen offset:2048 sc1
    buffer_load_dwordx4 a[28:31], v123, s[52:55], s91 offen offset:3072 sc1
    v_exp_f32 v32, v32
    v_exp_f32 v33, v33
    v_exp_f32 v34, v34
    v_cvt_pk_bf16_f32 v64, v32, v33
    v_exp_f32 v35, v35
    v_mfma_f32_32x32x16_bf16 v[176:191], a[60:63], v[68:71], v[176:191]
    v_cvt_pk_bf16_f32 v65, v34, v35
    v_exp_f32 v36, v36
    v_exp_f32 v37, v37
    v_exp_f32 v38, v38
    v_cvt_pk_bf16_f32 v66, v36, v37
    v_exp_f32 v39, v39
    v_mfma_f32_32x32x16_bf16 v[48:63], a[68:71], a[184:187], v[48:63]
    s_waitcnt vmcnt(20)
    v_cvt_pk_bf16_f32 v67, v38, v39
    v_exp_f32 v40, v40
    v_exp_f32 v41, v41
    v_exp_f32 v42, v42
    v_cvt_pk_bf16_f32 v68, v40, v41
    v_exp_f32 v43, v43
    v_mfma_f32_32x32x16_bf16 v[128:143], a[72:75], v[64:67], v[128:143]
    s_xor_b32 s91, s72, 45056
    v_cvt_pk_bf16_f32 v69, v42, v43
    v_exp_f32 v44, v44
    v_exp_f32 v45, v45
    v_exp_f32 v46, v46
    v_exp_f32 v47, v47
    v_cvt_pk_bf16_f32 v70, v44, v45
    v_cvt_pk_bf16_f32 v71, v46, v47
    v_mfma_f32_32x32x16_bf16 v[32:47], a[64:67], a[188:191], 0
    v_exp_f32 v48, v48
    v_exp_f32 v49, v49
    v_exp_f32 v50, v50
    v_cvt_pk_bf16_f32 v64, v48, v49
    v_exp_f32 v51, v51
    v_mfma_f32_32x32x16_bf16 v[128:143], a[76:79], v[68:71], v[128:143]
    v_cvt_pk_bf16_f32 v65, v50, v51
    v_exp_f32 v52, v52
    v_exp_f32 v53, v53
    v_exp_f32 v54, v54
    v_cvt_pk_bf16_f32 v66, v52, v53
    v_exp_f32 v55, v55
    v_mfma_f32_32x32x16_bf16 v[32:47], a[68:71], a[192:195], v[32:47]
    v_cvt_pk_bf16_f32 v67, v54, v55
    v_exp_f32 v56, v56
    v_exp_f32 v57, v57
    v_exp_f32 v58, v58
    v_cvt_pk_bf16_f32 v68, v56, v57
    v_exp_f32 v59, v59
    v_mfma_f32_32x32x16_bf16 v[144:159], a[72:75], v[64:67], v[144:159]
    v_cvt_pk_bf16_f32 v69, v58, v59
    v_exp_f32 v60, v60
    v_exp_f32 v61, v61
    v_exp_f32 v62, v62
    v_exp_f32 v63, v63
    v_cvt_pk_bf16_f32 v70, v60, v61
    v_cvt_pk_bf16_f32 v71, v62, v63
    v_mfma_f32_32x32x16_bf16 v[48:63], a[64:67], a[196:199], 0
    buffer_load_dwordx4 a[32:35], v123, s[52:55], s91 offen offset:0 sc1
    buffer_load_dwordx4 a[36:39], v123, s[52:55], s91 offen offset:1024 sc1
    buffer_load_dwordx4 a[40:43], v123, s[52:55], s91 offen offset:2048 sc1
    buffer_load_dwordx4 a[44:47], v123, s[52:55], s91 offen offset:3072 sc1
    v_exp_f32 v32, v32
    v_exp_f32 v33, v33
    v_exp_f32 v34, v34
    v_cvt_pk_bf16_f32 v64, v32, v33
    v_exp_f32 v35, v35
    v_mfma_f32_32x32x16_bf16 v[144:159], a[76:79], v[68:71], v[144:159]
    v_cvt_pk_bf16_f32 v65, v34, v35
    v_exp_f32 v36, v36
    v_exp_f32 v37, v37
    v_exp_f32 v38, v38
    v_cvt_pk_bf16_f32 v66, v36, v37
    v_exp_f32 v39, v39
    v_mfma_f32_32x32x16_bf16 v[48:63], a[68:71], a[200:203], v[48:63]
    s_xor_b32 s91, s72, 49152
    v_cvt_pk_bf16_f32 v67, v38, v39
    v_exp_f32 v40, v40
    v_exp_f32 v41, v41
    v_exp_f32 v42, v42
    v_cvt_pk_bf16_f32 v68, v40, v41
    v_exp_f32 v43, v43
    v_mfma_f32_32x32x16_bf16 v[160:175], a[72:75], v[64:67], v[160:175]
    s_waitcnt vmcnt(22)
    v_cvt_pk_bf16_f32 v69, v42, v43
    v_exp_f32 v44, v44
    v_exp_f32 v45, v45
    v_exp_f32 v46, v46
    v_exp_f32 v47, v47
    v_cvt_pk_bf16_f32 v70, v44, v45
    v_cvt_pk_bf16_f32 v71, v46, v47
    v_mfma_f32_32x32x16_bf16 v[32:47], a[80:83], v[104:107], 0
    v_exp_f32 v48, v48
    v_exp_f32 v49, v49
    v_exp_f32 v50, v50
    v_cvt_pk_bf16_f32 v64, v48, v49
    v_exp_f32 v51, v51
    v_mfma_f32_32x32x16_bf16 v[160:175], a[76:79], v[68:71], v[160:175]
    v_cvt_pk_bf16_f32 v65, v50, v51
    v_exp_f32 v52, v52
    v_exp_f32 v53, v53
    v_exp_f32 v54, v54
    v_cvt_pk_bf16_f32 v66, v52, v53
    v_exp_f32 v55, v55
    v_mfma_f32_32x32x16_bf16 v[32:47], a[84:87], v[108:111], v[32:47]
    v_cvt_pk_bf16_f32 v67, v54, v55
    v_exp_f32 v56, v56
    v_exp_f32 v57, v57
    v_exp_f32 v58, v58
    v_cvt_pk_bf16_f32 v68, v56, v57
    v_exp_f32 v59, v59
    v_mfma_f32_32x32x16_bf16 v[176:191], a[72:75], v[64:67], v[176:191]
    v_cvt_pk_bf16_f32 v69, v58, v59
    v_exp_f32 v60, v60
    v_exp_f32 v61, v61
    v_exp_f32 v62, v62
    v_exp_f32 v63, v63
    v_cvt_pk_bf16_f32 v70, v60, v61
    v_cvt_pk_bf16_f32 v71, v62, v63
    v_mfma_f32_32x32x16_bf16 v[48:63], a[80:83], a[180:183], 0
    buffer_load_dwordx4 a[48:51], v123, s[52:55], s91 offen offset:0 sc1
    buffer_load_dwordx4 a[52:55], v123, s[52:55], s91 offen offset:1024 sc1
    buffer_load_dwordx4 a[56:59], v123, s[52:55], s91 offen offset:2048 sc1
    buffer_load_dwordx4 a[60:63], v123, s[52:55], s91 offen offset:3072 sc1
    v_exp_f32 v32, v32
    v_exp_f32 v33, v33
    v_exp_f32 v34, v34
    v_cvt_pk_bf16_f32 v64, v32, v33
    v_exp_f32 v35, v35
    v_mfma_f32_32x32x16_bf16 v[176:191], a[76:79], v[68:71], v[176:191]
    v_cvt_pk_bf16_f32 v65, v34, v35
    v_exp_f32 v36, v36
    v_exp_f32 v37, v37
    v_exp_f32 v38, v38
    v_cvt_pk_bf16_f32 v66, v36, v37
    v_exp_f32 v39, v39
    v_mfma_f32_32x32x16_bf16 v[48:63], a[84:87], a[184:187], v[48:63]
    s_waitcnt vmcnt(24)
    v_cvt_pk_bf16_f32 v67, v38, v39
    v_exp_f32 v40, v40
    v_exp_f32 v41, v41
    v_exp_f32 v42, v42
    v_cvt_pk_bf16_f32 v68, v40, v41
    v_exp_f32 v43, v43
    v_mfma_f32_32x32x16_bf16 v[128:143], a[88:91], v[64:67], v[128:143]
    s_xor_b32 s91, s72, 53248
    v_cvt_pk_bf16_f32 v69, v42, v43
    v_exp_f32 v44, v44
    v_exp_f32 v45, v45
    v_exp_f32 v46, v46
    v_exp_f32 v47, v47
    v_cvt_pk_bf16_f32 v70, v44, v45
    v_cvt_pk_bf16_f32 v71, v46, v47
    v_mfma_f32_32x32x16_bf16 v[32:47], a[80:83], a[188:191], 0
    v_exp_f32 v48, v48
    v_exp_f32 v49, v49
    v_exp_f32 v50, v50
    v_cvt_pk_bf16_f32 v64, v48, v49
    v_exp_f32 v51, v51
    v_mfma_f32_32x32x16_bf16 v[128:143], a[92:95], v[68:71], v[128:143]
    v_cvt_pk_bf16_f32 v65, v50, v51
    v_exp_f32 v52, v52
    v_exp_f32 v53, v53
    v_exp_f32 v54, v54
    v_cvt_pk_bf16_f32 v66, v52, v53
    v_exp_f32 v55, v55
    v_mfma_f32_32x32x16_bf16 v[32:47], a[84:87], a[192:195], v[32:47]
    v_cvt_pk_bf16_f32 v67, v54, v55
    v_exp_f32 v56, v56
    v_exp_f32 v57, v57
    v_exp_f32 v58, v58
    v_cvt_pk_bf16_f32 v68, v56, v57
    v_exp_f32 v59, v59
    v_mfma_f32_32x32x16_bf16 v[144:159], a[88:91], v[64:67], v[144:159]
    v_cvt_pk_bf16_f32 v69, v58, v59
    v_exp_f32 v60, v60
    v_exp_f32 v61, v61
    v_exp_f32 v62, v62
    v_exp_f32 v63, v63
    v_cvt_pk_bf16_f32 v70, v60, v61
    v_cvt_pk_bf16_f32 v71, v62, v63
    v_mfma_f32_32x32x16_bf16 v[48:63], a[80:83], a[196:199], 0
    buffer_load_dwordx4 a[64:67], v123, s[52:55], s91 offen offset:0 sc1
    buffer_load_dwordx4 a[68:71], v123, s[52:55], s91 offen offset:1024 sc1
    buffer_load_dwordx4 a[72:75], v123, s[52:55], s91 offen offset:2048 sc1
    buffer_load_dwordx4 a[76:79], v123, s[52:55], s91 offen offset:3072 sc1
    v_exp_f32 v32, v32
    v_exp_f32 v33, v33
    v_exp_f32 v34, v34
    v_cvt_pk_bf16_f32 v64, v32, v33
    v_exp_f32 v35, v35
    v_mfma_f32_32x32x16_bf16 v[144:159], a[92:95], v[68:71], v[144:159]
    v_cvt_pk_bf16_f32 v65, v34, v35
    v_exp_f32 v36, v36
    v_exp_f32 v37, v37
    v_exp_f32 v38, v38
    v_cvt_pk_bf16_f32 v66, v36, v37
    v_exp_f32 v39, v39
    v_mfma_f32_32x32x16_bf16 v[48:63], a[84:87], a[200:203], v[48:63]
    s_xor_b32 s91, s72, 57344
    v_cvt_pk_bf16_f32 v67, v38, v39
    v_exp_f32 v40, v40
    v_exp_f32 v41, v41
    v_exp_f32 v42, v42
    v_cvt_pk_bf16_f32 v68, v40, v41
    v_exp_f32 v43, v43
    v_mfma_f32_32x32x16_bf16 v[160:175], a[88:91], v[64:67], v[160:175]
    s_waitcnt vmcnt(26)
    v_cvt_pk_bf16_f32 v69, v42, v43
    v_exp_f32 v44, v44
    v_exp_f32 v45, v45
    v_exp_f32 v46, v46
    v_exp_f32 v47, v47
    v_cvt_pk_bf16_f32 v70, v44, v45
    v_cvt_pk_bf16_f32 v71, v46, v47
    v_mfma_f32_32x32x16_bf16 v[32:47], a[96:99], v[104:107], 0
    v_exp_f32 v48, v48
    v_exp_f32 v49, v49
    v_exp_f32 v50, v50
    v_cvt_pk_bf16_f32 v64, v48, v49
    v_exp_f32 v51, v51
    v_mfma_f32_32x32x16_bf16 v[160:175], a[92:95], v[68:71], v[160:175]
    v_cvt_pk_bf16_f32 v65, v50, v51
    v_exp_f32 v52, v52
    v_exp_f32 v53, v53
    v_exp_f32 v54, v54
    v_cvt_pk_bf16_f32 v66, v52, v53
    v_exp_f32 v55, v55
    v_mfma_f32_32x32x16_bf16 v[32:47], a[100:103], v[108:111], v[32:47]
    v_cvt_pk_bf16_f32 v67, v54, v55
    v_exp_f32 v56, v56
    v_exp_f32 v57, v57
    v_exp_f32 v58, v58
    v_cvt_pk_bf16_f32 v68, v56, v57
    v_exp_f32 v59, v59
    v_mfma_f32_32x32x16_bf16 v[176:191], a[88:91], v[64:67], v[176:191]
    v_cvt_pk_bf16_f32 v69, v58, v59
    v_exp_f32 v60, v60
    v_exp_f32 v61, v61
    v_exp_f32 v62, v62
    v_exp_f32 v63, v63
    v_cvt_pk_bf16_f32 v70, v60, v61
    v_cvt_pk_bf16_f32 v71, v62, v63
    v_mfma_f32_32x32x16_bf16 v[48:63], a[96:99], a[180:183], 0
    v_exp_f32 v32, v32
    v_exp_f32 v33, v33
    v_exp_f32 v34, v34
    v_cvt_pk_bf16_f32 v64, v32, v33
    v_exp_f32 v35, v35
    v_mfma_f32_32x32x16_bf16 v[176:191], a[92:95], v[68:71], v[176:191]
    v_cvt_pk_bf16_f32 v65, v34, v35
    v_exp_f32 v36, v36
    v_exp_f32 v37, v37
    v_exp_f32 v38, v38
    v_cvt_pk_bf16_f32 v66, v36, v37
    v_exp_f32 v39, v39
    v_mfma_f32_32x32x16_bf16 v[48:63], a[100:103], a[184:187], v[48:63]
    s_waitcnt vmcnt(24)
    v_cvt_pk_bf16_f32 v67, v38, v39
    v_exp_f32 v40, v40
    v_exp_f32 v41, v41
    v_exp_f32 v42, v42
    v_cvt_pk_bf16_f32 v68, v40, v41
    v_exp_f32 v43, v43
    v_mfma_f32_32x32x16_bf16 v[128:143], a[104:107], v[64:67], v[128:143]
    v_cvt_pk_bf16_f32 v69, v42, v43
    v_exp_f32 v44, v44
    v_exp_f32 v45, v45
    v_exp_f32 v46, v46
    v_exp_f32 v47, v47
    v_cvt_pk_bf16_f32 v70, v44, v45
    v_cvt_pk_bf16_f32 v71, v46, v47
    v_mfma_f32_32x32x16_bf16 v[32:47], a[96:99], a[188:191], 0
    v_exp_f32 v48, v48
    v_exp_f32 v49, v49
    v_exp_f32 v50, v50
    v_cvt_pk_bf16_f32 v64, v48, v49
    v_exp_f32 v51, v51
    v_mfma_f32_32x32x16_bf16 v[128:143], a[108:111], v[68:71], v[128:143]
    v_cvt_pk_bf16_f32 v65, v50, v51
    v_exp_f32 v52, v52
    v_exp_f32 v53, v53
    v_exp_f32 v54, v54
    v_cvt_pk_bf16_f32 v66, v52, v53
    v_exp_f32 v55, v55
    v_mfma_f32_32x32x16_bf16 v[32:47], a[100:103], a[192:195], v[32:47]
    v_cvt_pk_bf16_f32 v67, v54, v55
    v_exp_f32 v56, v56
    v_exp_f32 v57, v57
    v_exp_f32 v58, v58
    v_cvt_pk_bf16_f32 v68, v56, v57
    v_exp_f32 v59, v59
    v_mfma_f32_32x32x16_bf16 v[144:159], a[104:107], v[64:67], v[144:159]
    v_cvt_pk_bf16_f32 v69, v58, v59
    v_exp_f32 v60, v60
    v_exp_f32 v61, v61
    v_exp_f32 v62, v62
    v_exp_f32 v63, v63
    v_cvt_pk_bf16_f32 v70, v60, v61
    v_cvt_pk_bf16_f32 v71, v62, v63
    v_mfma_f32_32x32x16_bf16 v[48:63], a[96:99], a[196:199], 0
    buffer_load_dwordx4 a[80:83], v123, s[52:55], s91 offen offset:0 sc1
    buffer_load_dwordx4 a[84:87], v123, s[52:55], s91 offen offset:1024 sc1
    buffer_load_dwordx4 a[88:91], v123, s[52:55], s91 offen offset:2048 sc1
    buffer_load_dwordx4 a[92:95], v123, s[52:55], s91 offen offset:3072 sc1
    v_exp_f32 v32, v32
    v_exp_f32 v33, v33
    v_exp_f32 v34, v34
    v_cvt_pk_bf16_f32 v64, v32, v33
    v_exp_f32 v35, v35
    v_mfma_f32_32x32x16_bf16 v[144:159], a[108:111], v[68:71], v[144:159]
    v_cvt_pk_bf16_f32 v65, v34, v35
    v_exp_f32 v36, v36
    v_exp_f32 v37, v37
    v_exp_f32 v38, v38
    v_cvt_pk_bf16_f32 v66, v36, v37
    v_exp_f32 v39, v39
    v_mfma_f32_32x32x16_bf16 v[48:63], a[100:103], a[200:203], v[48:63]
    s_xor_b32 s91, s72, 61440
    v_cvt_pk_bf16_f32 v67, v38, v39
    v_exp_f32 v40, v40
    v_exp_f32 v41, v41
    v_exp_f32 v42, v42
    v_cvt_pk_bf16_f32 v68, v40, v41
    v_exp_f32 v43, v43
    v_mfma_f32_32x32x16_bf16 v[160:175], a[104:107], v[64:67], v[160:175]
    s_waitcnt vmcnt(26)
    v_cvt_pk_bf16_f32 v69, v42, v43
    v_exp_f32 v44, v44
    v_exp_f32 v45, v45
    v_exp_f32 v46, v46
    v_exp_f32 v47, v47
    v_cvt_pk_bf16_f32 v70, v44, v45
    v_cvt_pk_bf16_f32 v71, v46, v47
    v_mfma_f32_32x32x16_bf16 v[32:47], a[112:115], v[104:107], 0
    v_exp_f32 v48, v48
    v_exp_f32 v49, v49
    v_exp_f32 v50, v50
    v_cvt_pk_bf16_f32 v64, v48, v49
    v_exp_f32 v51, v51
    v_mfma_f32_32x32x16_bf16 v[160:175], a[108:111], v[68:71], v[160:175]
    v_cvt_pk_bf16_f32 v65, v50, v51
    v_exp_f32 v52, v52
    v_exp_f32 v53, v53
    v_exp_f32 v54, v54
    v_cvt_pk_bf16_f32 v66, v52, v53
    v_exp_f32 v55, v55
    v_mfma_f32_32x32x16_bf16 v[32:47], a[116:119], v[108:111], v[32:47]
    v_cvt_pk_bf16_f32 v67, v54, v55
    v_exp_f32 v56, v56
    v_exp_f32 v57, v57
    v_exp_f32 v58, v58
    v_cvt_pk_bf16_f32 v68, v56, v57
    v_exp_f32 v59, v59
    v_mfma_f32_32x32x16_bf16 v[176:191], a[104:107], v[64:67], v[176:191]
    v_cvt_pk_bf16_f32 v69, v58, v59
    v_exp_f32 v60, v60
    v_exp_f32 v61, v61
    v_exp_f32 v62, v62
    v_exp_f32 v63, v63
    v_cvt_pk_bf16_f32 v70, v60, v61
    v_cvt_pk_bf16_f32 v71, v62, v63
    v_mfma_f32_32x32x16_bf16 v[48:63], a[112:115], a[180:183], 0
    v_exp_f32 v32, v32
    v_exp_f32 v33, v33
    v_exp_f32 v34, v34
    v_cvt_pk_bf16_f32 v64, v32, v33
    v_exp_f32 v35, v35
    v_mfma_f32_32x32x16_bf16 v[176:191], a[108:111], v[68:71], v[176:191]
    v_cvt_pk_bf16_f32 v65, v34, v35
    v_exp_f32 v36, v36
    v_exp_f32 v37, v37
    v_exp_f32 v38, v38
    v_cvt_pk_bf16_f32 v66, v36, v37
    v_exp_f32 v39, v39
    v_mfma_f32_32x32x16_bf16 v[48:63], a[116:119], a[184:187], v[48:63]
    s_waitcnt vmcnt(24)
    v_cvt_pk_bf16_f32 v67, v38, v39
    v_exp_f32 v40, v40
    v_exp_f32 v41, v41
    v_exp_f32 v42, v42
    v_cvt_pk_bf16_f32 v68, v40, v41
    v_exp_f32 v43, v43
    v_mfma_f32_32x32x16_bf16 v[128:143], a[120:123], v[64:67], v[128:143]
    v_cvt_pk_bf16_f32 v69, v42, v43
    v_exp_f32 v44, v44
    v_exp_f32 v45, v45
    v_exp_f32 v46, v46
    v_exp_f32 v47, v47
    v_cvt_pk_bf16_f32 v70, v44, v45
    v_cvt_pk_bf16_f32 v71, v46, v47
    v_mfma_f32_32x32x16_bf16 v[32:47], a[112:115], a[188:191], 0
    v_exp_f32 v48, v48
    v_exp_f32 v49, v49
    v_exp_f32 v50, v50
    v_cvt_pk_bf16_f32 v64, v48, v49
    v_exp_f32 v51, v51
    v_mfma_f32_32x32x16_bf16 v[128:143], a[124:127], v[68:71], v[128:143]
    v_cvt_pk_bf16_f32 v65, v50, v51
    v_exp_f32 v52, v52
    v_exp_f32 v53, v53
    v_exp_f32 v54, v54
    v_cvt_pk_bf16_f32 v66, v52, v53
    v_exp_f32 v55, v55
    v_mfma_f32_32x32x16_bf16 v[32:47], a[116:119], a[192:195], v[32:47]
    v_cvt_pk_bf16_f32 v67, v54, v55
    v_exp_f32 v56, v56
    v_exp_f32 v57, v57
    v_exp_f32 v58, v58
    v_cvt_pk_bf16_f32 v68, v56, v57
    v_exp_f32 v59, v59
    v_mfma_f32_32x32x16_bf16 v[144:159], a[120:123], v[64:67], v[144:159]
    v_cvt_pk_bf16_f32 v69, v58, v59
    v_exp_f32 v60, v60
    v_exp_f32 v61, v61
    v_exp_f32 v62, v62
    v_exp_f32 v63, v63
    v_cvt_pk_bf16_f32 v70, v60, v61
    v_cvt_pk_bf16_f32 v71, v62, v63
    v_mfma_f32_32x32x16_bf16 v[48:63], a[112:115], a[196:199], 0
    buffer_load_dwordx4 a[96:99], v123, s[52:55], s91 offen offset:0 sc1
    buffer_load_dwordx4 a[100:103], v123, s[52:55], s91 offen offset:1024 sc1
    buffer_load_dwordx4 a[104:107], v123, s[52:55], s91 offen offset:2048 sc1
    buffer_load_dwordx4 a[108:111], v123, s[52:55], s91 offen offset:3072 sc1
    v_exp_f32 v32, v32
    v_exp_f32 v33, v33
    v_exp_f32 v34, v34
    v_cvt_pk_bf16_f32 v64, v32, v33
    v_exp_f32 v35, v35
    v_mfma_f32_32x32x16_bf16 v[144:159], a[124:127], v[68:71], v[144:159]
    v_cvt_pk_bf16_f32 v65, v34, v35
    v_exp_f32 v36, v36
    v_exp_f32 v37, v37
    v_exp_f32 v38, v38
    v_cvt_pk_bf16_f32 v66, v36, v37
    v_exp_f32 v39, v39
    v_mfma_f32_32x32x16_bf16 v[48:63], a[116:119], a[200:203], v[48:63]
    v_cvt_pk_bf16_f32 v67, v38, v39
    v_exp_f32 v40, v40
    v_exp_f32 v41, v41
    v_exp_f32 v42, v42
    v_cvt_pk_bf16_f32 v68, v40, v41
    v_exp_f32 v43, v43
    v_mfma_f32_32x32x16_bf16 v[160:175], a[120:123], v[64:67], v[160:175]
    s_waitcnt vmcnt(26)
    v_cvt_pk_bf16_f32 v69, v42, v43
    v_exp_f32 v44, v44
    v_exp_f32 v45, v45
    v_exp_f32 v46, v46
    v_exp_f32 v47, v47
    v_cvt_pk_bf16_f32 v70, v44, v45
    v_cvt_pk_bf16_f32 v71, v46, v47
    v_mfma_f32_32x32x16_bf16 v[32:47], a[0:3], v[104:107], 0
    v_exp_f32 v48, v48
    v_exp_f32 v49, v49
    v_exp_f32 v50, v50
    v_cvt_pk_bf16_f32 v64, v48, v49
    v_exp_f32 v51, v51
    v_mfma_f32_32x32x16_bf16 v[160:175], a[124:127], v[68:71], v[160:175]
    v_cvt_pk_bf16_f32 v65, v50, v51
    v_exp_f32 v52, v52
    v_exp_f32 v53, v53
    v_exp_f32 v54, v54
    v_cvt_pk_bf16_f32 v66, v52, v53
    v_exp_f32 v55, v55
    v_mfma_f32_32x32x16_bf16 v[32:47], a[4:7], v[108:111], v[32:47]
    v_cvt_pk_bf16_f32 v67, v54, v55
    v_exp_f32 v56, v56
    v_exp_f32 v57, v57
    v_exp_f32 v58, v58
    v_cvt_pk_bf16_f32 v68, v56, v57
    v_exp_f32 v59, v59
    v_mfma_f32_32x32x16_bf16 v[176:191], a[120:123], v[64:67], v[176:191]
    v_cvt_pk_bf16_f32 v69, v58, v59
    v_exp_f32 v60, v60
    v_exp_f32 v61, v61
    v_exp_f32 v62, v62
    v_exp_f32 v63, v63
    v_cvt_pk_bf16_f32 v70, v60, v61
    v_cvt_pk_bf16_f32 v71, v62, v63
    v_mfma_f32_32x32x16_bf16 v[48:63], a[0:3], a[180:183], 0
    v_exp_f32 v32, v32
    v_exp_f32 v33, v33
    v_exp_f32 v34, v34
    v_cvt_pk_bf16_f32 v64, v32, v33
    v_exp_f32 v35, v35
    v_mfma_f32_32x32x16_bf16 v[176:191], a[124:127], v[68:71], v[176:191]
    v_cvt_pk_bf16_f32 v65, v34, v35
    v_exp_f32 v36, v36
    v_exp_f32 v37, v37
    v_exp_f32 v38, v38
    v_cvt_pk_bf16_f32 v66, v36, v37
    v_exp_f32 v39, v39
    v_mfma_f32_32x32x16_bf16 v[48:63], a[4:7], a[184:187], v[48:63]
    s_waitcnt vmcnt(24)
    v_cvt_pk_bf16_f32 v67, v38, v39
    v_exp_f32 v40, v40
    v_exp_f32 v41, v41
    v_exp_f32 v42, v42
    v_cvt_pk_bf16_f32 v68, v40, v41
    v_exp_f32 v43, v43
    v_mfma_f32_32x32x16_bf16 v[128:143], a[8:11], v[64:67], v[128:143]
    v_cvt_pk_bf16_f32 v69, v42, v43
    v_exp_f32 v44, v44
    v_exp_f32 v45, v45
    v_exp_f32 v46, v46
    v_exp_f32 v47, v47
    v_cvt_pk_bf16_f32 v70, v44, v45
    v_cvt_pk_bf16_f32 v71, v46, v47
    v_mfma_f32_32x32x16_bf16 v[32:47], a[0:3], a[188:191], 0
    v_exp_f32 v48, v48
    v_exp_f32 v49, v49
    v_exp_f32 v50, v50
    v_cvt_pk_bf16_f32 v64, v48, v49
    v_exp_f32 v51, v51
    v_mfma_f32_32x32x16_bf16 v[128:143], a[12:15], v[68:71], v[128:143]
    v_cvt_pk_bf16_f32 v65, v50, v51
    v_exp_f32 v52, v52
    v_exp_f32 v53, v53
    v_exp_f32 v54, v54
    v_cvt_pk_bf16_f32 v66, v52, v53
    v_exp_f32 v55, v55
    v_mfma_f32_32x32x16_bf16 v[32:47], a[4:7], a[192:195], v[32:47]
    v_cvt_pk_bf16_f32 v67, v54, v55
    v_exp_f32 v56, v56
    v_exp_f32 v57, v57
    v_exp_f32 v58, v58
    v_cvt_pk_bf16_f32 v68, v56, v57
    v_exp_f32 v59, v59
    v_mfma_f32_32x32x16_bf16 v[144:159], a[8:11], v[64:67], v[144:159]
    v_cvt_pk_bf16_f32 v69, v58, v59
    v_exp_f32 v60, v60
    v_exp_f32 v61, v61
    v_exp_f32 v62, v62
    v_exp_f32 v63, v63
    v_cvt_pk_bf16_f32 v70, v60, v61
    v_cvt_pk_bf16_f32 v71, v62, v63
    v_mfma_f32_32x32x16_bf16 v[48:63], a[0:3], a[196:199], 0
    v_exp_f32 v32, v32
L_page_11:
    s_cbranch_vccnz L_page_ret1
    v_exp_f32 v33, v33
    v_exp_f32 v34, v34
    v_cvt_pk_bf16_f32 v64, v32, v33
    v_exp_f32 v35, v35
    v_mfma_f32_32x32x16_bf16 v[144:159], a[12:15], v[68:71], v[144:159]
    v_cvt_pk_bf16_f32 v65, v34, v35
    v_exp_f32 v36, v36
    v_exp_f32 v37, v37
    v_exp_f32 v38, v38
    v_cvt_pk_bf16_f32 v66, v36, v37
    v_exp_f32 v39, v39
    v_mfma_f32_32x32x16_bf16 v[48:63], a[4:7], a[200:203], v[48:63]
    v_cvt_pk_bf16_f32 v67, v38, v39
    v_exp_f32 v40, v40
    v_exp_f32 v41, v41
    v_exp_f32 v42, v42
    v_cvt_pk_bf16_f32 v68, v40, v41
    v_exp_f32 v43, v43
    v_mfma_f32_32x32x16_bf16 v[160:175], a[8:11], v[64:67], v[160:175]
    s_waitcnt vmcnt(22)
    v_cvt_pk_bf16_f32 v69, v42, v43
    v_exp_f32 v44, v44
    v_exp_f32 v45, v45
    v_exp_f32 v46, v46
    v_exp_f32 v47, v47
    v_cvt_pk_bf16_f32 v70, v44, v45
    v_cvt_pk_bf16_f32 v71, v46, v47
    v_mfma_f32_32x32x16_bf16 v[32:47], a[16:19], v[104:107], 0
    v_exp_f32 v48, v48
    v_exp_f32 v49, v49
    v_exp_f32 v50, v50
    v_cvt_pk_bf16_f32 v64, v48, v49
    v_exp_f32 v51, v51
    v_mfma_f32_32x32x16_bf16 v[160:175], a[12:15], v[68:71], v[160:175]
    v_cvt_pk_bf16_f32 v65, v50, v51
    v_exp_f32 v52, v52
    v_exp_f32 v53, v53
    v_exp_f32 v54, v54
    v_cvt_pk_bf16_f32 v66, v52, v53
    v_exp_f32 v55, v55
    v_mfma_f32_32x32x16_bf16 v[32:47], a[20:23], v[108:111], v[32:47]
    v_cvt_pk_bf16_f32 v67, v54, v55
    v_exp_f32 v56, v56
    v_exp_f32 v57, v57
    v_exp_f32 v58, v58
    v_cvt_pk_bf16_f32 v68, v56, v57
    v_exp_f32 v59, v59
    v_mfma_f32_32x32x16_bf16 v[176:191], a[8:11], v[64:67], v[176:191]
    v_cvt_pk_bf16_f32 v69, v58, v59
    v_exp_f32 v60, v60
    v_exp_f32 v61, v61
    v_exp_f32 v62, v62
    v_exp_f32 v63, v63
    v_cvt_pk_bf16_f32 v70, v60, v61
    v_cvt_pk_bf16_f32 v71, v62, v63
    v_mfma_f32_32x32x16_bf16 v[48:63], a[16:19], a[180:183], 0
    v_exp_f32 v32, v32
    v_exp_f32 v33, v33
    v_exp_f32 v34, v34
    v_cvt_pk_bf16_f32 v64, v32, v33
    v_exp_f32 v35, v35
    v_mfma_f32_32x32x16_bf16 v[176:191], a[12:15], v[68:71], v[176:191]
    v_cvt_pk_bf16_f32 v65, v34, v35
    v_exp_f32 v36, v36
    v_exp_f32 v37, v37
    v_exp_f32 v38, v38
    v_cvt_pk_bf16_f32 v66, v36, v37
    v_exp_f32 v39, v39
    v_mfma_f32_32x32x16_bf16 v[48:63], a[20:23], a[184:187], v[48:63]
    s_waitcnt vmcnt(20)
    v_cvt_pk_bf16_f32 v67, v38, v39
    v_exp_f32 v40, v40
    v_exp_f32 v41, v41
    v_exp_f32 v42, v42
    v_cvt_pk_bf16_f32 v68, v40, v41
    v_exp_f32 v43, v43
    v_mfma_f32_32x32x16_bf16 v[128:143], a[24:27], v[64:67], v[128:143]
    v_cvt_pk_bf16_f32 v69, v42, v43
    v_exp_f32 v44, v44
    v_exp_f32 v45, v45
    v_exp_f32 v46, v46
    v_exp_f32 v47, v47
    v_cvt_pk_bf16_f32 v70, v44, v45
    v_cvt_pk_bf16_f32 v71, v46, v47
    v_mfma_f32_32x32x16_bf16 v[32:47], a[16:19], a[188:191], 0
    v_exp_f32 v48, v48
    v_exp_f32 v49, v49
    v_exp_f32 v50, v50
    v_cvt_pk_bf16_f32 v64, v48, v49
    v_exp_f32 v51, v51
    v_mfma_f32_32x32x16_bf16 v[128:143], a[28:31], v[68:71], v[128:143]
    v_cvt_pk_bf16_f32 v65, v50, v51
    v_exp_f32 v52, v52
    v_exp_f32 v53, v53
    v_exp_f32 v54, v54
    v_cvt_pk_bf16_f32 v66, v52, v53
    v_exp_f32 v55, v55
    v_mfma_f32_32x32x16_bf16 v[32:47], a[20:23], a[192:195], v[32:47]
    v_cvt_pk_bf16_f32 v67, v54, v55
    v_exp_f32 v56, v56
    v_exp_f32 v57, v57
    v_exp_f32 v58, v58
    v_cvt_pk_bf16_f32 v68, v56, v57
    v_exp_f32 v59, v59
    v_mfma_f32_32x32x16_bf16 v[144:159], a[24:27], v[64:67], v[144:159]
    v_cvt_pk_bf16_f32 v69, v58, v59
    v_exp_f32 v60, v60
    v_exp_f32 v61, v61
    v_exp_f32 v62, v62
    v_exp_f32 v63, v63
    v_cvt_pk_bf16_f32 v70, v60, v61
    v_cvt_pk_bf16_f32 v71, v62, v63
    v_mfma_f32_32x32x16_bf16 v[48:63], a[16:19], a[196:199], 0
    v_exp_f32 v32, v32
    v_exp_f32 v33, v33
    v_exp_f32 v34, v34
    v_cvt_pk_bf16_f32 v64, v32, v33
    v_exp_f32 v35, v35
    v_mfma_f32_32x32x16_bf16 v[144:159], a[28:31], v[68:71], v[144:159]
    v_cvt_pk_bf16_f32 v65, v34, v35
    v_exp_f32 v36, v36
    v_exp_f32 v37, v37
    v_exp_f32 v38, v38
    v_cvt_pk_bf16_f32 v66, v36, v37
    v_exp_f32 v39, v39
    v_mfma_f32_32x32x16_bf16 v[48:63], a[20:23], a[200:203], v[48:63]
    v_cvt_pk_bf16_f32 v67, v38, v39
    v_exp_f32 v40, v40
    v_exp_f32 v41, v41
    v_exp_f32 v42, v42
    v_cvt_pk_bf16_f32 v68, v40, v41
    v_exp_f32 v43, v43
    v_mfma_f32_32x32x16_bf16 v[160:175], a[24:27], v[64:67], v[160:175]
    s_waitcnt vmcnt(18)
    v_cvt_pk_bf16_f32 v69, v42, v43
    v_exp_f32 v44, v44
    v_exp_f32 v45, v45
    v_exp_f32 v46, v46
    v_exp_f32 v47, v47
    v_cvt_pk_bf16_f32 v70, v44, v45
    v_cvt_pk_bf16_f32 v71, v46, v47
    v_mfma_f32_32x32x16_bf16 v[32:47], a[32:35], v[104:107], 0
    v_exp_f32 v48, v48
    v_exp_f32 v49, v49
    v_exp_f32 v50, v50
    v_cvt_pk_bf16_f32 v64, v48, v49
    v_exp_f32 v51, v51
    v_mfma_f32_32x32x16_bf16 v[160:175], a[28:31], v[68:71], v[160:175]
    v_cvt_pk_bf16_f32 v65, v50, v51
    v_exp_f32 v52, v52
    v_exp_f32 v53, v53
    v_exp_f32 v54, v54
    v_cvt_pk_bf16_f32 v66, v52, v53
    v_exp_f32 v55, v55
    v_mfma_f32_32x32x16_bf16 v[32:47], a[36:39], v[108:111], v[32:47]
    v_cvt_pk_bf16_f32 v67, v54, v55
    v_exp_f32 v56, v56
    v_exp_f32 v57, v57
    v_exp_f32 v58, v58
    v_cvt_pk_bf16_f32 v68, v56, v57
    v_exp_f32 v59, v59
    v_mfma_f32_32x32x16_bf16 v[176:191], a[24:27], v[64:67], v[176:191]
    v_cvt_pk_bf16_f32 v69, v58, v59
    v_exp_f32 v60, v60
    v_exp_f32 v61, v61
    v_exp_f32 v62, v62
    v_exp_f32 v63, v63
    v_cvt_pk_bf16_f32 v70, v60, v61
    v_cvt_pk_bf16_f32 v71, v62, v63
    v_mfma_f32_32x32x16_bf16 v[48:63], a[32:35], a[180:183], 0
    v_exp_f32 v32, v32
    v_exp_f32 v33, v33
    v_exp_f32 v34, v34
    v_cvt_pk_bf16_f32 v64, v32, v33
    v_exp_f32 v35, v35
    v_mfma_f32_32x32x16_bf16 v[176:191], a[28:31], v[68:71], v[176:191]
    v_cvt_pk_bf16_f32 v65, v34, v35
    v_exp_f32 v36, v36
    v_exp_f32 v37, v37
    v_exp_f32 v38, v38
    v_cvt_pk_bf16_f32 v66, v36, v37
    v_exp_f32 v39, v39
    v_mfma_f32_32x32x16_bf16 v[48:63], a[36:39], a[184:187], v[48:63]
    s_waitcnt vmcnt(16)
    v_cvt_pk_bf16_f32 v67, v38, v39
    v_exp_f32 v40, v40
    v_exp_f32 v41, v41
    v_exp_f32 v42, v42
    v_cvt_pk_bf16_f32 v68, v40, v41
    v_exp_f32 v43, v43
    v_mfma_f32_32x32x16_bf16 v[128:143], a[40:43], v[64:67], v[128:143]
    v_cvt_pk_bf16_f32 v69, v42, v43
    v_exp_f32 v44, v44
    v_exp_f32 v45, v45
    v_exp_f32 v46, v46
    v_exp_f32 v47, v47
    v_cvt_pk_bf16_f32 v70, v44, v45
    v_cvt_pk_bf16_f32 v71, v46, v47
    v_mfma_f32_32x32x16_bf16 v[32:47], a[32:35], a[188:191], 0
    v_exp_f32 v48, v48
    v_exp_f32 v49, v49
    v_exp_f32 v50, v50
    v_cvt_pk_bf16_f32 v64, v48, v49
    v_exp_f32 v51, v51
    v_mfma_f32_32x32x16_bf16 v[128:143], a[44:47], v[68:71], v[128:143]
    v_cvt_pk_bf16_f32 v65, v50, v51
    v_exp_f32 v52, v52
    v_exp_f32 v53, v53
    v_exp_f32 v54, v54
    v_cvt_pk_bf16_f32 v66, v52, v53
    v_exp_f32 v55, v55
    v_mfma_f32_32x32x16_bf16 v[32:47], a[36:39], a[192:195], v[32:47]
    v_cvt_pk_bf16_f32 v67, v54, v55
    v_exp_f32 v56, v56
    v_exp_f32 v57, v57
    v_exp_f32 v58, v58
    v_cvt_pk_bf16_f32 v68, v56, v57
    v_exp_f32 v59, v59
    v_mfma_f32_32x32x16_bf16 v[144:159], a[40:43], v[64:67], v[144:159]
    v_cvt_pk_bf16_f32 v69, v58, v59
    v_exp_f32 v60, v60
    v_exp_f32 v61, v61
    v_exp_f32 v62, v62
    v_exp_f32 v63, v63
    v_cvt_pk_bf16_f32 v70, v60, v61
    v_cvt_pk_bf16_f32 v71, v62, v63
    v_mfma_f32_32x32x16_bf16 v[48:63], a[32:35], a[196:199], 0
    v_exp_f32 v32, v32
    v_exp_f32 v33, v33
    v_exp_f32 v34, v34
    v_cvt_pk_bf16_f32 v64, v32, v33
    v_exp_f32 v35, v35
    v_mfma_f32_32x32x16_bf16 v[144:159], a[44:47], v[68:71], v[144:159]
    v_cvt_pk_bf16_f32 v65, v34, v35
    v_exp_f32 v36, v36
    v_exp_f32 v37, v37
    v_exp_f32 v38, v38
    v_cvt_pk_bf16_f32 v66, v36, v37
    v_exp_f32 v39, v39
    v_mfma_f32_32x32x16_bf16 v[48:63], a[36:39], a[200:203], v[48:63]
    v_cvt_pk_bf16_f32 v67, v38, v39
    v_exp_f32 v40, v40
    v_exp_f32 v41, v41
    v_exp_f32 v42, v42
    v_cvt_pk_bf16_f32 v68, v40, v41
    v_exp_f32 v43, v43
    v_mfma_f32_32x32x16_bf16 v[160:175], a[40:43], v[64:67], v[160:175]
    s_waitcnt vmcnt(14)
    v_cvt_pk_bf16_f32 v69, v42, v43
    v_exp_f32 v44, v44
    v_exp_f32 v45, v45
    v_exp_f32 v46, v46
    v_exp_f32 v47, v47
    v_cvt_pk_bf16_f32 v70, v44, v45
    v_cvt_pk_bf16_f32 v71, v46, v47
    v_mfma_f32_32x32x16_bf16 v[32:47], a[48:51], v[104:107], 0
    v_exp_f32 v48, v48
    v_exp_f32 v49, v49
    v_exp_f32 v50, v50
    v_cvt_pk_bf16_f32 v64, v48, v49
    v_exp_f32 v51, v51
    v_mfma_f32_32x32x16_bf16 v[160:175], a[44:47], v[68:71], v[160:175]
    v_cvt_pk_bf16_f32 v65, v50, v51
    v_exp_f32 v52, v52
    v_exp_f32 v53, v53
    v_exp_f32 v54, v54
    v_cvt_pk_bf16_f32 v66, v52, v53
    v_exp_f32 v55, v55
    v_mfma_f32_32x32x16_bf16 v[32:47], a[52:55], v[108:111], v[32:47]
    v_cvt_pk_bf16_f32 v67, v54, v55
    v_exp_f32 v56, v56
    v_exp_f32 v57, v57
    v_exp_f32 v58, v58
    v_cvt_pk_bf16_f32 v68, v56, v57
    v_exp_f32 v59, v59
    v_mfma_f32_32x32x16_bf16 v[176:191], a[40:43], v[64:67], v[176:191]
    v_cvt_pk_bf16_f32 v69, v58, v59
    v_exp_f32 v60, v60
    v_exp_f32 v61, v61
    v_exp_f32 v62, v62
    v_exp_f32 v63, v63
    v_cvt_pk_bf16_f32 v70, v60, v61
    v_cvt_pk_bf16_f32 v71, v62, v63
    v_mfma_f32_32x32x16_bf16 v[48:63], a[48:51], a[180:183], 0
    v_exp_f32 v32, v32
    v_exp_f32 v33, v33
    v_exp_f32 v34, v34
    v_cvt_pk_bf16_f32 v64, v32, v33
    v_exp_f32 v35, v35
    v_mfma_f32_32x32x16_bf16 v[176:191], a[44:47], v[68:71], v[176:191]
    v_cvt_pk_bf16_f32 v65, v34, v35
    v_exp_f32 v36, v36
    v_exp_f32 v37, v37
    v_exp_f32 v38, v38
    v_cvt_pk_bf16_f32 v66, v36, v37
    v_exp_f32 v39, v39
    v_mfma_f32_32x32x16_bf16 v[48:63], a[52:55], a[184:187], v[48:63]
    s_waitcnt vmcnt(12)
    v_cvt_pk_bf16_f32 v67, v38, v39
    v_exp_f32 v40, v40
    v_exp_f32 v41, v41
    v_exp_f32 v42, v42
    v_cvt_pk_bf16_f32 v68, v40, v41
    v_exp_f32 v43, v43
    v_mfma_f32_32x32x16_bf16 v[128:143], a[56:59], v[64:67], v[128:143]
    v_cvt_pk_bf16_f32 v69, v42, v43
    v_exp_f32 v44, v44
    v_exp_f32 v45, v45
    v_exp_f32 v46, v46
    v_exp_f32 v47, v47
    v_cvt_pk_bf16_f32 v70, v44, v45
    v_cvt_pk_bf16_f32 v71, v46, v47
    v_mfma_f32_32x32x16_bf16 v[32:47], a[48:51], a[188:191], 0
    v_exp_f32 v48, v48
    v_exp_f32 v49, v49
    v_exp_f32 v50, v50
    v_cvt_pk_bf16_f32 v64, v48, v49
    v_exp_f32 v51, v51
    v_mfma_f32_32x32x16_bf16 v[128:143], a[60:63], v[68:71], v[128:143]
    v_cvt_pk_bf16_f32 v65, v50, v51
    v_exp_f32 v52, v52
    v_exp_f32 v53, v53
    v_exp_f32 v54, v54
    v_cvt_pk_bf16_f32 v66, v52, v53
    v_exp_f32 v55, v55
    v_mfma_f32_32x32x16_bf16 v[32:47], a[52:55], a[192:195], v[32:47]
    v_cvt_pk_bf16_f32 v67, v54, v55
    v_exp_f32 v56, v56
    v_exp_f32 v57, v57
    v_exp_f32 v58, v58
    v_cvt_pk_bf16_f32 v68, v56, v57
    v_exp_f32 v59, v59
    v_mfma_f32_32x32x16_bf16 v[144:159], a[56:59], v[64:67], v[144:159]
    v_cvt_pk_bf16_f32 v69, v58, v59
    v_exp_f32 v60, v60
    v_exp_f32 v61, v61
    v_exp_f32 v62, v62
    v_exp_f32 v63, v63
    v_cvt_pk_bf16_f32 v70, v60, v61
    v_cvt_pk_bf16_f32 v71, v62, v63
    v_mfma_f32_32x32x16_bf16 v[48:63], a[48:51], a[196:199], 0
    v_exp_f32 v32, v32
    v_exp_f32 v33, v33
    v_exp_f32 v34, v34
    v_cvt_pk_bf16_f32 v64, v32, v33
    v_exp_f32 v35, v35
    v_mfma_f32_32x32x16_bf16 v[144:159], a[60:63], v[68:71], v[144:159]
    v_cvt_pk_bf16_f32 v65, v34, v35
    v_exp_f32 v36, v36
    v_exp_f32 v37, v37
    v_exp_f32 v38, v38
    v_cvt_pk_bf16_f32 v66, v36, v37
    v_exp_f32 v39, v39
    v_mfma_f32_32x32x16_bf16 v[48:63], a[52:55], a[200:203], v[48:63]
    v_cvt_pk_bf16_f32 v67, v38, v39
    v_exp_f32 v40, v40
    v_exp_f32 v41, v41
    v_exp_f32 v42, v42
    v_cvt_pk_bf16_f32 v68, v40, v41
    v_exp_f32 v43, v43
    v_mfma_f32_32x32x16_bf16 v[160:175], a[56:59], v[64:67], v[160:175]
    s_waitcnt vmcnt(10)
    v_cvt_pk_bf16_f32 v69, v42, v43
    v_exp_f32 v44, v44
    v_exp_f32 v45, v45
    v_exp_f32 v46, v46
    v_exp_f32 v47, v47
    v_cvt_pk_bf16_f32 v70, v44, v45
    v_cvt_pk_bf16_f32 v71, v46, v47
    v_mfma_f32_32x32x16_bf16 v[32:47], a[64:67], v[104:107], 0
    v_exp_f32 v48, v48
    v_exp_f32 v49, v49
    v_exp_f32 v50, v50
    v_cvt_pk_bf16_f32 v64, v48, v49
    v_exp_f32 v51, v51
    v_mfma_f32_32x32x16_bf16 v[160:175], a[60:63], v[68:71], v[160:175]
    v_cvt_pk_bf16_f32 v65, v50, v51
    v_exp_f32 v52, v52
    v_exp_f32 v53, v53
    v_exp_f32 v54, v54
    v_cvt_pk_bf16_f32 v66, v52, v53
    v_exp_f32 v55, v55
    v_mfma_f32_32x32x16_bf16 v[32:47], a[68:71], v[108:111], v[32:47]
    v_cvt_pk_bf16_f32 v67, v54, v55
    v_exp_f32 v56, v56
    v_exp_f32 v57, v57
    v_exp_f32 v58, v58
    v_cvt_pk_bf16_f32 v68, v56, v57
    v_exp_f32 v59, v59
    v_mfma_f32_32x32x16_bf16 v[176:191], a[56:59], v[64:67], v[176:191]
    v_cvt_pk_bf16_f32 v69, v58, v59
    v_exp_f32 v60, v60
    v_exp_f32 v61, v61
    v_exp_f32 v62, v62
    v_exp_f32 v63, v63
    v_cvt_pk_bf16_f32 v70, v60, v61
    v_cvt_pk_bf16_f32 v71, v62, v63
    v_mfma_f32_32x32x16_bf16 v[48:63], a[64:67], a[180:183], 0
    v_exp_f32 v32, v32
    v_exp_f32 v33, v33
    v_exp_f32 v34, v34
    v_cvt_pk_bf16_f32 v64, v32, v33
    v_exp_f32 v35, v35
    v_mfma_f32_32x32x16_bf16 v[176:191], a[60:63], v[68:71], v[176:191]
    v_cvt_pk_bf16_f32 v65, v34, v35
    v_exp_f32 v36, v36
    v_exp_f32 v37, v37
    v_exp_f32 v38, v38
    v_cvt_pk_bf16_f32 v66, v36, v37
    v_exp_f32 v39, v39
    v_mfma_f32_32x32x16_bf16 v[48:63], a[68:71], a[184:187], v[48:63]
    s_waitcnt vmcnt(8)
    v_cvt_pk_bf16_f32 v67, v38, v39
    v_exp_f32 v40, v40
    v_exp_f32 v41, v41
    v_exp_f32 v42, v42
    v_cvt_pk_bf16_f32 v68, v40, v41
    v_exp_f32 v43, v43
    v_mfma_f32_32x32x16_bf16 v[128:143], a[72:75], v[64:67], v[128:143]
    v_cvt_pk_bf16_f32 v69, v42, v43
    v_exp_f32 v44, v44
    v_exp_f32 v45, v45
    v_exp_f32 v46, v46
    v_exp_f32 v47, v47
    v_cvt_pk_bf16_f32 v70, v44, v45
    v_cvt_pk_bf16_f32 v71, v46, v47
    v_mfma_f32_32x32x16_bf16 v[32:47], a[64:67], a[188:191], 0
    v_exp_f32 v48, v48
    v_exp_f32 v49, v49
    v_exp_f32 v50, v50
    v_cvt_pk_bf16_f32 v64, v48, v49
    v_exp_f32 v51, v51
    v_mfma_f32_32x32x16_bf16 v[128:143], a[76:79], v[68:71], v[128:143]
    v_cvt_pk_bf16_f32 v65, v50, v51
    v_exp_f32 v52, v52
    v_exp_f32 v53, v53
    v_exp_f32 v54, v54
    v_cvt_pk_bf16_f32 v66, v52, v53
    v_exp_f32 v55, v55
    v_mfma_f32_32x32x16_bf16 v[32:47], a[68:71], a[192:195], v[32:47]
    v_cvt_pk_bf16_f32 v67, v54, v55
    v_exp_f32 v56, v56
    v_exp_f32 v57, v57
    v_exp_f32 v58, v58
    v_cvt_pk_bf16_f32 v68, v56, v57
    v_exp_f32 v59, v59
    v_mfma_f32_32x32x16_bf16 v[144:159], a[72:75], v[64:67], v[144:159]
    v_cvt_pk_bf16_f32 v69, v58, v59
    v_exp_f32 v60, v60
    v_exp_f32 v61, v61
    v_exp_f32 v62, v62
    v_exp_f32 v63, v63
    v_cvt_pk_bf16_f32 v70, v60, v61
    v_cvt_pk_bf16_f32 v71, v62, v63
    v_mfma_f32_32x32x16_bf16 v[48:63], a[64:67], a[196:199], 0
    v_exp_f32 v32, v32
    v_exp_f32 v33, v33
    v_exp_f32 v34, v34
    v_cvt_pk_bf16_f32 v64, v32, v33
    v_exp_f32 v35, v35
    v_mfma_f32_32x32x16_bf16 v[144:159], a[76:79], v[68:71], v[144:159]
    v_cvt_pk_bf16_f32 v65, v34, v35
    v_exp_f32 v36, v36
    v_exp_f32 v37, v37
    v_exp_f32 v38, v38
    v_cvt_pk_bf16_f32 v66, v36, v37
    v_exp_f32 v39, v39
    v_mfma_f32_32x32x16_bf16 v[48:63], a[68:71], a[200:203], v[48:63]
    v_cvt_pk_bf16_f32 v67, v38, v39
    v_exp_f32 v40, v40
    v_exp_f32 v41, v41
    v_exp_f32 v42, v42
    v_cvt_pk_bf16_f32 v68, v40, v41
    v_exp_f32 v43, v43
    v_mfma_f32_32x32x16_bf16 v[160:175], a[72:75], v[64:67], v[160:175]
    s_waitcnt vmcnt(6)
    v_cvt_pk_bf16_f32 v69, v42, v43
    v_exp_f32 v44, v44
    v_exp_f32 v45, v45
    v_exp_f32 v46, v46
    v_exp_f32 v47, v47
    v_cvt_pk_bf16_f32 v70, v44, v45
    v_cvt_pk_bf16_f32 v71, v46, v47
    v_mfma_f32_32x32x16_bf16 v[32:47], a[80:83], a[180:183], 0
    v_exp_f32 v48, v48
    v_exp_f32 v49, v49
    v_exp_f32 v50, v50
    v_cvt_pk_bf16_f32 v64, v48, v49
    v_exp_f32 v51, v51
    v_mfma_f32_32x32x16_bf16 v[160:175], a[76:79], v[68:71], v[160:175]
    v_cvt_pk_bf16_f32 v65, v50, v51
    v_exp_f32 v52, v52
    v_exp_f32 v53, v53
    v_exp_f32 v54, v54
    v_cvt_pk_bf16_f32 v66, v52, v53
    v_exp_f32 v55, v55
    v_mfma_f32_32x32x16_bf16 v[32:47], a[84:87], a[184:187], v[32:47]
    v_cvt_pk_bf16_f32 v67, v54, v55
    v_exp_f32 v56, v56
    v_exp_f32 v57, v57
    v_exp_f32 v58, v58
    v_cvt_pk_bf16_f32 v68, v56, v57
    v_exp_f32 v59, v59
    v_mfma_f32_32x32x16_bf16 v[176:191], a[72:75], v[64:67], v[176:191]
    v_cvt_pk_bf16_f32 v69, v58, v59
    v_exp_f32 v60, v60
    v_exp_f32 v61, v61
    v_exp_f32 v62, v62
    v_exp_f32 v63, v63
    v_cvt_pk_bf16_f32 v70, v60, v61
    v_cvt_pk_bf16_f32 v71, v62, v63
    v_mfma_f32_32x32x16_bf16 v[48:63], a[80:83], a[188:191], 0
    v_exp_f32 v32, v32
    v_exp_f32 v33, v33
    v_exp_f32 v34, v34
    v_cvt_pk_bf16_f32 v64, v32, v33
    v_exp_f32 v35, v35
    v_mfma_f32_32x32x16_bf16 v[176:191], a[76:79], v[68:71], v[176:191]
    v_cvt_pk_bf16_f32 v65, v34, v35
    v_exp_f32 v36, v36
    v_exp_f32 v37, v37
    v_exp_f32 v38, v38
    v_cvt_pk_bf16_f32 v66, v36, v37
    v_exp_f32 v39, v39
    v_mfma_f32_32x32x16_bf16 v[48:63], a[84:87], a[192:195], v[48:63]
    s_waitcnt vmcnt(4)
    v_cvt_pk_bf16_f32 v67, v38, v39
    v_exp_f32 v40, v40
    v_exp_f32 v41, v41
    v_exp_f32 v42, v42
    v_cvt_pk_bf16_f32 v68, v40, v41
    v_exp_f32 v43, v43
    v_mfma_f32_32x32x16_bf16 v[144:159], a[88:91], v[64:67], v[144:159]
    v_cvt_pk_bf16_f32 v69, v42, v43
    v_exp_f32 v44, v44
    v_exp_f32 v45, v45
    v_exp_f32 v46, v46
    v_exp_f32 v47, v47
    v_cvt_pk_bf16_f32 v70, v44, v45
    v_cvt_pk_bf16_f32 v71, v46, v47
    v_mfma_f32_32x32x16_bf16 v[32:47], a[80:83], a[196:199], 0
    v_exp_f32 v48, v48
    v_exp_f32 v49, v49
    v_exp_f32 v50, v50
    v_cvt_pk_bf16_f32 v64, v48, v49
    v_exp_f32 v51, v51
    v_mfma_f32_32x32x16_bf16 v[144:159], a[92:95], v[68:71], v[144:159]
    v_cvt_pk_bf16_f32 v65, v50, v51
    v_exp_f32 v52, v52
    v_exp_f32 v53, v53
    v_exp_f32 v54, v54
    v_cvt_pk_bf16_f32 v66, v52, v53
    v_exp_f32 v55, v55
    v_mfma_f32_32x32x16_bf16 v[32:47], a[84:87], a[200:203], v[32:47]
    v_cvt_pk_bf16_f32 v67, v54, v55
    v_exp_f32 v56, v56
    v_exp_f32 v57, v57
    v_exp_f32 v58, v58
    v_cvt_pk_bf16_f32 v68, v56, v57
    v_exp_f32 v59, v59
    v_mfma_f32_32x32x16_bf16 v[160:175], a[88:91], v[64:67], v[160:175]
    s_waitcnt vmcnt(2)
    v_cvt_pk_bf16_f32 v69, v58, v59
    v_exp_f32 v60, v60
    v_exp_f32 v61, v61
    v_exp_f32 v62, v62
    v_exp_f32 v63, v63
    v_cvt_pk_bf16_f32 v70, v60, v61
    v_cvt_pk_bf16_f32 v71, v62, v63
    v_mfma_f32_32x32x16_bf16 v[48:63], a[96:99], a[180:183], 0
    v_exp_f32 v32, v32
    v_exp_f32 v33, v33
    v_exp_f32 v34, v34
    v_cvt_pk_bf16_f32 v64, v32, v33
    v_exp_f32 v35, v35
    v_mfma_f32_32x32x16_bf16 v[160:175], a[92:95], v[68:71], v[160:175]
    v_cvt_pk_bf16_f32 v65, v34, v35
    v_exp_f32 v36, v36
    v_exp_f32 v37, v37
    v_exp_f32 v38, v38
    v_cvt_pk_bf16_f32 v66, v36, v37
    v_exp_f32 v39, v39
    v_mfma_f32_32x32x16_bf16 v[48:63], a[100:103], a[184:187], v[48:63]
    v_cvt_pk_bf16_f32 v67, v38, v39
    v_exp_f32 v40, v40
    v_exp_f32 v41, v41
    v_exp_f32 v42, v42
    v_cvt_pk_bf16_f32 v68, v40, v41
    v_exp_f32 v43, v43
    v_mfma_f32_32x32x16_bf16 v[176:191], a[88:91], v[64:67], v[176:191]
    v_cvt_pk_bf16_f32 v69, v42, v43
    v_exp_f32 v44, v44
    v_exp_f32 v45, v45
    v_exp_f32 v46, v46
    v_exp_f32 v47, v47
    v_cvt_pk_bf16_f32 v70, v44, v45
    v_cvt_pk_bf16_f32 v71, v46, v47
    v_mfma_f32_32x32x16_bf16 v[32:47], a[96:99], a[188:191], 0
    v_exp_f32 v48, v48
    v_exp_f32 v49, v49
    v_exp_f32 v50, v50
    v_cvt_pk_bf16_f32 v64, v48, v49
    v_exp_f32 v51, v51
    v_mfma_f32_32x32x16_bf16 v[176:191], a[92:95], v[68:71], v[176:191]
    v_cvt_pk_bf16_f32 v65, v50, v51
    v_exp_f32 v52, v52
    v_exp_f32 v53, v53
    v_exp_f32 v54, v54
    v_cvt_pk_bf16_f32 v66, v52, v53
    v_exp_f32 v55, v55
    v_mfma_f32_32x32x16_bf16 v[32:47], a[100:103], a[192:195], v[32:47]
    s_waitcnt vmcnt(0)
    v_cvt_pk_bf16_f32 v67, v54, v55
    v_exp_f32 v56, v56
    v_exp_f32 v57, v57
    v_exp_f32 v58, v58
    v_cvt_pk_bf16_f32 v68, v56, v57
    v_exp_f32 v59, v59
    v_mfma_f32_32x32x16_bf16 v[144:159], a[104:107], v[64:67], v[144:159]
    v_cvt_pk_bf16_f32 v69, v58, v59
    v_exp_f32 v60, v60
    v_exp_f32 v61, v61
    v_exp_f32 v62, v62
    v_exp_f32 v63, v63
    v_cvt_pk_bf16_f32 v70, v60, v61
    v_cvt_pk_bf16_f32 v71, v62, v63
    v_mfma_f32_32x32x16_bf16 v[48:63], a[96:99], a[196:199], 0
    v_exp_f32 v32, v32
    v_exp_f32 v33, v33
    v_exp_f32 v34, v34
    v_cvt_pk_bf16_f32 v64, v32, v33
    v_exp_f32 v35, v35
    v_mfma_f32_32x32x16_bf16 v[144:159], a[108:111], v[68:71], v[144:159]
    v_cvt_pk_bf16_f32 v65, v34, v35
    v_exp_f32 v36, v36
    v_exp_f32 v37, v37
    v_exp_f32 v38, v38
    v_cvt_pk_bf16_f32 v66, v36, v37
    v_exp_f32 v39, v39
    v_mfma_f32_32x32x16_bf16 v[48:63], a[100:103], a[200:203], v[48:63]
    v_cvt_pk_bf16_f32 v67, v38, v39
    v_exp_f32 v40, v40
    v_exp_f32 v41, v41
    v_exp_f32 v42, v42
    v_cvt_pk_bf16_f32 v68, v40, v41
    v_exp_f32 v43, v43
    v_mfma_f32_32x32x16_bf16 v[160:175], a[104:107], v[64:67], v[160:175]
    ds_write_b128 v117, v[144:147] offset:0
    ds_write_b128 v117, v[148:151] offset:1024
    v_cvt_pk_bf16_f32 v69, v42, v43
    v_exp_f32 v44, v44
    v_exp_f32 v45, v45
    v_exp_f32 v46, v46
    v_exp_f32 v47, v47
    v_cvt_pk_bf16_f32 v70, v44, v45
    v_cvt_pk_bf16_f32 v71, v46, v47
    v_mfma_f32_32x32x16_bf16 v[32:47], a[80:83], v[104:107], 0
    ds_write_b128 v117, v[152:155] offset:2048
    ds_write_b128 v117, v[156:159] offset:3072
    v_exp_f32 v48, v48
    v_exp_f32 v49, v49
    v_exp_f32 v50, v50
    v_cvt_pk_bf16_f32 v64, v48, v49
    v_exp_f32 v51, v51
    v_mfma_f32_32x32x16_bf16 v[160:175], a[108:111], v[68:71], v[160:175]
    v_cvt_pk_bf16_f32 v65, v50, v51
    v_exp_f32 v52, v52
    v_exp_f32 v53, v53
    v_exp_f32 v54, v54
    v_cvt_pk_bf16_f32 v66, v52, v53
    v_exp_f32 v55, v55
    v_mfma_f32_32x32x16_bf16 v[32:47], a[84:87], v[108:111], v[32:47]
    v_cvt_pk_bf16_f32 v67, v54, v55
    v_exp_f32 v56, v56
    v_exp_f32 v57, v57
    v_exp_f32 v58, v58
    v_cvt_pk_bf16_f32 v68, v56, v57
    v_exp_f32 v59, v59
    v_mfma_f32_32x32x16_bf16 v[176:191], a[104:107], v[64:67], v[176:191]
    ds_write_b128 v118, v[160:163] offset:4096
    ds_write_b128 v118, v[164:167] offset:5120
    v_cvt_pk_bf16_f32 v69, v58, v59
    v_exp_f32 v60, v60
    v_exp_f32 v61, v61
    v_exp_f32 v62, v62
    v_exp_f32 v63, v63
    v_cvt_pk_bf16_f32 v70, v60, v61
    v_cvt_pk_bf16_f32 v71, v62, v63
    v_mfma_f32_32x32x16_bf16 v[48:63], a[96:99], v[104:107], 0
    ds_write_b128 v118, v[168:171] offset:6144
    ds_write_b128 v118, v[172:175] offset:7168
    v_exp_f32 v32, v32
    v_exp_f32 v33, v33
    v_exp_f32 v34, v34
    v_cvt_pk_bf16_f32 v64, v32, v33
    v_exp_f32 v35, v35
    v_mfma_f32_32x32x16_bf16 v[176:191], a[108:111], v[68:71], v[176:191]
    v_cvt_pk_bf16_f32 v65, v34, v35
    v_exp_f32 v36, v36
    v_exp_f32 v37, v37
    v_exp_f32 v38, v38
    v_cvt_pk_bf16_f32 v66, v36, v37
    v_exp_f32 v39, v39
    v_mfma_f32_32x32x16_bf16 v[48:63], a[100:103], v[108:111], v[48:63]
    v_cvt_pk_bf16_f32 v67, v38, v39
    v_exp_f32 v40, v40
    v_exp_f32 v41, v41
    v_exp_f32 v42, v42
    v_cvt_pk_bf16_f32 v68, v40, v41
    v_exp_f32 v43, v43
    v_mfma_f32_32x32x16_bf16 v[128:143], a[88:91], v[64:67], v[128:143]
    ds_write_b128 v119, v[176:179] offset:8192
    ds_write_b128 v119, v[180:183] offset:9216
    ds_write_b128 v119, v[184:187] offset:10240
    ds_write_b128 v119, v[188:191] offset:11264
L_page_12:
    s_cbranch_vccnz L_page_ret1
    v_cvt_pk_bf16_f32 v69, v42, v43
    v_exp_f32 v44, v44
    v_exp_f32 v45, v45
    v_exp_f32 v46, v46
    v_exp_f32 v47, v47
    v_cvt_pk_bf16_f32 v70, v44, v45
    v_cvt_pk_bf16_f32 v71, v46, v47
    s_waitcnt lgkmcnt(0)
    s_barrier
    ds_read_b128 v[204:207], v116 offset:3072
    ds_read_b128 v[220:223], v116 offset:7168
    ds_read_b128 v[236:239], v116 offset:11264
    v_exp_f32 v48, v48
    v_exp_f32 v49, v49
    v_exp_f32 v50, v50
    v_cvt_pk_bf16_f32 v64, v48, v49
    v_exp_f32 v51, v51
    v_mfma_f32_32x32x16_bf16 v[128:143], a[92:95], v[68:71], v[128:143]
    ds_read_b128 v[192:195], v116 offset:0
    ds_read_b128 v[208:211], v116 offset:4096
    ds_read_b128 v[224:227], v116 offset:8192
    ds_read_b128 v[196:199], v116 offset:1024
    ds_read_b128 v[212:215], v116 offset:5120
    ds_read_b128 v[228:231], v116 offset:9216
    v_cvt_pk_bf16_f32 v65, v50, v51
    v_exp_f32 v52, v52
    v_exp_f32 v53, v53
    v_exp_f32 v54, v54
    v_cvt_pk_bf16_f32 v66, v52, v53
    v_exp_f32 v55, v55
    s_nop 0
    v_cvt_pk_bf16_f32 v67, v54, v55
    v_exp_f32 v56, v56
    v_exp_f32 v57, v57
    v_exp_f32 v58, v58
    v_cvt_pk_bf16_f32 v68, v56, v57
    v_exp_f32 v59, v59
    v_mfma_f32_32x32x16_bf16 v[128:143], a[104:107], v[64:67], v[128:143]
    ds_read_b128 v[200:203], v116 offset:2048
    ds_read_b128 v[216:219], v116 offset:6144
    ds_read_b128 v[232:235], v116 offset:10240
    v_cvt_pk_bf16_f32 v69, v58, v59
    v_exp_f32 v60, v60
    v_exp_f32 v61, v61
    v_exp_f32 v62, v62
    v_exp_f32 v63, v63
    v_cvt_pk_bf16_f32 v70, v60, v61
    v_cvt_pk_bf16_f32 v71, v62, v63
    s_nop 1
    v_mfma_f32_32x32x16_bf16 v[128:143], a[108:111], v[68:71], v[128:143]
    s_waitcnt lgkmcnt(10)
    v_add_f32 v204, v204, v220
    v_add_f32 v205, v205, v221
    v_add_f32 v206, v206, v222
    v_add_f32 v207, v207, v223
    s_waitcnt lgkmcnt(7)
    v_add_f32 v192, v192, v208
    v_add_f32 v193, v193, v209
    v_add_f32 v194, v194, v210
    v_add_f32 v195, v195, v211
    s_waitcnt lgkmcnt(4)
    v_add_f32 v196, v196, v212
    v_add_f32 v197, v197, v213
    v_add_f32 v198, v198, v214
    v_add_f32 v199, v199, v215
    s_waitcnt lgkmcnt(1)
    v_pk_add_f32 v[200:201], v[200:201], v[216:217]
    v_pk_add_f32 v[202:203], v[202:203], v[218:219]
    v_pk_add_f32 v[140:141], v[140:141], v[236:237]
    v_pk_add_f32 v[142:143], v[142:143], v[238:239]
    v_pk_add_f32 v[140:141], v[140:141], v[204:205]
    v_pk_add_f32 v[142:143], v[142:143], v[206:207]
    v_pk_add_f32 v[128:129], v[128:129], v[224:225]
    v_mov_b32 v74, v140
    v_pk_add_f32 v[130:131], v[130:131], v[226:227]
    v_pk_add_f32 v[128:129], v[128:129], v[192:193]
    v_mov_b32 v75, v140
    v_pk_add_f32 v[130:131], v[130:131], v[194:195]
    v_pk_add_f32 v[132:133], v[132:133], v[228:229]
    s_add_u32 s90, s69, 13631488
    v_pk_add_f32 v[134:135], v[134:135], v[230:231]
    v_pk_add_f32 v[132:133], v[132:133], v[196:197]
    s_sub_u32 s91, s90, 4096
    v_pk_add_f32 v[134:135], v[134:135], v[198:199]
    s_waitcnt lgkmcnt(0)
    v_pk_add_f32 v[136:137], v[136:137], v[232:233]
    v_permlane32_swap_b32 v74, v75
    v_pk_add_f32 v[138:139], v[138:139], v[234:235]
    v_pk_add_f32 v[136:137], v[136:137], v[200:201]
    v_rcp_f32 v74, v75
    v_pk_add_f32 v[138:139], v[138:139], v[202:203]
    v_pk_mul_f32 v[128:129], v[128:129], v[74:75] op_sel:[0,0] op_sel_hi:[1,0]
    v_pk_mul_f32 v[130:131], v[130:131], v[74:75] op_sel:[0,0] op_sel_hi:[1,0]
    v_pk_mul_f32 v[132:133], v[132:133], v[74:75] op_sel:[0,0] op_sel_hi:[1,0]
    v_pk_mul_f32 v[134:135], v[134:135], v[74:75] op_sel:[0,0] op_sel_hi:[1,0]
    v_cvt_pk_bf16_f32 v192, v128, v129
    v_cvt_pk_bf16_f32 v193, v130, v131
    v_cvt_pk_bf16_f32 v194, v132, v133
    v_cvt_pk_bf16_f32 v195, v134, v135
    buffer_store_dwordx4 v[192:195], v1, s[52:55], s90 offen sc1
    v_pk_mul_f32 v[136:137], v[136:137], v[74:75] op_sel:[0,0] op_sel_hi:[1,0]
    v_pk_mul_f32 v[138:139], v[138:139], v[74:75] op_sel:[0,0] op_sel_hi:[1,0]
    v_pk_mul_f32 v[140:141], v[140:141], v[74:75] op_sel:[0,0] op_sel_hi:[1,0]
    v_pk_mul_f32 v[142:143], v[142:143], v[74:75] op_sel:[0,0] op_sel_hi:[1,0]
    v_cvt_pk_bf16_f32 v196, v136, v137
    v_cvt_pk_bf16_f32 v197, v138, v139
    v_cvt_pk_bf16_f32 v198, v140, v141
    v_cvt_pk_bf16_f32 v199, v142, v143
    s_mov_b64 exec, s[82:83]
    buffer_store_dwordx4 v[196:199], v1, s[52:55], s90 offen offset:1024 sc1
    s_mov_b64 exec, s[80:81]
    buffer_store_dwordx2 v[196:197], v5, s[52:55], s91 offen offset:1536 sc1
    s_mov_b64 exec, -1
    v_pk_mul_f32 v[72:73], v[128:129], 0
    v_pk_fma_f32 v[72:73], v[130:131], 0, v[72:73]
    v_pk_fma_f32 v[72:73], v[132:133], 0, v[72:73]
    v_pk_fma_f32 v[72:73], v[134:135], 0, v[72:73]
    v_pk_fma_f32 v[72:73], v[136:137], 0, v[72:73]
    v_pk_fma_f32 v[72:73], v[138:139], 0, v[72:73]
    v_pk_fma_f32 v[72:73], v[140:141], 0, v[72:73]
    v_pk_fma_f32 v[72:73], v[142:143], 0, v[72:73]
    v_add_f32 v72, v72, v73
    v_add_f32 v72, v72, v75
    s_mov_b32 s90, 0x5d800000
    v_cmp_nle_f32 s[98:99], v72, s90
    s_mov_b32 s90, 0x21800000
    v_cmp_nge_f32 s[96:97], v72, s90
    s_nop 1
    s_or_b64 s[98:99], s[98:99], s[96:97]
    s_or_b32 s90, s98, s99
    v_mov_b32 v72, s90
    ds_write_b32 v120, v72
    s_waitcnt lgkmcnt(0)
    s_barrier
    ds_read_b128 v[72:75], v121
    s_waitcnt lgkmcnt(0)
    v_or_b32 v72, v72, v73
    v_or3_b32 v72, v72, v74, v75
    s_nop 0
    v_readfirstlane_b32 s90, v72
    s_nop 1
    s_andn2_b32 s90, s90, s95
    s_cmp_lg_u32 s90, 0
    s_cbranch_scc1 L_slow_27
    s_waitcnt vmcnt(0)
    s_mov_b32 s101, s56
    s_atomic_add s101, s[64:65], 0 glc
    s_mul_i32 s90, s62, 2048
    s_add_u32 s90, s90, 151552
    v_and_b32 v106, 31, v0
    v_lshrrev_b32 v107, 5, v0
    v_mul_u32_u24 v104, 56, v106
    v_lshl_add_u32 v104, v107, 3, v104
    v_add_u32 v104, s90, v104
    v_lshl_add_u32 v105, v0, 3, s90
    s_lshl_b32 s90, s60, 2
    s_add_u32 s90, s90, s62
    s_mul_i32 s90, s90, 28672
    s_mul_i32 s91, s61, 56
    s_add_u32 s90, s90, s91
    v_add_u32 v106, 0, v0
    v_mul_u32_u24 v107, 9363, v106
    v_lshrrev_b32 v107, 16, v107
    v_mul_u32_u24 v107, 840, v107
    v_lshl_add_u32 v107, v106, 3, v107
    v_add_u32 v108, s90, v107
    v_add_u32 v106, 64, v0
    v_mul_u32_u24 v107, 9363, v106
    v_lshrrev_b32 v107, 16, v107
    v_mul_u32_u24 v107, 840, v107
    v_lshl_add_u32 v107, v106, 3, v107
    v_add_u32 v109, s90, v107
    v_add_u32 v106, 128, v0
    v_mul_u32_u24 v107, 9363, v106
    v_lshrrev_b32 v107, 16, v107
    v_mul_u32_u24 v107, 840, v107
    v_lshl_add_u32 v107, v106, 3, v107
    v_add_u32 v110, s90, v107
    v_add_u32 v106, 192, v0
    v_mul_u32_u24 v107, 9363, v106
    v_lshrrev_b32 v107, 16, v107
    v_mul_u32_u24 v107, 840, v107
    v_lshl_add_u32 v107, v106, 3, v107
    v_add_u32 v111, s90, v107
    s_mov_b64 exec, s[80:81]
    v_mov_b32 v111, 0x40000000
    s_mov_b64 exec, -1
    s_add_u32 s72, s68, 13631488
    s_xor_b32 s73, s72, 4096
    s_xor_b32 s74, s72, 8192
    s_xor_b32 s75, s72, 12288
    s_xor_b32 s76, s72, 16384
    s_xor_b32 s77, s72, 20480
    s_xor_b32 s78, s72, 24576
    s_xor_b32 s79, s72, 28672
    ds_read_b128 a[128:131], v2 offset:28672
    ds_read_b128 a[132:135], v2 offset:29696
    ds_read_b128 a[136:139], v2 offset:30720
    ds_read_b128 a[140:143], v2 offset:31744
    ds_read_b128 a[144:147], v2 offset:32768
    s_waitcnt lgkmcnt(0)
    s_add_u32 s101, s101, s56
    s_waitcnt lgkmcnt(0)
    s_add_u32 s89, s101, 0x64646464
    s_and_b32 s89, s89, 0x80808080
    s_cmp_eq_u32 s89, 0x80808080
    s_cbranch_scc1 L_go_29
L_poll_28:
    s_mov_b32 s101, 0
    s_atomic_add s101, s[64:65], 0 glc
    s_sub_u32 s63, s63, 1
    s_cbranch_scc1 L_go_29_to
    s_waitcnt lgkmcnt(0)
    s_add_u32 s89, s101, 0x64646464
    s_and_b32 s89, s89, 0x80808080
    s_cmp_eq_u32 s89, 0x80808080
    s_cbranch_scc0 L_poll_28
    s_branch L_go_29
L_go_29_to:
    s_mov_b32 s63, 0
    s_waitcnt lgkmcnt(0)
L_go_29:
    buffer_load_dwordx4 v[128:131], v1, s[52:55], s72 offen offset:0 sc1
    buffer_load_dwordx4 v[132:135], v1, s[52:55], s72 offen offset:2048 sc1
    buffer_load_dwordx4 v[136:139], v1, s[52:55], s73 offen offset:0 sc1
    buffer_load_dwordx4 v[140:143], v1, s[52:55], s73 offen offset:2048 sc1
    buffer_load_dwordx4 v[144:147], v10, s[52:55], s72 offen offset:1024 sc1
    buffer_load_dwordx4 v[148:151], v10, s[52:55], s73 offen offset:1024 sc1
    buffer_load_dwordx2 v[154:155], v5, s[52:55], s72 offen offset:1536 sc1
    buffer_load_dwordx2 v[156:157], v5, s[52:55], s72 offen offset:3584 sc1
    buffer_load_dwordx2 v[186:187], v5, s[52:55], s74 offen offset:1536 sc1
    buffer_load_dwordx2 v[188:189], v5, s[52:55], s74 offen offset:3584 sc1
    buffer_load_dwordx2 v[218:219], v5, s[52:55], s76 offen offset:1536 sc1
    buffer_load_dwordx2 v[220:221], v5, s[52:55], s76 offen offset:3584 sc1
    buffer_load_dwordx2 v[250:251], v5, s[52:55], s78 offen offset:1536 sc1
    buffer_load_dwordx2 v[252:253], v5, s[52:55], s78 offen offset:3584 sc1
    s_waitcnt vmcnt(13)
    v_mfma_f32_32x32x16_bf16 v[16:31], a[128:131], v[128:131], v[16:31]
    ds_read_b128 a[148:151], v2 offset:33792
    buffer_load_dwordx4 v[160:163], v1, s[52:55], s74 offen offset:0 sc1
    buffer_load_dwordx4 v[164:167], v1, s[52:55], s74 offen offset:2048 sc1
    s_waitcnt vmcnt(14)
    v_mfma_f32_32x32x16_bf16 v[16:31], a[132:135], v[132:135], v[16:31]
    ds_read_b128 a[152:155], v2 offset:34816
    buffer_load_dwordx4 v[168:171], v1, s[52:55], s75 offen offset:0 sc1
    buffer_load_dwordx4 v[172:175], v1, s[52:55], s75 offen offset:2048 sc1
    s_waitcnt vmcnt(15)
    v_mfma_f32_32x32x16_bf16 v[16:31], a[136:139], v[136:139], v[16:31]
    ds_read_b128 a[156:159], v2 offset:41984
    buffer_load_dwordx4 v[176:179], v10, s[52:55], s74 offen offset:1024 sc1
    s_waitcnt vmcnt(15)
    v_mfma_f32_32x32x16_bf16 v[16:31], a[140:143], v[140:143], v[16:31]
    ds_read_b128 a[128:131], v2 offset:49152
    buffer_load_dwordx4 v[180:183], v10, s[52:55], s75 offen offset:1024 sc1
    s_waitcnt vmcnt(15)
    v_mfma_f32_32x32x16_bf16 v[16:31], a[144:147], v[144:147], v[16:31]
    ds_read_b128 a[132:135], v2 offset:56320
    buffer_load_dwordx4 v[192:195], v1, s[52:55], s76 offen offset:0 sc1
    s_waitcnt vmcnt(15) lgkmcnt(4)
    v_mfma_f32_32x32x16_bf16 v[16:31], a[148:151], v[148:151], v[16:31]
    ds_read_b128 a[136:139], v2 offset:35840
    buffer_load_dwordx4 v[196:199], v1, s[52:55], s76 offen offset:2048 sc1
    s_waitcnt vmcnt(14) lgkmcnt(4)
    v_mfma_f32_32x32x16_bf16 v[16:31], a[152:155], v[154:157], v[16:31]
    ds_read_b128 a[140:143], v2 offset:36864
    buffer_load_dwordx4 v[200:203], v1, s[52:55], s77 offen offset:0 sc1
    s_waitcnt vmcnt(13) lgkmcnt(4)
    v_mfma_f32_32x32x16_bf16 v[16:31], a[156:159], v[186:189], v[16:31]
    ds_read_b128 a[144:147], v2 offset:37888
    buffer_load_dwordx4 v[204:207], v1, s[52:55], s77 offen offset:2048 sc1
    s_waitcnt vmcnt(12) lgkmcnt(4)
    v_mfma_f32_32x32x16_bf16 v[16:31], a[128:131], v[218:221], v[16:31]
    ds_read_b128 a[148:151], v2 offset:38912
    buffer_load_dwordx4 v[208:211], v10, s[52:55], s76 offen offset:1024 sc1
    s_waitcnt vmcnt(11) lgkmcnt(4)
    v_mfma_f32_32x32x16_bf16 v[16:31], a[132:135], v[250:253], v[16:31]
    ds_read_b128 a[152:155], v2 offset:39936
    buffer_load_dwordx4 v[212:215], v10, s[52:55], s77 offen offset:1024 sc1
    s_waitcnt vmcnt(11) lgkmcnt(4)
    v_mfma_f32_32x32x16_bf16 v[16:31], a[136:139], v[160:163], v[16:31]
    ds_read_b128 a[156:159], v2 offset:40960
    buffer_load_dwordx4 v[224:227], v1, s[52:55], s78 offen offset:0 sc1
    s_waitcnt vmcnt(11) lgkmcnt(4)
    v_mfma_f32_32x32x16_bf16 v[16:31], a[140:143], v[164:167], v[16:31]
    ds_read_b128 a[128:131], v2 offset:43008
    buffer_load_dwordx4 v[228:231], v1, s[52:55], s78 offen offset:2048 sc1
    s_waitcnt vmcnt(11) lgkmcnt(4)
    v_mfma_f32_32x32x16_bf16 v[16:31], a[144:147], v[168:171], v[16:31]
    ds_read_b128 a[132:135], v2 offset:44032
    buffer_load_dwordx4 v[232:235], v1, s[52:55], s79 offen offset:0 sc1
    s_waitcnt vmcnt(11) lgkmcnt(4)
    v_mfma_f32_32x32x16_bf16 v[16:31], a[148:151], v[172:175], v[16:31]
    ds_read_b128 a[136:139], v2 offset:45056
    buffer_load_dwordx4 v[236:239], v1, s[52:55], s79 offen offset:2048 sc1
    s_waitcnt vmcnt(11) lgkmcnt(4)
    v_mfma_f32_32x32x16_bf16 v[16:31], a[152:155], v[176:179], v[16:31]
    ds_read_b128 a[140:143], v2 offset:46080
    buffer_load_dwordx4 v[240:243], v10, s[52:55], s78 offen offset:1024 sc1
    s_waitcnt vmcnt(11) lgkmcnt(4)
    v_mfma_f32_32x32x16_bf16 v[16:31], a[156:159], v[180:183], v[16:31]
    ds_read_b128 a[144:147], v2 offset:47104
    buffer_load_dwordx4 v[244:247], v10, s[52:55], s79 offen offset:1024 sc1
    s_waitcnt vmcnt(11) lgkmcnt(4)
    v_mfma_f32_32x32x16_bf16 v[16:31], a[128:131], v[192:195], v[16:31]
    ds_read_b128 a[148:151], v2 offset:48128
    s_waitcnt vmcnt(10) lgkmcnt(4)
    v_mfma_f32_32x32x16_bf16 v[16:31], a[132:135], v[196:199], v[16:31]
    ds_read_b128 a[152:155], v2 offset:50176
    s_waitcnt vmcnt(9) lgkmcnt(4)
    v_mfma_f32_32x32x16_bf16 v[16:31], a[136:139], v[200:203], v[16:31]
    ds_read_b128 a[156:159], v2 offset:51200
    s_waitcnt vmcnt(8) lgkmcnt(4)
    v_mfma_f32_32x32x16_bf16 v[16:31], a[140:143], v[204:207], v[16:31]
    ds_read_b128 a[128:131], v2 offset:52224
    s_waitcnt vmcnt(7) lgkmcnt(4)
    v_mfma_f32_32x32x16_bf16 v[16:31], a[144:147], v[208:211], v[16:31]
    ds_read_b128 a[132:135], v2 offset:53248
    s_waitcnt vmcnt(6) lgkmcnt(4)
    v_mfma_f32_32x32x16_bf16 v[16:31], a[148:151], v[212:215], v[16:31]
    ds_read_b128 a[136:139], v2 offset:54272
    s_waitcnt vmcnt(5) lgkmcnt(4)
    v_mfma_f32_32x32x16_bf16 v[16:31], a[152:155], v[224:227], v[16:31]
    ds_read_b128 a[140:143], v2 offset:55296
    s_waitcnt vmcnt(4) lgkmcnt(4)
    v_mfma_f32_32x32x16_bf16 v[16:31], a[156:159], v[228:231], v[16:31]
    s_waitcnt vmcnt(3) lgkmcnt(3)
    v_mfma_f32_32x32x16_bf16 v[16:31], a[128:131], v[232:235], v[16:31]
    s_waitcnt vmcnt(2) lgkmcnt(2)
    v_mfma_f32_32x32x16_bf16 v[16:31], a[132:135], v[236:239], v[16:31]
    s_waitcnt vmcnt(1) lgkmcnt(1)
    v_mfma_f32_32x32x16_bf16 v[16:31], a[136:139], v[240:243], v[16:31]
    s_waitcnt vmcnt(0) lgkmcnt(0)
    v_mfma_f32_32x32x16_bf16 v[16:31], a[140:143], v[244:247], v[16:31]
    s_nop 11
    v_cvt_pk_bf16_f32 v88, v16, v17
    v_cvt_pk_bf16_f32 v89, v18, v19
    v_cvt_pk_bf16_f32 v90, v20, v21
    v_cvt_pk_bf16_f32 v91, v22, v23
    v_cvt_pk_bf16_f32 v92, v24, v25
    v_cvt_pk_bf16_f32 v93, v26, v27
    v_cvt_pk_bf16_f32 v94, v28, v29
    v_cvt_pk_bf16_f32 v95, v30, v31
    ds_write_b64 v104, v[88:89] offset:0
    ds_write_b64 v104, v[90:91] offset:16
    ds_write_b64 v104, v[92:93] offset:32
    s_mov_b64 exec, s[82:83]
    ds_write_b64 v104, v[94:95] offset:48
    s_mov_b64 exec, -1
    ds_read_b64 v[96:97], v105 offset:0
    ds_read_b64 v[98:99], v105 offset:512
    ds_read_b64 v[100:101], v105 offset:1024
    ds_read_b64 v[102:103], v105 offset:1536
    s_waitcnt lgkmcnt(3)
    buffer_store_dwordx2 v[96:97], v108, s[48:51], 0 offen
    s_waitcnt lgkmcnt(2)
    buffer_store_dwordx2 v[98:99], v109, s[48:51], 0 offen
    s_waitcnt lgkmcnt(1)
    buffer_store_dwordx2 v[100:101], v110, s[48:51], 0 offen
    s_waitcnt lgkmcnt(0)
    buffer_store_dwordx2 v[102:103], v111, s[48:51], 0 offen
    s_waitcnt vmcnt(0)
L_end:
    s_endpgm
L_slow_12:
    s_waitcnt vmcnt(0) lgkmcnt(0)
    s_mov_b32 s95, -1
    s_add_u32 s92, s70, 15728640
    s_mov_b32 s91, 16
    v_mov_b32 v72, 0xff800000
    v_mov_b32 v73, 0xff800000
    v_mov_b32 v74, 0xff800000
    v_mov_b32 v75, 0xff800000
L_mx_30:
    buffer_load_dwordx4 a[0:3], v1, s[52:55], s92 offen sc1
    buffer_load_dwordx4 a[4:7], v1, s[52:55], s92 offen offset:1024 sc1
    s_waitcnt vmcnt(1)
    v_mfma_f32_32x32x16_bf16 v[32:47], a[0:3], v[104:107], 0
    s_waitcnt vmcnt(0)
    v_mfma_f32_32x32x16_bf16 v[32:47], a[4:7], v[108:111], v[32:47]
    s_nop 11
    v_max3_f32 v72, v72, v32, v33
    v_max3_f32 v72, v72, v34, v35
    v_max3_f32 v72, v72, v36, v37
    v_max3_f32 v72, v72, v38, v39
    v_max3_f32 v72, v72, v40, v41
    v_max3_f32 v72, v72, v42, v43
    v_max3_f32 v72, v72, v44, v45
    v_max3_f32 v72, v72, v46, v47
    v_mfma_f32_32x32x16_bf16 v[32:47], a[0:3], a[180:183], 0
    v_mfma_f32_32x32x16_bf16 v[32:47], a[4:7], a[184:187], v[32:47]
    s_nop 11
    v_max3_f32 v73, v73, v32, v33
    v_max3_f32 v73, v73, v34, v35
    v_max3_f32 v73, v73, v36, v37
    v_max3_f32 v73, v73, v38, v39
    v_max3_f32 v73, v73, v40, v41
    v_max3_f32 v73, v73, v42, v43
    v_max3_f32 v73, v73, v44, v45
    v_max3_f32 v73, v73, v46, v47
    v_mfma_f32_32x32x16_bf16 v[32:47], a[0:3], a[188:191], 0
    v_mfma_f32_32x32x16_bf16 v[32:47], a[4:7], a[192:195], v[32:47]
    s_nop 11
    v_max3_f32 v74, v74, v32, v33
    v_max3_f32 v74, v74, v34, v35
    v_max3_f32 v74, v74, v36, v37
    v_max3_f32 v74, v74, v38, v39
    v_max3_f32 v74, v74, v40, v41
    v_max3_f32 v74, v74, v42, v43
    v_max3_f32 v74, v74, v44, v45
    v_max3_f32 v74, v74, v46, v47
    v_mfma_f32_32x32x16_bf16 v[32:47], a[0:3], a[196:199], 0
    v_mfma_f32_32x32x16_bf16 v[32:47], a[4:7], a[200:203], v[32:47]
    s_nop 11
    v_max3_f32 v75, v75, v32, v33
    v_max3_f32 v75, v75, v34, v35
    v_max3_f32 v75, v75, v36, v37
    v_max3_f32 v75, v75, v38, v39
    v_max3_f32 v75, v75, v40, v41
    v_max3_f32 v75, v75, v42, v43
    v_max3_f32 v75, v75, v44, v45
    v_max3_f32 v75, v75, v46, v47
    s_add_u32 s92, s92, 4096
    s_sub_u32 s91, s91, 1
    s_cmp_lg_u32 s91, 0
    s_nop 0
    s_cbranch_scc1 L_mx_30
    s_barrier
    s_add_u32 s90, s62, 0
    s_and_b32 s90, s90, 3
    s_lshl_b32 s90, s90, 10
    s_add_u32 s90, s90, 0
    v_lshl_add_u32 v71, v0, 2, s90
    ds_write_b32 v71, v72
    s_add_u32 s90, s62, 1
    s_and_b32 s90, s90, 3
    s_lshl_b32 s90, s90, 10
    s_add_u32 s90, s90, 256
    v_lshl_add_u32 v71, v0, 2, s90
    ds_write_b32 v71, v73
    s_add_u32 s90, s62, 2
    s_and_b32 s90, s90, 3
    s_lshl_b32 s90, s90, 10
    s_add_u32 s90, s90, 512
    v_lshl_add_u32 v71, v0, 2, s90
    ds_write_b32 v71, v74
    s_add_u32 s90, s62, 3
    s_and_b32 s90, s90, 3
    s_lshl_b32 s90, s90, 10
    s_add_u32 s90, s90, 768
    v_lshl_add_u32 v71, v0, 2, s90
    ds_write_b32 v71, v75
    s_lshl_b32 s90, s62, 10
    s_add_u32 s90, s90, 0
    v_lshl_add_u32 v71, v0, 2, s90
    s_waitcnt lgkmcnt(0)
    s_barrier
    ds_read_b32 v72, v71 offset:0
    ds_read_b32 v73, v71 offset:256
    ds_read_b32 v74, v71 offset:512
    ds_read_b32 v75, v71 offset:768
    s_waitcnt lgkmcnt(1)
    v_max3_f32 v72, v72, v73, v74
    s_waitcnt lgkmcnt(0)
    v_max_f32 v72, v72, v75
    v_mov_b32 v73, v72
    s_nop 1
    v_permlane32_swap_b32 v73, v72
    v_max_f32 v72, v72, v73
    v_add_f32 v15, v15, v72
    s_add_u32 s92, s70, 15728640
    s_waitcnt lgkmcnt(0)
    s_barrier
    s_branch L_attn_8
L_slow_27:
    s_waitcnt vmcnt(0) lgkmcnt(0)
    s_mov_b32 s95, -1
    s_add_u32 s92, s70, 19922944
    s_mov_b32 s91, 16
    v_mov_b32 v72, 0xff800000
    v_mov_b32 v73, 0xff800000
    v_mov_b32 v74, 0xff800000
    v_mov_b32 v75, 0xff800000
L_mx_31:
    buffer_load_dwordx4 a[0:3], v1, s[52:55], s92 offen sc1
    buffer_load_dwordx4 a[4:7], v1, s[52:55], s92 offen offset:1024 sc1
    s_waitcnt vmcnt(1)
    v_mfma_f32_32x32x16_bf16 v[32:47], a[0:3], v[104:107], 0
    s_waitcnt vmcnt(0)
    v_mfma_f32_32x32x16_bf16 v[32:47], a[4:7], v[108:111], v[32:47]
    s_nop 11
    v_max3_f32 v72, v72, v32, v33
    v_max3_f32 v72, v72, v34, v35
    v_max3_f32 v72, v72, v36, v37
    v_max3_f32 v72, v72, v38, v39
    v_max3_f32 v72, v72, v40, v41
    v_max3_f32 v72, v72, v42, v43
    v_max3_f32 v72, v72, v44, v45
    v_max3_f32 v72, v72, v46, v47
    v_mfma_f32_32x32x16_bf16 v[32:47], a[0:3], a[180:183], 0
    v_mfma_f32_32x32x16_bf16 v[32:47], a[4:7], a[184:187], v[32:47]
    s_nop 11
    v_max3_f32 v73, v73, v32, v33
    v_max3_f32 v73, v73, v34, v35
    v_max3_f32 v73, v73, v36, v37
    v_max3_f32 v73, v73, v38, v39
    v_max3_f32 v73, v73, v40, v41
    v_max3_f32 v73, v73, v42, v43
    v_max3_f32 v73, v73, v44, v45
    v_max3_f32 v73, v73, v46, v47
    v_mfma_f32_32x32x16_bf16 v[32:47], a[0:3], a[188:191], 0
    v_mfma_f32_32x32x16_bf16 v[32:47], a[4:7], a[192:195], v[32:47]
    s_nop 11
    v_max3_f32 v74, v74, v32, v33
    v_max3_f32 v74, v74, v34, v35
    v_max3_f32 v74, v74, v36, v37
    v_max3_f32 v74, v74, v38, v39
    v_max3_f32 v74, v74, v40, v41
    v_max3_f32 v74, v74, v42, v43
    v_max3_f32 v74, v74, v44, v45
    v_max3_f32 v74, v74, v46, v47
    v_mfma_f32_32x32x16_bf16 v[32:47], a[0:3], a[196:199], 0
    v_mfma_f32_32x32x16_bf16 v[32:47], a[4:7], a[200:203], v[32:47]
    s_nop 11
    v_max3_f32 v75, v75, v32, v33
    v_max3_f32 v75, v75, v34, v35
    v_max3_f32 v75, v75, v36, v37
    v_max3_f32 v75, v75, v38, v39
    v_max3_f32 v75, v75, v40, v41
    v_max3_f32 v75, v75, v42, v43
    v_max3_f32 v75, v75, v44, v45
    v_max3_f32 v75, v75, v46, v47
    s_add_u32 s92, s92, 4096
    s_sub_u32 s91, s91, 1
    s_cmp_lg_u32 s91, 0
    s_nop 0
    s_cbranch_scc1 L_mx_31
    s_barrier
    s_add_u32 s90, s62, 0
    s_and_b32 s90, s90, 3
    s_lshl_b32 s90, s90, 10
    s_add_u32 s90, s90, 0
    v_lshl_add_u32 v71, v0, 2, s90
    ds_write_b32 v71, v72
    s_add_u32 s90, s62, 1
    s_and_b32 s90, s90, 3
    s_lshl_b32 s90, s90, 10
    s_add_u32 s90, s90, 256
    v_lshl_add_u32 v71, v0, 2, s90
    ds_write_b32 v71, v73
    s_add_u32 s90, s62, 2
    s_and_b32 s90, s90, 3
    s_lshl_b32 s90, s90, 10
    s_add_u32 s90, s90, 512
    v_lshl_add_u32 v71, v0, 2, s90
    ds_write_b32 v71, v74
    s_add_u32 s90, s62, 3
    s_and_b32 s90, s90, 3
    s_lshl_b32 s90, s90, 10
    s_add_u32 s90, s90, 768
    v_lshl_add_u32 v71, v0, 2, s90
    ds_write_b32 v71, v75
    s_lshl_b32 s90, s62, 10
    s_add_u32 s90, s90, 0
    v_lshl_add_u32 v71, v0, 2, s90
    s_waitcnt lgkmcnt(0)
    s_barrier
    ds_read_b32 v72, v71 offset:0
    ds_read_b32 v73, v71 offset:256
    ds_read_b32 v74, v71 offset:512
    ds_read_b32 v75, v71 offset:768
    s_waitcnt lgkmcnt(1)
    v_max3_f32 v72, v72, v73, v74
    s_waitcnt lgkmcnt(0)
    v_max_f32 v72, v72, v75
    v_mov_b32 v73, v72
    s_nop 1
    v_permlane32_swap_b32 v73, v72
    v_max_f32 v72, v72, v73
    v_add_f32 v15, v15, v72
    s_add_u32 s92, s70, 19922944
    s_waitcnt lgkmcnt(0)
    s_barrier
    s_branch L_attn_23
L_rest_11:
    s_mov_b32 s101, 0
    s_atomic_add s101, s[66:67], 0 glc
    s_waitcnt lgkmcnt(0)
    s_add_u32 s89, s101, 0x78787878
    s_and_b32 s89, s89, 0x80808080
    s_cmp_eq_u32 s89, 0x80808080
    s_cbranch_scc1 L_go_33
L_poll_32:
    s_mov_b32 s101, 0
    s_atomic_add s101, s[66:67], 0 glc
    s_sub_u32 s63, s63, 1
    s_cbranch_scc1 L_go_33_to
    s_waitcnt lgkmcnt(0)
    s_add_u32 s89, s101, 0x78787878
    s_and_b32 s89, s89, 0x80808080
    s_cmp_eq_u32 s89, 0x80808080
    s_cbranch_scc0 L_poll_32
    s_branch L_go_33
L_go_33_to:
    s_mov_b32 s63, 0
    s_waitcnt lgkmcnt(0)
L_go_33:
    s_branch L_rest_11_ok
L_rest_26:
    s_mov_b32 s101, 0
    s_atomic_add s101, s[66:67], 0 glc
    s_waitcnt lgkmcnt(0)
    s_add_u32 s89, s101, 0x70707070
    s_and_b32 s89, s89, 0x80808080
    s_cmp_eq_u32 s89, 0x80808080
    s_cbranch_scc1 L_go_35
L_poll_34:
    s_mov_b32 s101, 0
    s_atomic_add s101, s[66:67], 0 glc
    s_sub_u32 s63, s63, 1
    s_cbranch_scc1 L_go_35_to
    s_waitcnt lgkmcnt(0)
    s_add_u32 s89, s101, 0x70707070
    s_and_b32 s89, s89, 0x80808080
    s_cmp_eq_u32 s89, 0x80808080
    s_cbranch_scc0 L_poll_34
    s_branch L_go_35
L_go_35_to:
    s_mov_b32 s63, 0
    s_waitcnt lgkmcnt(0)
L_go_35:
    s_branch L_rest_26_ok
L_code_end:
.fill 64, 4, 0xbf800000
.section .rodata,"a"
.p2align 6
.amdhsa_kernel interleave_layers__linear_kernel_hedgehog__mha_block__prompt_kernel
  .amdhsa_next_free_vgpr 464
  .amdhsa_next_free_sgpr 102
  .amdhsa_accum_offset 256
  .amdhsa_group_segment_fixed_size 0
  .amdhsa_kernarg_size 80
  .amdhsa_user_sgpr_count 2
  .amdhsa_user_sgpr_kernarg_segment_ptr 1
  .amdhsa_system_sgpr_workgroup_id_x 1
  .amdhsa_float_denorm_mode_32 3
.end_amdhsa_kernel
```
